```python
import torch

def _softmax(x, axis=-1):
    return torch.softmax(x, dim=axis)
def _gelu(x):
    return torch.nn.functional.gelu(x, approximate="tanh")
def _silu(x):
    return torch.nn.functional.silu(x)
def _sigmoid(x):
    return torch.sigmoid(x)
def _layernorm(x, axis=-1, eps=1e-5):
    m = x.mean(dim=axis, keepdim=True)
    v = x.var(dim=axis, keepdim=True, unbiased=False)
    return (x - m) / torch.sqrt(v + eps)
def _scatter_add(tgt, idx, src, axis=0):
    return tgt.clone().index_add_(axis, idx, src)
def _segment_sum(src, seg, n):
    out = torch.zeros((n,) + src.shape[1:], dtype=src.dtype)
    return out.index_add_(0, seg, src)
def _pad(x, pw):
    flat = tuple(v for pair in reversed(pw) for v in pair)
    return torch.nn.functional.pad(x, flat)

kernel_name = 'interleave_layers__grouped_kv_mqa__dense_activation_gelu__prompt'

def setup_inputs():

    _w = (lambda a: (lambda t: t.to(torch.bfloat16) if t.is_floating_point() else t)(torch.as_tensor(a)))
    def _A_setup():
        B, S, D, H = 1, 2048, 512, 32
        Dh = D // H
        return {
            "x": _w((lambda *s: torch.randn(*s, dtype=torch.bfloat16) * 0.05)(B, S, D)),
            "wq": _w((lambda *s: torch.randn(*s, dtype=torch.bfloat16) * 0.05)(D, H * Dh)),
            "wk": _w((lambda *s: torch.randn(*s, dtype=torch.bfloat16) * 0.05)(D, Dh)),
            "wv": _w((lambda *s: torch.randn(*s, dtype=torch.bfloat16) * 0.05)(D, Dh)),
            "wo": _w((lambda *s: torch.randn(*s, dtype=torch.bfloat16) * 0.05)(H * Dh, D)),
        }
    _A_in = _A_setup()

    def _B_setup():
        B, S, D, F = 1, 2048, 512, 1376
        return {
            "x": _w((lambda *s: torch.randn(*s, dtype=torch.bfloat16) * 0.05)(B, S, D)),
            "w1": _w((lambda *s: torch.randn(*s, dtype=torch.bfloat16) * 0.8)(D, F) * (D ** -0.5)),
            "b1": _w((lambda *s: torch.randn(*s, dtype=torch.bfloat16) * 12.8)(F) * 0.01),
            "w2": _w((lambda *s: torch.randn(*s, dtype=torch.bfloat16) * 0.2)(F, D) * (F ** -0.5)),
            "b2": _w((lambda *s: torch.randn(*s, dtype=torch.bfloat16) * 1.6)(D) * 0.01),
        }
    _B_in = _B_setup()

    return {
        "A_x": _A_in["x"],
        "A_wq": _A_in["wq"],
        "A_wk": _A_in["wk"],
        "A_wv": _A_in["wv"],
        "A_wo": _A_in["wo"],
        "B_x": _B_in["x"],
        "B_w1": _B_in["w1"],
        "B_b1": _B_in["b1"],
        "B_w2": _B_in["w2"],
        "B_b2": _B_in["b2"],
    }

def reference(A_x, A_wq, A_wk, A_wv, A_wo, B_x, B_w1, B_b1, B_w2, B_b2):
    def _A_ref(x, wq, wk, wv, wo):
        B, S, D = x.shape
        H = 32
        Dh = D // H
        q = (lambda x, *d: x.permute(*d))((x @ wq).reshape(B, S, H, Dh), 0, 2, 1, 3)
        k = x @ wk
        v = x @ wv
        scores = torch.einsum("bhqd,bkd->bhqk", q, k) * (Dh ** -0.5)
        p = _softmax(scores, axis=-1)
        o = torch.einsum("bhqk,bkd->bhqd", p, v)
        return (lambda x, *d: x.permute(*d))(o, 0, 2, 1, 3).reshape(B, S, H * Dh) @ wo

    def _B_ref(x, w1, b1, w2, b2):
        h = torch.einsum("bsd,df->bsf", x, w1) + b1
        h = _gelu(h)
        return torch.einsum("bsf,fd->bsd", h, w2) + b2

    x = A_x
    x = x + _A_ref(_layernorm(x, axis=-1), A_wq, A_wk, A_wv, A_wo)
    x = x + _B_ref(_layernorm(x, axis=-1), B_w1, B_b1, B_w2, B_b2)
    x = x + _A_ref(_layernorm(x, axis=-1), A_wq, A_wk, A_wv, A_wo)
    x = x + _B_ref(_layernorm(x, axis=-1), B_w1, B_b1, B_w2, B_b2)
    return x
```

```asm
; @launch kernel=prep_kernel grid=(221,1,1) block=(512,1,1) lds=4096
; @launch kernel=main_kernel grid=(256,1,1) block=(512,1,1) lds=163840
.amdgcn_target "amdgcn-amd-amdhsa--gfx950"
.text
.globl prep_kernel
.p2align 8
.type prep_kernel,@function
prep_kernel:
    s_cmp_ge_u32 s2, 221
    s_cbranch_scc1 prep_kernel_exit
    s_load_dwordx2 s[4:5], s[0:1], 96
    s_load_dwordx2 s[40:41], s[0:1], 0
    s_load_dwordx2 s[44:45], s[0:1], 8
    s_load_dwordx2 s[48:49], s[0:1], 16
    s_load_dwordx2 s[52:53], s[0:1], 24
    s_load_dwordx2 s[56:57], s[0:1], 32
    s_load_dwordx2 s[60:61], s[0:1], 48
    s_load_dwordx2 s[64:65], s[0:1], 64
    s_load_dwordx2 s[12:13], s[0:1], 56
    v_lshrrev_b32 v2, 6, v0
    v_and_b32 v3, 63, v0
    v_readfirstlane_b32 s20, v2
    v_lshlrev_b32 v0, 4, v3
    v_lshrrev_b32 v1, 5, v3
    v_lshlrev_b32 v1, 4, v1
    s_mov_b32 s35, 0x3f803f80
    s_mov_b32 s14, 0xac0
    s_mov_b32 s15, 0x00020000
    s_mov_b32 s6, 0x10000000
    s_mov_b32 s7, 0x00020000
    s_mov_b32 s42, 0x200000
    s_mov_b32 s43, 0x00020000
    s_mov_b32 s46, 0x80000
    s_mov_b32 s47, 0x00020000
    s_mov_b32 s50, 0x4000
    s_mov_b32 s51, 0x00020000
    s_mov_b32 s54, 0x4000
    s_mov_b32 s55, 0x00020000
    s_mov_b32 s58, 0x80000
    s_mov_b32 s59, 0x00020000
    s_mov_b32 s62, 0x158000
    s_mov_b32 s63, 0x00020000
    s_mov_b32 s66, 0x158000
    s_mov_b32 s67, 0x00020000
    v_and_b32 v4, 31, v3
    v_lshrrev_b32 v5, 5, v3
    s_waitcnt lgkmcnt(0)
    s_cmp_ge_u32 s2, 194
    s_cbranch_scc1 P_zero
    s_cmp_ge_u32 s2, 193
    s_cbranch_scc1 P_flag
    s_cmp_eq_u32 s2, 192
    s_cbranch_scc1 P_kv
    s_cmp_ge_u32 s2, 128
    s_cbranch_scc1 P_x
    s_cmp_ge_u32 s2, 80
    s_cbranch_scc1 P_w2
    s_cmp_ge_u32 s2, 64
    s_cbranch_scc1 P_wo
    s_cmp_ge_u32 s2, 16
    s_cbranch_scc1 P_w1
    v_mul_u32_u24 v6, 4096, v5
    v_lshl_add_u32 v8, v4, 1, v6
    v_add_u32 v9, 1024, v8
    v_add_u32 v10, 2048, v8
    v_add_u32 v11, 3072, v8
    v_add_u32 v12, 8192, v8
    v_add_u32 v13, 9216, v8
    v_add_u32 v14, 10240, v8
    v_add_u32 v15, 11264, v8
    s_sub_u32 s26, s2, 0
    s_and_b32 s27, s26, 7
    s_mul_i32 s27, s27, 2
    s_lshr_b32 s26, s26, 3
    s_add_u32 s26, s26, s27
    s_mul_i32 s27, s20, 65536
    s_lshl_b32 s28, s26, 6
    s_add_u32 s27, s27, s28
    buffer_load_ushort v16, v8, s[44:47], s27 offen
    buffer_load_ushort v17, v9, s[44:47], s27 offen
    buffer_load_ushort v18, v10, s[44:47], s27 offen
    buffer_load_ushort v19, v11, s[44:47], s27 offen
    buffer_load_ushort v20, v12, s[44:47], s27 offen
    buffer_load_ushort v21, v13, s[44:47], s27 offen
    buffer_load_ushort v22, v14, s[44:47], s27 offen
    buffer_load_ushort v23, v15, s[44:47], s27 offen
    s_add_u32 s27, s27, 16384
    buffer_load_ushort v24, v8, s[44:47], s27 offen
    buffer_load_ushort v25, v9, s[44:47], s27 offen
    buffer_load_ushort v26, v10, s[44:47], s27 offen
    buffer_load_ushort v27, v11, s[44:47], s27 offen
    buffer_load_ushort v28, v12, s[44:47], s27 offen
    buffer_load_ushort v29, v13, s[44:47], s27 offen
    buffer_load_ushort v30, v14, s[44:47], s27 offen
    buffer_load_ushort v31, v15, s[44:47], s27 offen
    s_add_u32 s27, s27, 16384
    buffer_load_ushort v32, v8, s[44:47], s27 offen
    buffer_load_ushort v33, v9, s[44:47], s27 offen
    buffer_load_ushort v34, v10, s[44:47], s27 offen
    buffer_load_ushort v35, v11, s[44:47], s27 offen
    buffer_load_ushort v36, v12, s[44:47], s27 offen
    buffer_load_ushort v37, v13, s[44:47], s27 offen
    buffer_load_ushort v38, v14, s[44:47], s27 offen
    buffer_load_ushort v39, v15, s[44:47], s27 offen
    s_add_u32 s27, s27, 16384
    buffer_load_ushort v40, v8, s[44:47], s27 offen
    buffer_load_ushort v41, v9, s[44:47], s27 offen
    buffer_load_ushort v42, v10, s[44:47], s27 offen
    buffer_load_ushort v43, v11, s[44:47], s27 offen
    buffer_load_ushort v44, v12, s[44:47], s27 offen
    buffer_load_ushort v45, v13, s[44:47], s27 offen
    buffer_load_ushort v46, v14, s[44:47], s27 offen
    buffer_load_ushort v47, v15, s[44:47], s27 offen
    s_add_u32 s27, s27, 16384
    s_lshl_b32 s29, s26, 15
    s_add_u32 s29, s29, 0x0
    s_lshl_b32 s30, s26, 7
    s_add_u32 s30, s30, 0x3d0000
    s_branch P_fin
P_w1:
    v_mul_u32_u24 v6, 11008, v5
    v_lshl_add_u32 v8, v4, 1, v6
    v_add_u32 v9, 2752, v8
    v_add_u32 v10, 5504, v8
    v_add_u32 v11, 8256, v8
    v_add_u32 v12, 22016, v8
    v_add_u32 v13, 24768, v8
    v_add_u32 v14, 27520, v8
    v_add_u32 v15, 30272, v8
    s_sub_u32 s26, s2, 16
    s_and_b32 s27, s26, 7
    s_mul_i32 s27, s27, 6
    s_lshr_b32 s26, s26, 3
    s_add_u32 s26, s26, s27
    s_cmp_ge_u32 s26, 43
    s_cbranch_scc1 prep_kernel_exit
    s_mul_i32 s27, s20, 176128
    s_lshl_b32 s28, s26, 6
    s_add_u32 s27, s27, s28
    buffer_load_ushort v16, v8, s[60:63], s27 offen
    buffer_load_ushort v17, v9, s[60:63], s27 offen
    buffer_load_ushort v18, v10, s[60:63], s27 offen
    buffer_load_ushort v19, v11, s[60:63], s27 offen
    buffer_load_ushort v20, v12, s[60:63], s27 offen
    buffer_load_ushort v21, v13, s[60:63], s27 offen
    buffer_load_ushort v22, v14, s[60:63], s27 offen
    buffer_load_ushort v23, v15, s[60:63], s27 offen
    s_add_u32 s27, s27, 44032
    buffer_load_ushort v24, v8, s[60:63], s27 offen
    buffer_load_ushort v25, v9, s[60:63], s27 offen
    buffer_load_ushort v26, v10, s[60:63], s27 offen
    buffer_load_ushort v27, v11, s[60:63], s27 offen
    buffer_load_ushort v28, v12, s[60:63], s27 offen
    buffer_load_ushort v29, v13, s[60:63], s27 offen
    buffer_load_ushort v30, v14, s[60:63], s27 offen
    buffer_load_ushort v31, v15, s[60:63], s27 offen
    s_add_u32 s27, s27, 44032
    buffer_load_ushort v32, v8, s[60:63], s27 offen
    buffer_load_ushort v33, v9, s[60:63], s27 offen
    buffer_load_ushort v34, v10, s[60:63], s27 offen
    buffer_load_ushort v35, v11, s[60:63], s27 offen
    buffer_load_ushort v36, v12, s[60:63], s27 offen
    buffer_load_ushort v37, v13, s[60:63], s27 offen
    buffer_load_ushort v38, v14, s[60:63], s27 offen
    buffer_load_ushort v39, v15, s[60:63], s27 offen
    s_add_u32 s27, s27, 44032
    buffer_load_ushort v40, v8, s[60:63], s27 offen
    buffer_load_ushort v41, v9, s[60:63], s27 offen
    buffer_load_ushort v42, v10, s[60:63], s27 offen
    buffer_load_ushort v43, v11, s[60:63], s27 offen
    buffer_load_ushort v44, v12, s[60:63], s27 offen
    buffer_load_ushort v45, v13, s[60:63], s27 offen
    buffer_load_ushort v46, v14, s[60:63], s27 offen
    buffer_load_ushort v47, v15, s[60:63], s27 offen
    s_add_u32 s27, s27, 44032
    s_lshl_b32 s29, s26, 15
    s_add_u32 s29, s29, 0x100000
    s_lshl_b32 s30, s26, 7
    s_add_u32 s30, s30, 0x3d1000
    s_branch P_fin
P_wo:
    v_mul_u32_u24 v6, 4096, v5
    v_lshl_add_u32 v8, v4, 1, v6
    v_add_u32 v9, 1024, v8
    v_add_u32 v10, 2048, v8
    v_add_u32 v11, 3072, v8
    v_add_u32 v12, 8192, v8
    v_add_u32 v13, 9216, v8
    v_add_u32 v14, 10240, v8
    v_add_u32 v15, 11264, v8
    s_sub_u32 s26, s2, 64
    s_and_b32 s27, s26, 7
    s_mul_i32 s27, s27, 2
    s_lshr_b32 s26, s26, 3
    s_add_u32 s26, s26, s27
    s_mul_i32 s27, s20, 65536
    s_lshl_b32 s28, s26, 6
    s_add_u32 s27, s27, s28
    buffer_load_ushort v16, v8, s[56:59], s27 offen
    buffer_load_ushort v17, v9, s[56:59], s27 offen
    buffer_load_ushort v18, v10, s[56:59], s27 offen
    buffer_load_ushort v19, v11, s[56:59], s27 offen
    buffer_load_ushort v20, v12, s[56:59], s27 offen
    buffer_load_ushort v21, v13, s[56:59], s27 offen
    buffer_load_ushort v22, v14, s[56:59], s27 offen
    buffer_load_ushort v23, v15, s[56:59], s27 offen
    s_add_u32 s27, s27, 16384
    buffer_load_ushort v24, v8, s[56:59], s27 offen
    buffer_load_ushort v25, v9, s[56:59], s27 offen
    buffer_load_ushort v26, v10, s[56:59], s27 offen
    buffer_load_ushort v27, v11, s[56:59], s27 offen
    buffer_load_ushort v28, v12, s[56:59], s27 offen
    buffer_load_ushort v29, v13, s[56:59], s27 offen
    buffer_load_ushort v30, v14, s[56:59], s27 offen
    buffer_load_ushort v31, v15, s[56:59], s27 offen
    s_add_u32 s27, s27, 16384
    buffer_load_ushort v32, v8, s[56:59], s27 offen
    buffer_load_ushort v33, v9, s[56:59], s27 offen
    buffer_load_ushort v34, v10, s[56:59], s27 offen
    buffer_load_ushort v35, v11, s[56:59], s27 offen
    buffer_load_ushort v36, v12, s[56:59], s27 offen
    buffer_load_ushort v37, v13, s[56:59], s27 offen
    buffer_load_ushort v38, v14, s[56:59], s27 offen
    buffer_load_ushort v39, v15, s[56:59], s27 offen
    s_add_u32 s27, s27, 16384
    buffer_load_ushort v40, v8, s[56:59], s27 offen
    buffer_load_ushort v41, v9, s[56:59], s27 offen
    buffer_load_ushort v42, v10, s[56:59], s27 offen
    buffer_load_ushort v43, v11, s[56:59], s27 offen
    buffer_load_ushort v44, v12, s[56:59], s27 offen
    buffer_load_ushort v45, v13, s[56:59], s27 offen
    buffer_load_ushort v46, v14, s[56:59], s27 offen
    buffer_load_ushort v47, v15, s[56:59], s27 offen
    s_add_u32 s27, s27, 16384
    s_lshl_b32 s29, s26, 15
    s_add_u32 s29, s29, 0x80000
    s_mov_b32 s30, -1
    s_branch P_fin
P_kv:
    v_and_b32 v7, 15, v3
    v_mul_u32_u24 v6, 128, v5
    v_lshl_add_u32 v8, v7, 1, v6
    v_add_u32 v9, 32, v8
    v_add_u32 v10, 64, v8
    v_add_u32 v11, 96, v8
    v_add_u32 v12, 256, v8
    v_add_u32 v13, 288, v8
    v_add_u32 v14, 320, v8
    v_add_u32 v15, 352, v8
    s_lshl_b32 s27, s20, 11
    s_mov_b32 s38, 0x0000ffff
    s_mov_b32 s39, 0x0000ffff
    s_mov_b64 exec, s[38:39]
    buffer_load_ushort v16, v8, s[48:51], s27 offen
    buffer_load_ushort v17, v9, s[48:51], s27 offen
    buffer_load_ushort v18, v10, s[48:51], s27 offen
    buffer_load_ushort v19, v11, s[48:51], s27 offen
    buffer_load_ushort v20, v12, s[48:51], s27 offen
    buffer_load_ushort v21, v13, s[48:51], s27 offen
    buffer_load_ushort v22, v14, s[48:51], s27 offen
    buffer_load_ushort v23, v15, s[48:51], s27 offen
    s_not_b64 exec, s[38:39]
    buffer_load_ushort v16, v8, s[52:55], s27 offen
    buffer_load_ushort v17, v9, s[52:55], s27 offen
    buffer_load_ushort v18, v10, s[52:55], s27 offen
    buffer_load_ushort v19, v11, s[52:55], s27 offen
    buffer_load_ushort v20, v12, s[52:55], s27 offen
    buffer_load_ushort v21, v13, s[52:55], s27 offen
    buffer_load_ushort v22, v14, s[52:55], s27 offen
    buffer_load_ushort v23, v15, s[52:55], s27 offen
    s_add_u32 s27, s27, 512
    s_mov_b64 exec, s[38:39]
    buffer_load_ushort v24, v8, s[48:51], s27 offen
    buffer_load_ushort v25, v9, s[48:51], s27 offen
    buffer_load_ushort v26, v10, s[48:51], s27 offen
    buffer_load_ushort v27, v11, s[48:51], s27 offen
    buffer_load_ushort v28, v12, s[48:51], s27 offen
    buffer_load_ushort v29, v13, s[48:51], s27 offen
    buffer_load_ushort v30, v14, s[48:51], s27 offen
    buffer_load_ushort v31, v15, s[48:51], s27 offen
    s_not_b64 exec, s[38:39]
    buffer_load_ushort v24, v8, s[52:55], s27 offen
    buffer_load_ushort v25, v9, s[52:55], s27 offen
    buffer_load_ushort v26, v10, s[52:55], s27 offen
    buffer_load_ushort v27, v11, s[52:55], s27 offen
    buffer_load_ushort v28, v12, s[52:55], s27 offen
    buffer_load_ushort v29, v13, s[52:55], s27 offen
    buffer_load_ushort v30, v14, s[52:55], s27 offen
    buffer_load_ushort v31, v15, s[52:55], s27 offen
    s_waitcnt vmcnt(0)
    s_add_u32 s27, s27, 512
    s_mov_b64 exec, s[38:39]
    buffer_load_ushort v32, v8, s[48:51], s27 offen
    buffer_load_ushort v33, v9, s[48:51], s27 offen
    buffer_load_ushort v34, v10, s[48:51], s27 offen
    buffer_load_ushort v35, v11, s[48:51], s27 offen
    buffer_load_ushort v36, v12, s[48:51], s27 offen
    buffer_load_ushort v37, v13, s[48:51], s27 offen
    buffer_load_ushort v38, v14, s[48:51], s27 offen
    buffer_load_ushort v39, v15, s[48:51], s27 offen
    s_not_b64 exec, s[38:39]
    buffer_load_ushort v32, v8, s[52:55], s27 offen
    buffer_load_ushort v33, v9, s[52:55], s27 offen
    buffer_load_ushort v34, v10, s[52:55], s27 offen
    buffer_load_ushort v35, v11, s[52:55], s27 offen
    buffer_load_ushort v36, v12, s[52:55], s27 offen
    buffer_load_ushort v37, v13, s[52:55], s27 offen
    buffer_load_ushort v38, v14, s[52:55], s27 offen
    buffer_load_ushort v39, v15, s[52:55], s27 offen
    s_add_u32 s27, s27, 512
    s_mov_b64 exec, s[38:39]
    buffer_load_ushort v40, v8, s[48:51], s27 offen
    buffer_load_ushort v41, v9, s[48:51], s27 offen
    buffer_load_ushort v42, v10, s[48:51], s27 offen
    buffer_load_ushort v43, v11, s[48:51], s27 offen
    buffer_load_ushort v44, v12, s[48:51], s27 offen
    buffer_load_ushort v45, v13, s[48:51], s27 offen
    buffer_load_ushort v46, v14, s[48:51], s27 offen
    buffer_load_ushort v47, v15, s[48:51], s27 offen
    s_not_b64 exec, s[38:39]
    buffer_load_ushort v40, v8, s[52:55], s27 offen
    buffer_load_ushort v41, v9, s[52:55], s27 offen
    buffer_load_ushort v42, v10, s[52:55], s27 offen
    buffer_load_ushort v43, v11, s[52:55], s27 offen
    buffer_load_ushort v44, v12, s[52:55], s27 offen
    buffer_load_ushort v45, v13, s[52:55], s27 offen
    buffer_load_ushort v46, v14, s[52:55], s27 offen
    buffer_load_ushort v47, v15, s[52:55], s27 offen
    s_add_u32 s27, s27, 512
    s_mov_b64 exec, -1
    s_mov_b32 s29, 0x3c0000
    s_mov_b32 s30, 0x3d0800
    s_branch P_fin
P_w2:
    v_mul_u32_u24 v6, 4096, v5
    v_lshl_add_u32 v8, v4, 1, v6
    v_add_u32 v9, 1024, v8
    v_add_u32 v10, 2048, v8
    v_add_u32 v11, 3072, v8
    v_add_u32 v12, 8192, v8
    v_add_u32 v13, 9216, v8
    v_add_u32 v14, 10240, v8
    v_add_u32 v15, 11264, v8
    s_sub_u32 s26, s2, 80
    s_and_b32 s28, s26, 7
    s_mul_i32 s28, s28, 172
    s_lshr_b32 s26, s26, 3
    s_lshl_b32 s26, s26, 5
    s_add_u32 s29, s26, s28
    s_lshl_b32 s29, s29, 10
    s_add_u32 s29, s29, 0x260000
    s_lshl_b32 s27, s20, 2
    s_add_u32 s26, s26, s27
    s_cmp_ge_u32 s26, 172
    s_cbranch_scc1 prep_kernel_exit
    s_add_u32 s26, s26, s28
    s_mul_i32 s27, s26, 12193
    s_lshr_b32 s27, s27, 20
    s_mul_i32 s28, s27, 86
    s_sub_u32 s28, s26, s28
    s_lshl_b32 s28, s28, 14
    s_lshl_b32 s27, s27, 6
    s_add_u32 s27, s27, s28
    buffer_load_ushort v16, v8, s[64:67], s27 offen
    buffer_load_ushort v17, v9, s[64:67], s27 offen
    buffer_load_ushort v18, v10, s[64:67], s27 offen
    buffer_load_ushort v19, v11, s[64:67], s27 offen
    buffer_load_ushort v20, v12, s[64:67], s27 offen
    buffer_load_ushort v21, v13, s[64:67], s27 offen
    buffer_load_ushort v22, v14, s[64:67], s27 offen
    buffer_load_ushort v23, v15, s[64:67], s27 offen
    s_add_u32 s26, s26, 1
    s_mul_i32 s27, s26, 12193
    s_lshr_b32 s27, s27, 20
    s_mul_i32 s28, s27, 86
    s_sub_u32 s28, s26, s28
    s_lshl_b32 s28, s28, 14
    s_lshl_b32 s27, s27, 6
    s_add_u32 s27, s27, s28
    buffer_load_ushort v24, v8, s[64:67], s27 offen
    buffer_load_ushort v25, v9, s[64:67], s27 offen
    buffer_load_ushort v26, v10, s[64:67], s27 offen
    buffer_load_ushort v27, v11, s[64:67], s27 offen
    buffer_load_ushort v28, v12, s[64:67], s27 offen
    buffer_load_ushort v29, v13, s[64:67], s27 offen
    buffer_load_ushort v30, v14, s[64:67], s27 offen
    buffer_load_ushort v31, v15, s[64:67], s27 offen
    s_add_u32 s26, s26, 1
    s_mul_i32 s27, s26, 12193
    s_lshr_b32 s27, s27, 20
    s_mul_i32 s28, s27, 86
    s_sub_u32 s28, s26, s28
    s_lshl_b32 s28, s28, 14
    s_lshl_b32 s27, s27, 6
    s_add_u32 s27, s27, s28
    buffer_load_ushort v32, v8, s[64:67], s27 offen
    buffer_load_ushort v33, v9, s[64:67], s27 offen
    buffer_load_ushort v34, v10, s[64:67], s27 offen
    buffer_load_ushort v35, v11, s[64:67], s27 offen
    buffer_load_ushort v36, v12, s[64:67], s27 offen
    buffer_load_ushort v37, v13, s[64:67], s27 offen
    buffer_load_ushort v38, v14, s[64:67], s27 offen
    buffer_load_ushort v39, v15, s[64:67], s27 offen
    s_add_u32 s26, s26, 1
    s_mul_i32 s27, s26, 12193
    s_lshr_b32 s27, s27, 20
    s_mul_i32 s28, s27, 86
    s_sub_u32 s28, s26, s28
    s_lshl_b32 s28, s28, 14
    s_lshl_b32 s27, s27, 6
    s_add_u32 s27, s27, s28
    buffer_load_ushort v40, v8, s[64:67], s27 offen
    buffer_load_ushort v41, v9, s[64:67], s27 offen
    buffer_load_ushort v42, v10, s[64:67], s27 offen
    buffer_load_ushort v43, v11, s[64:67], s27 offen
    buffer_load_ushort v44, v12, s[64:67], s27 offen
    buffer_load_ushort v45, v13, s[64:67], s27 offen
    buffer_load_ushort v46, v14, s[64:67], s27 offen
    buffer_load_ushort v47, v15, s[64:67], s27 offen
    s_add_u32 s26, s26, 1
    s_mov_b32 s30, -1
P_fin:
    s_lshl_b32 s26, s20, 12
    s_add_u32 s29, s29, s26
    v_mov_b32 v6, 0
    s_waitcnt vmcnt(24)
    v_lshl_or_b32 v48, v17, 16, v16
    v_lshl_or_b32 v49, v19, 16, v18
    v_lshl_or_b32 v50, v21, 16, v20
    v_lshl_or_b32 v51, v23, 16, v22
    buffer_store_dwordx4 v[48:51], v0, s[4:7], s29 offen offset:0 sc1
    s_waitcnt vmcnt(17)
    v_lshl_or_b32 v52, v25, 16, v24
    v_lshl_or_b32 v53, v27, 16, v26
    v_lshl_or_b32 v54, v29, 16, v28
    v_lshl_or_b32 v55, v31, 16, v30
    buffer_store_dwordx4 v[52:55], v0, s[4:7], s29 offen offset:1024 sc1
    s_waitcnt vmcnt(10)
    v_lshl_or_b32 v56, v33, 16, v32
    v_lshl_or_b32 v57, v35, 16, v34
    v_lshl_or_b32 v58, v37, 16, v36
    v_lshl_or_b32 v59, v39, 16, v38
    buffer_store_dwordx4 v[56:59], v0, s[4:7], s29 offen offset:2048 sc1
    s_waitcnt vmcnt(3)
    v_lshl_or_b32 v60, v41, 16, v40
    v_lshl_or_b32 v61, v43, 16, v42
    v_lshl_or_b32 v62, v45, 16, v44
    v_lshl_or_b32 v63, v47, 16, v46
    buffer_store_dwordx4 v[60:63], v0, s[4:7], s29 offen offset:3072 sc1
    s_cmp_eq_u32 s30, -1
    s_cbranch_scc1 prep_kernel_exit
    v_dot2_f32_bf16 v6, v48, s35, v6
    v_dot2_f32_bf16 v6, v49, s35, v6
    v_dot2_f32_bf16 v6, v50, s35, v6
    v_dot2_f32_bf16 v6, v51, s35, v6
    v_dot2_f32_bf16 v6, v52, s35, v6
    v_dot2_f32_bf16 v6, v53, s35, v6
    v_dot2_f32_bf16 v6, v54, s35, v6
    v_dot2_f32_bf16 v6, v55, s35, v6
    v_dot2_f32_bf16 v6, v56, s35, v6
    v_dot2_f32_bf16 v6, v57, s35, v6
    v_dot2_f32_bf16 v6, v58, s35, v6
    v_dot2_f32_bf16 v6, v59, s35, v6
    v_dot2_f32_bf16 v6, v60, s35, v6
    v_dot2_f32_bf16 v6, v61, s35, v6
    v_dot2_f32_bf16 v6, v62, s35, v6
    v_dot2_f32_bf16 v6, v63, s35, v6
    s_nop 2
    v_mov_b32 v7, v6
    s_nop 1
    v_permlane32_swap_b32 v6, v7
    s_nop 1
    v_add_f32 v6, v6, v7
    s_lshl_b32 s26, s20, 8
    v_lshlrev_b32 v7, 2, v3
    v_add_u32 v8, s26, v7
    ds_write_b32 v8, v6
    s_waitcnt lgkmcnt(0)
    s_barrier
    s_cmp_lg_u32 s20, 0
    s_cbranch_scc1 prep_kernel_exit
    ds_read_b32 v16, v7 offset:0
    ds_read_b32 v17, v7 offset:256
    ds_read_b32 v18, v7 offset:512
    ds_read_b32 v19, v7 offset:768
    ds_read_b32 v20, v7 offset:1024
    ds_read_b32 v21, v7 offset:1280
    ds_read_b32 v22, v7 offset:1536
    ds_read_b32 v23, v7 offset:1792
    s_waitcnt lgkmcnt(0)
    v_add_f32 v16, v16, v17
    v_add_f32 v16, v16, v18
    v_add_f32 v16, v16, v19
    v_add_f32 v16, v16, v20
    v_add_f32 v16, v16, v21
    v_add_f32 v16, v16, v22
    v_add_f32 v16, v16, v23
    v_lshlrev_b32 v7, 2, v4
    buffer_store_dword v16, v7, s[4:7], s30 offen sc1
    s_endpgm
P_x:
    s_and_b32 s10, s2, 7
    s_lshl_b32 s10, s10, 1
    s_bfe_u32 s26, s2, 0x10003
    s_add_u32 s10, s10, s26
    s_and_b32 s26, s2, 0x30
    s_add_u32 s10, s10, s26
    s_mov_b32 s26, s10
    v_lshlrev_b32 v6, 10, v4
    v_lshl_add_u32 v6, v5, 3, v6
    s_lshl_b32 s26, s26, 15
    s_lshl_b32 s27, s20, 7
    s_add_u32 s27, s27, s26
    buffer_load_dwordx2 v[16:17], v6, s[40:43], s27 offen offset:0
    buffer_load_dwordx2 v[18:19], v6, s[40:43], s27 offen offset:16
    buffer_load_dwordx2 v[20:21], v6, s[40:43], s27 offen offset:32
    buffer_load_dwordx2 v[22:23], v6, s[40:43], s27 offen offset:48
    buffer_load_dwordx2 v[24:25], v6, s[40:43], s27 offen offset:64
    buffer_load_dwordx2 v[26:27], v6, s[40:43], s27 offen offset:80
    buffer_load_dwordx2 v[28:29], v6, s[40:43], s27 offen offset:96
    buffer_load_dwordx2 v[30:31], v6, s[40:43], s27 offen offset:112
    s_lshl_b32 s27, s20, 12
    s_add_u32 s26, s26, s27
    s_add_u32 s26, s26, 0x400000
    s_waitcnt vmcnt(0)
    buffer_store_dwordx4 v[16:19], v0, s[4:7], s26 offen offset:0 sc1
    buffer_store_dwordx4 v[20:23], v0, s[4:7], s26 offen offset:1024 sc1
    buffer_store_dwordx4 v[24:27], v0, s[4:7], s26 offen offset:2048 sc1
    buffer_store_dwordx4 v[28:31], v0, s[4:7], s26 offen offset:3072 sc1
    v_mov_b32 v32, 0
    v_mov_b32 v33, 0
    v_mov_b32 v34, 0
    v_mov_b32 v35, 0
    v_dot2_f32_bf16 v32, v16, s35, v32
    v_dot2_f32_bf16 v33, v16, v16, v33
    v_dot2_f32_bf16 v32, v17, s35, v32
    v_dot2_f32_bf16 v33, v17, v17, v33
    v_dot2_f32_bf16 v32, v18, s35, v32
    v_dot2_f32_bf16 v33, v18, v18, v33
    v_dot2_f32_bf16 v32, v19, s35, v32
    v_dot2_f32_bf16 v33, v19, v19, v33
    v_dot2_f32_bf16 v32, v20, s35, v32
    v_dot2_f32_bf16 v33, v20, v20, v33
    v_dot2_f32_bf16 v32, v21, s35, v32
    v_dot2_f32_bf16 v33, v21, v21, v33
    v_dot2_f32_bf16 v32, v22, s35, v32
    v_dot2_f32_bf16 v33, v22, v22, v33
    v_dot2_f32_bf16 v32, v23, s35, v32
    v_dot2_f32_bf16 v33, v23, v23, v33
    v_dot2_f32_bf16 v32, v24, s35, v32
    v_dot2_f32_bf16 v33, v24, v24, v33
    v_dot2_f32_bf16 v32, v25, s35, v32
    v_dot2_f32_bf16 v33, v25, v25, v33
    v_dot2_f32_bf16 v32, v26, s35, v32
    v_dot2_f32_bf16 v33, v26, v26, v33
    v_dot2_f32_bf16 v32, v27, s35, v32
    v_dot2_f32_bf16 v33, v27, v27, v33
    v_dot2_f32_bf16 v32, v28, s35, v32
    v_dot2_f32_bf16 v33, v28, v28, v33
    v_dot2_f32_bf16 v32, v29, s35, v32
    v_dot2_f32_bf16 v33, v29, v29, v33
    v_dot2_f32_bf16 v32, v30, s35, v32
    v_dot2_f32_bf16 v33, v30, v30, v33
    v_dot2_f32_bf16 v32, v31, s35, v32
    v_dot2_f32_bf16 v33, v31, v31, v33
    s_mov_b32 s26, s10
    s_lshr_b32 s27, s26, 1
    s_lshl_b32 s27, s27, 14
    s_and_b32 s26, s26, 1
    s_lshl_b32 s26, s26, 10
    s_add_u32 s26, s26, s27
    s_lshl_b32 s27, s20, 11
    s_add_u32 s26, s26, s27
    s_add_u32 s26, s26, 0x1800000
    v_or_b32 v33, 0x80000000, v33
    v_lshl_add_u32 v6, v4, 5, v1
    buffer_store_dwordx4 v[32:35], v6, s[4:7], s26 offen sc1
    s_endpgm
P_zero:
    s_cmp_ge_u32 s2, 205
    s_cselect_b32 s28, -1, 0
    s_mov_b32 s29, 0x1a80000
    s_cselect_b32 s29, 0xbd4000, s29
    v_mov_b32 v16, s28
    v_mov_b32 v17, s28
    v_mov_b32 v18, s28
    v_mov_b32 v19, s28
    s_sub_u32 s26, s2, 194
    s_lshl_b32 s26, s26, 14
    s_lshl_b32 s27, s20, 11
    s_add_u32 s26, s26, s27
    s_add_u32 s26, s26, s29
    buffer_store_dwordx4 v[16:19], v0, s[4:7], s26 offen offset:0 sc1
    buffer_store_dwordx4 v[16:19], v0, s[4:7], s26 offen offset:1024 sc1
    s_endpgm
P_flag:
    v_lshl_add_u32 v6, v2, 6, v3
    v_lshlrev_b32 v7, 1, v6
    v_lshlrev_b32 v6, 2, v6
    buffer_load_ushort v20, v7, s[12:15], 0 offen offset:0
    buffer_load_ushort v21, v7, s[12:15], 0 offen offset:1024
    buffer_load_ushort v22, v7, s[12:15], 0 offen offset:2048
    s_mov_b32 s26, 0x3d3000
    s_mov_b32 s27, 0x3d4000
    s_waitcnt vmcnt(0)
    v_lshlrev_b32 v20, 16, v20
    v_lshlrev_b32 v21, 16, v21
    v_lshlrev_b32 v22, 16, v22
    buffer_store_dword v20, v6, s[4:7], s26 offen sc1
    buffer_store_dword v21, v6, s[4:7], s26 offen offset:2048 sc1
    buffer_store_dword v22, v6, s[4:7], s27 offen sc1
prep_kernel_exit:
    s_endpgm
.globl main_kernel
.p2align 8
.type main_kernel,@function
main_kernel:
    s_cmp_ge_u32 s2, 256
    s_cbranch_scc1 main_kernel_exit
    s_load_dwordx2 s[4:5], s[0:1], 96
    s_load_dwordx2 s[8:9], s[0:1], 80
    s_load_dwordx2 s[16:17], s[0:1], 72
    v_lshrrev_b32 v2, 6, v0
    v_and_b32 v3, 63, v0
    v_readfirstlane_b32 s20, v2
    v_lshlrev_b32 v0, 4, v3
    v_lshrrev_b32 v1, 5, v3
    v_lshlrev_b32 v1, 4, v1
    s_mov_b32 s35, 0x3f803f80
    s_mov_b32 s6, 0x10000000
    s_mov_b32 s7, 0x00020000
    s_mov_b32 s10, 0x200000
    s_mov_b32 s11, 0x00020000
    s_mov_b32 s18, 0x400
    s_mov_b32 s19, 0x00020000
    s_lshr_b32 s26, s2, 3
    s_and_b32 s21, s26, 7
    s_lshr_b32 s26, s2, 6
    s_lshl_b32 s26, s26, 3
    s_and_b32 s22, s2, 7
    s_add_u32 s22, s22, s26
    s_and_b32 s24, s20, 1
    s_lshr_b32 s23, s20, 1
    s_and_b32 s23, s23, 1
    s_lshr_b32 s25, s20, 2
    s_lshl_b32 s26, s22, 1
    s_add_u32 s26, s26, s23
    s_lshl_b32 s26, s26, 5
    s_lshl_b32 s27, s21, 2
    s_add_u32 s26, s26, s27
    s_lshl_b32 s27, s24, 1
    s_add_u32 s26, s26, s27
    s_add_u32 s26, s26, s25
    s_lshl_b32 s34, s26, 10
    s_mul_i32 s32, s21, 5
    s_min_u32 s30, s21, 3
    s_add_u32 s32, s32, s30
    s_mul_i32 s33, s20, 5
    s_min_u32 s30, s20, 3
    s_add_u32 s33, s33, s30
    s_add_u32 s26, s23, 4
    s_cmp_lt_u32 s20, 4
    s_cselect_b32 s26, s20, s26
    s_add_u32 s32, s32, s26
    s_lshl_b32 s26, s22, 14
    s_lshl_b32 s27, s21, 11
    s_add_u32 s26, s26, s27
    s_lshl_b32 s27, s23, 10
    s_add_u32 s26, s26, s27
    s_lshr_b32 s27, s34, 7
    s_and_b32 s27, s27, 24
    s_add_u32 s31, s26, s27
    s_lshr_b32 s26, s22, 3
    s_lshr_b32 s27, s20, 1
    s_add_u32 s26, s26, s27
    s_and_b32 s26, s26, 3
    s_lshl_b32 s26, s26, 15
    s_lshl_b32 s27, s24, 11
    s_add_u32 s54, s26, s27
    v_lshlrev_b32 v91, 1, v0
    s_mov_b32 s60, 512
    s_lshl_b32 s26, s22, 14
    s_lshl_b32 s27, s20, 11
    s_add_u32 s26, s26, s27
    s_add_u32 s26, s26, 0x1800000
    v_lshlrev_b32 v3, 1, v0
    s_waitcnt lgkmcnt(0)
    buffer_load_dwordx4 v[16:19], v3, s[4:7], s26 offen offset:0
    buffer_load_dwordx4 v[20:23], v3, s[4:7], s26 offen offset:16
    s_and_b32 s57, s22, 7
    s_lshl_b32 s57, s57, 12
    s_add_u32 s57, s57, s54
    s_add_u32 s57, s57, 0xc20000
    buffer_load_dword v90, v91, s[4:7], s57 offen
    s_lshl_b32 s27, s20, 9
    s_add_u32 m0, s27, 0x27000
    v_lshrrev_b32 v4, 2, v0
    v_and_b32 v5, 0x7c, v4
    v_mad_u32_u24 v5, v1, s60, v5
    s_lshl_b32 s27, s32, 7
    s_add_u32 s27, s27, 0x3d1000
    buffer_load_dword v5, s[4:7], s27 offen lds
    s_lshr_b32 s27, s34, 4
    s_and_b32 s27, s27, 0x7ff
    s_add_u32 s27, s27, 0x3cff00
    buffer_load_dword v4, s[4:7], s27 offen offset:256 lds
    s_lshl_b32 s26, s22, 16
    s_lshl_b32 s27, s20, 12
    s_add_u32 s26, s26, s27
    s_add_u32 s26, s26, 0x400000
    s_add_u32 s27, s27, 0x0
    s_mov_b32 m0, s27
    s_nop 0
    buffer_load_dwordx4 v0, s[4:7], s26 offen offset:0 lds
    buffer_load_dwordx4 v0, s[4:7], s26 offen offset:1024 lds
    buffer_load_dwordx4 v0, s[4:7], s26 offen offset:2048 lds
    buffer_load_dwordx4 v0, s[4:7], s26 offen offset:3072 lds
    s_lshl_b32 s26, s22, 16
    s_lshl_b32 s27, s20, 12
    s_add_u32 s26, s26, s27
    s_add_u32 s26, s26, 0x408000
    s_add_u32 s27, s27, 0x8000
    s_mov_b32 m0, s27
    s_nop 0
    buffer_load_dwordx4 v0, s[4:7], s26 offen offset:0 lds
    buffer_load_dwordx4 v0, s[4:7], s26 offen offset:1024 lds
    buffer_load_dwordx4 v0, s[4:7], s26 offen offset:2048 lds
    buffer_load_dwordx4 v0, s[4:7], s26 offen offset:3072 lds
    s_cmp_gt_u32 s21, 1
    s_cbranch_scc1 L_kvp_1
    s_lshl_b32 s44, s20, 12
    s_add_u32 s44, s44, 0x3c0000
    buffer_load_dwordx4 v[168:171], v0, s[4:7], s44 offen offset:0
    buffer_load_dwordx4 v[172:175], v0, s[4:7], s44 offen offset:1024
    buffer_load_dwordx4 v[176:179], v0, s[4:7], s44 offen offset:2048
    buffer_load_dwordx4 v[180:183], v0, s[4:7], s44 offen offset:3072
    s_lshl_b32 s44, s24, 6
    s_add_u32 s44, s44, 0x3d0800
    buffer_load_dwordx4 v[184:187], v1, s[4:7], s44 offen
    buffer_load_dwordx4 v[188:191], v1, s[4:7], s44 offen offset:32
    s_lshl_b32 s44, s21, 1
    s_add_u32 s44, s44, s24
    s_lshl_b32 s44, s44, 15
    s_lshr_b32 s45, s20, 1
    s_lshl_b32 s45, s45, 13
    s_add_u32 s44, s44, s45
    s_add_u32 s44, s44, 0x0
    buffer_load_dwordx4 v[96:99], v0, s[4:7], s44 offen offset:0
    buffer_load_dwordx4 v[100:103], v0, s[4:7], s44 offen offset:1024
    buffer_load_dwordx4 v[104:107], v0, s[4:7], s44 offen offset:2048
    buffer_load_dwordx4 v[108:111], v0, s[4:7], s44 offen offset:3072
    s_add_u32 s44, s44, 4096
    buffer_load_dwordx4 v[112:115], v0, s[4:7], s44 offen offset:0
    buffer_load_dwordx4 v[116:119], v0, s[4:7], s44 offen offset:1024
    buffer_load_dwordx4 v[120:123], v0, s[4:7], s44 offen offset:2048
    buffer_load_dwordx4 v[124:127], v0, s[4:7], s44 offen offset:3072
    s_getreg_b32 s46, hwreg(HW_REG_XCC_ID, 0, 4)
    s_add_u32 s46, s46, 1
    s_lshl_b32 s26, s22, 5
    s_lshl_b32 s27, s21, 2
    s_add_u32 s26, s26, s27
    s_add_u32 s26, s26, 0x1a88000
    v_mov_b32 v6, s46
    s_add_u32 s27, s34, 0x400000
    buffer_load_dwordx4 v[12:15], v0, s[4:7], s27 offen
    s_mov_b64 exec, 1
    buffer_store_dword v6, off, s[4:7], s26 sc1
    s_mov_b64 exec, 0xffffffff
    v_mov_b32 v4, 0
    v_mov_b32 v5, 0
    s_add_u32 s26, s31, 0x1900000
    buffer_store_dwordx2 v[4:5], v3, s[4:7], s26 offen sc1
    s_add_u32 s26, s31, 0x1980000
    buffer_store_dwordx2 v[4:5], v3, s[4:7], s26 offen sc1
    s_add_u32 s26, s31, 0x1a00000
    buffer_store_dwordx2 v[4:5], v3, s[4:7], s26 offen sc1
    s_mov_b64 exec, -1
    s_waitcnt vmcnt(19)
    s_branch L_kvq_2
L_kvp_1:
    s_lshl_b32 s44, s21, 1
    s_add_u32 s44, s44, s24
    s_lshl_b32 s44, s44, 15
    s_lshr_b32 s45, s20, 1
    s_lshl_b32 s45, s45, 13
    s_add_u32 s44, s44, s45
    s_add_u32 s44, s44, 0x0
    buffer_load_dwordx4 v[96:99], v0, s[4:7], s44 offen offset:0
    buffer_load_dwordx4 v[100:103], v0, s[4:7], s44 offen offset:1024
    buffer_load_dwordx4 v[104:107], v0, s[4:7], s44 offen offset:2048
    buffer_load_dwordx4 v[108:111], v0, s[4:7], s44 offen offset:3072
    s_add_u32 s44, s44, 4096
    buffer_load_dwordx4 v[112:115], v0, s[4:7], s44 offen offset:0
    buffer_load_dwordx4 v[116:119], v0, s[4:7], s44 offen offset:1024
    buffer_load_dwordx4 v[120:123], v0, s[4:7], s44 offen offset:2048
    buffer_load_dwordx4 v[124:127], v0, s[4:7], s44 offen offset:3072
    s_getreg_b32 s46, hwreg(HW_REG_XCC_ID, 0, 4)
    s_add_u32 s46, s46, 1
    s_lshl_b32 s26, s22, 5
    s_lshl_b32 s27, s21, 2
    s_add_u32 s26, s26, s27
    s_add_u32 s26, s26, 0x1a88000
    v_mov_b32 v6, s46
    s_add_u32 s27, s34, 0x400000
    buffer_load_dwordx4 v[12:15], v0, s[4:7], s27 offen
    s_mov_b64 exec, 1
    buffer_store_dword v6, off, s[4:7], s26 sc1
    s_mov_b64 exec, 0xffffffff
    v_mov_b32 v4, 0
    v_mov_b32 v5, 0
    s_add_u32 s26, s31, 0x1900000
    buffer_store_dwordx2 v[4:5], v3, s[4:7], s26 offen sc1
    s_add_u32 s26, s31, 0x1980000
    buffer_store_dwordx2 v[4:5], v3, s[4:7], s26 offen sc1
    s_add_u32 s26, s31, 0x1a00000
    buffer_store_dwordx2 v[4:5], v3, s[4:7], s26 offen sc1
    s_mov_b64 exec, -1
    s_waitcnt vmcnt(13)
L_kvq_2:
    v_pk_add_f32 v[16:17], v[16:17], v[18:19]
    v_pk_add_f32 v[20:21], v[20:21], v[22:23]
    s_lshl_b32 s28, s20, 9
    s_add_u32 s28, s28, 0x24000
    v_lshrrev_b32 v3, 1, v0
    v_add_u32 v3, s28, v3
    v_pk_add_f32 v[16:17], v[16:17], v[20:21]
    ds_write_b64 v3, v[16:17]
    s_waitcnt vmcnt(63) lgkmcnt(0)
    s_barrier
    v_and_b32 v3, 0x1f0, v0
    v_lshrrev_b32 v3, 1, v3
    s_lshl_b32 s28, s23, 8
    s_add_u32 s28, s28, 0x24000
    v_add_u32 v3, s28, v3
    ds_read2st64_b64 v[80:83], v3 offset0:0 offset1:1
    ds_read2st64_b64 v[84:87], v3 offset0:2 offset1:3
    ds_read2st64_b64 v[88:91], v3 offset0:4 offset1:5
    ds_read2st64_b64 v[92:95], v3 offset0:6 offset1:7
    s_mov_b32 s47, 0
    s_mov_b32 s49, 0
    s_cmp_gt_u32 s21, 1
    s_cbranch_scc1 L_kvd_3
    s_lshl_b32 s26, s21, 15
    s_lshl_b32 s27, s20, 12
    s_add_u32 s26, s26, s27
    v_add_u32 v2, s26, v0
    ds_read_b128 v[32:35], v2 offset:0
    ds_read_b128 v[36:39], v2 offset:1024
    ds_read_b128 v[40:43], v2 offset:2048
    ds_read_b128 v[44:47], v2 offset:3072
    s_add_u32 s27, s27, 0x10000
    v_add_u32 v3, s27, v0
    s_waitcnt vmcnt(13)
    s_waitcnt lgkmcnt(3)
    v_mfma_f32_32x32x16_bf16 v[64:79], v[168:171], v[32:35], 0
    s_waitcnt lgkmcnt(2)
    v_mfma_f32_32x32x16_bf16 v[64:79], v[172:175], v[36:39], v[64:79]
    s_waitcnt lgkmcnt(1)
    v_mfma_f32_32x32x16_bf16 v[64:79], v[176:179], v[40:43], v[64:79]
    s_waitcnt lgkmcnt(0)
    v_mfma_f32_32x32x16_bf16 v[64:79], v[180:183], v[44:47], v[64:79]
    s_nop 15
    ds_write_b128 v3, v[64:67] offset:0
    ds_write_b128 v3, v[68:71] offset:1024
    ds_write_b128 v3, v[72:75] offset:2048
    ds_write_b128 v3, v[76:79] offset:3072
    s_waitcnt lgkmcnt(0)
    s_barrier
    s_cmp_lg_u32 s23, s21
    s_cbranch_scc1 L_kvd_3
    s_cmp_lg_u32 s25, 0
    s_cbranch_scc1 L_kvd_3
    s_lshl_b32 s26, s24, 11
    s_add_u32 s26, s26, 0x10000
    v_add_u32 v2, s26, v0
    ds_read_b128 v[16:19], v2 offset:0
    ds_read_b128 v[20:23], v2 offset:1024
    ds_read_b128 v[24:27], v2 offset:4096
    ds_read_b128 v[28:31], v2 offset:5120
    ds_read_b128 v[32:35], v2 offset:8192
    ds_read_b128 v[36:39], v2 offset:9216
    ds_read_b128 v[40:43], v2 offset:12288
    ds_read_b128 v[44:47], v2 offset:13312
    s_waitcnt lgkmcnt(4)
    ds_read_b128 v[48:51], v2 offset:16384
    ds_read_b128 v[52:55], v2 offset:17408
    ds_read_b128 v[56:59], v2 offset:20480
    ds_read_b128 v[60:63], v2 offset:21504
    ds_read_b128 v[64:67], v2 offset:24576
    ds_read_b128 v[68:71], v2 offset:25600
    ds_read_b128 v[72:75], v2 offset:28672
    ds_read_b128 v[76:79], v2 offset:29696
    v_mov_b32 v192, v80
    v_mov_b32 v193, v81
    v_mov_b32 v194, v82
    v_mov_b32 v195, v83
    v_mov_b32 v196, v84
    v_mov_b32 v197, v85
    v_mov_b32 v198, v86
    v_mov_b32 v199, v87
    v_pk_add_f32 v[192:193], v[192:193], v[88:89]
    v_pk_add_f32 v[194:195], v[194:195], v[90:91]
    v_pk_add_f32 v[196:197], v[196:197], v[92:93]
    v_pk_add_f32 v[198:199], v[198:199], v[94:95]
    v_pk_add_f32 v[192:193], v[192:193], v[196:197]
    v_pk_add_f32 v[194:195], v[194:195], v[198:199]
    v_pk_add_f32 v[8:9], v[192:193], v[194:195]
    v_mul_f32 v8, 0xbb000000, v8
    v_mul_f32 v9, 0xbb000000, v9
    v_fma_f32 v9, -v8, v8, v9
    v_max_f32 v9, 0, v9
    v_add_f32 v9, 0x3727c5ac, v9
    v_rsq_f32 v9, v9
    s_nop 0
    v_pk_add_f32 v[16:17], v[16:17], v[24:25]
    v_pk_add_f32 v[18:19], v[18:19], v[26:27]
    v_pk_add_f32 v[20:21], v[20:21], v[28:29]
    v_pk_add_f32 v[22:23], v[22:23], v[30:31]
    s_waitcnt lgkmcnt(10)
    v_pk_add_f32 v[16:17], v[16:17], v[32:33]
    v_pk_add_f32 v[18:19], v[18:19], v[34:35]
    v_pk_add_f32 v[20:21], v[20:21], v[36:37]
    v_pk_add_f32 v[22:23], v[22:23], v[38:39]
    s_waitcnt lgkmcnt(8)
    v_pk_add_f32 v[16:17], v[16:17], v[40:41]
    v_pk_add_f32 v[18:19], v[18:19], v[42:43]
    v_pk_add_f32 v[20:21], v[20:21], v[44:45]
    v_pk_add_f32 v[22:23], v[22:23], v[46:47]
    s_waitcnt lgkmcnt(6)
    v_pk_add_f32 v[16:17], v[16:17], v[48:49]
    v_pk_add_f32 v[18:19], v[18:19], v[50:51]
    v_pk_add_f32 v[20:21], v[20:21], v[52:53]
    v_pk_add_f32 v[22:23], v[22:23], v[54:55]
    s_waitcnt lgkmcnt(4)
    v_pk_add_f32 v[16:17], v[16:17], v[56:57]
    v_pk_add_f32 v[18:19], v[18:19], v[58:59]
    v_pk_add_f32 v[20:21], v[20:21], v[60:61]
    v_pk_add_f32 v[22:23], v[22:23], v[62:63]
    s_waitcnt lgkmcnt(2)
    v_pk_add_f32 v[16:17], v[16:17], v[64:65]
    v_pk_add_f32 v[18:19], v[18:19], v[66:67]
    v_pk_add_f32 v[20:21], v[20:21], v[68:69]
    v_pk_add_f32 v[22:23], v[22:23], v[70:71]
    s_waitcnt lgkmcnt(0)
    v_pk_add_f32 v[16:17], v[16:17], v[72:73]
    v_pk_add_f32 v[18:19], v[18:19], v[74:75]
    v_pk_add_f32 v[20:21], v[20:21], v[76:77]
    v_pk_add_f32 v[22:23], v[22:23], v[78:79]
    v_fma_f32 v16, v8, v184, v16
    v_fma_f32 v17, v8, v185, v17
    v_fma_f32 v18, v8, v186, v18
    v_fma_f32 v19, v8, v187, v19
    v_fma_f32 v20, v8, v188, v20
    v_fma_f32 v21, v8, v189, v21
    v_fma_f32 v22, v8, v190, v22
    v_fma_f32 v23, v8, v191, v23
    v_mul_f32 v16, v9, v16
    v_mul_f32 v17, v9, v17
    v_mul_f32 v18, v9, v18
    v_mul_f32 v19, v9, v19
    v_mul_f32 v20, v9, v20
    v_mul_f32 v21, v9, v21
    v_mul_f32 v22, v9, v22
    v_mul_f32 v23, v9, v23
    v_cvt_pk_bf16_f32 v24, v16, v17
    v_cvt_pk_bf16_f32 v25, v18, v19
    v_cvt_pk_bf16_f32 v26, v20, v21
    v_cvt_pk_bf16_f32 v27, v22, v23
    s_lshl_b32 s26, s22, 1
    s_add_u32 s26, s26, s23
    s_lshl_b32 s27, s26, 11
    s_add_u32 s29, s27, 0xc00000
    s_add_u32 s30, s27, 0xe00000
    s_add_u32 s27, s27, 0x1580000
    s_lshl_b32 s48, s26, 2
    s_add_u32 s48, s48, 0x1a89000
    s_cmp_lg_u32 s24, 0
    s_cbranch_scc1 L_kvv_4
    s_add_u32 s57, s29, 0x20000
    buffer_store_dwordx4 v[24:27], v0, s[4:7], s57 offen offset:0
    buffer_store_dwordx4 v[24:27], v0, s[4:7], s29 offen offset:0 sc1
    buffer_store_dwordx4 v[24:27], v0, s[4:7], s27 offen offset:0 sc1
    v_mov_b32 v28, -1
    v_mov_b32 v29, -1
    v_mov_b32 v30, -1
    v_mov_b32 v31, -1
    buffer_store_dwordx4 v[28:31], v0, s[4:7], s30 offen offset:0 sc1
    s_add_u32 s57, s30, 0x20000
    buffer_store_dwordx4 v[28:31], v0, s[4:7], s57 offen offset:0 sc1
    s_waitcnt vmcnt(5)
    s_mov_b32 s49, 1
    v_mov_b32 v4, 0
    v_dot2_f32_bf16 v4, v24, v24, v4
    v_dot2_f32_bf16 v4, v25, v25, v4
    v_dot2_f32_bf16 v4, v26, v26, v4
    v_dot2_f32_bf16 v4, v27, v27, v4
    s_nop 2
    v_mov_b32 v6, v4
    s_nop 1
    v_permlane32_swap_b32 v4, v6
    s_nop 1
    v_add_f32 v4, v4, v6
    v_cmp_ge_f32 vcc, 0x43800000, v4
    s_cmp_eq_u64 vcc, exec
    s_cselect_b32 s47, 1, 2
    s_branch L_kvd_3
L_kvv_4:
    v_lshrrev_b32 v2, 4, v0
    v_bfe_u32 v3, v2, 2, 1
    v_lshlrev_b32 v3, 9, v3
    v_bfe_u32 v4, v2, 4, 1
    v_lshl_add_u32 v3, v4, 8, v3
    v_and_b32 v4, 3, v2
    v_lshl_add_u32 v3, v4, 1, v3
    v_bfe_u32 v4, v2, 3, 1
    v_lshl_add_u32 v3, v4, 3, v3
    v_lshl_add_u32 v3, v1, 2, v3
    v_add_u32 v3, 0x26000, v3
    ds_write_b16 v3, v24 offset:0
    ds_write_b16_d16_hi v3, v24 offset:16
    ds_write_b16 v3, v25 offset:32
    ds_write_b16_d16_hi v3, v25 offset:48
    ds_write_b16 v3, v26 offset:128
    ds_write_b16_d16_hi v3, v26 offset:144
    ds_write_b16 v3, v27 offset:160
    ds_write_b16_d16_hi v3, v27 offset:176
    v_add_u32 v2, 0x26000, v0
    s_waitcnt lgkmcnt(0)
    ds_read_b128 v[24:27], v2
    s_waitcnt lgkmcnt(0)
    s_add_u32 s57, s29, 0x20000
    buffer_store_dwordx4 v[24:27], v0, s[4:7], s57 offen offset:1024
    buffer_store_dwordx4 v[24:27], v0, s[4:7], s29 offen offset:1024 sc1
    buffer_store_dwordx4 v[24:27], v0, s[4:7], s27 offen offset:1024 sc1
    v_mov_b32 v28, -1
    v_mov_b32 v29, -1
    v_mov_b32 v30, -1
    v_mov_b32 v31, -1
    buffer_store_dwordx4 v[28:31], v0, s[4:7], s30 offen offset:1024 sc1
    s_add_u32 s57, s30, 0x20000
    buffer_store_dwordx4 v[28:31], v0, s[4:7], s57 offen offset:1024 sc1
    s_waitcnt vmcnt(5)
    s_mov_b32 s49, 1
L_kvd_3:
    s_lshr_b32 s27, s20, 1
    s_lshl_b32 s26, s27, 13
    s_add_u32 s26, s26, 0x0
    v_add_u32 v2, s26, v0
    ds_read_b128 v[48:51], v2 offset:0
    ds_read_b128 v[52:55], v2 offset:32768
    ds_read_b128 v[56:59], v2 offset:1024
    ds_read_b128 v[60:63], v2 offset:33792
    ds_read_b128 v[64:67], v2 offset:4096
    ds_read_b128 v[68:71], v2 offset:36864
    ds_read_b128 v[72:75], v2 offset:5120
    ds_read_b128 v[76:79], v2 offset:37888
    s_waitcnt lgkmcnt(8)
    v_pk_add_f32 v[80:81], v[80:81], v[88:89]
    v_pk_add_f32 v[82:83], v[82:83], v[90:91]
    v_pk_add_f32 v[84:85], v[84:85], v[92:93]
    v_pk_add_f32 v[86:87], v[86:87], v[94:95]
    v_pk_add_f32 v[80:81], v[80:81], v[84:85]
    v_pk_add_f32 v[82:83], v[82:83], v[86:87]
    v_pk_add_f32 v[4:5], v[80:81], v[82:83]
    v_mul_f32 v4, 0xbb000000, v4
    v_mul_f32 v5, 0xbb000000, v5
    v_fma_f32 v5, -v4, v4, v5
    v_max_f32 v5, 0, v5
    v_add_f32 v5, 0x3727c5ac, v5
    v_rsq_f32 v5, v5
    s_nop 0
    v_mul_f32 v5, 0x3eb8aa3b, v5
    s_cmp_lg_u32 s49, 0
    s_cbranch_scc1 L_qw_6
    s_waitcnt vmcnt(4)
L_qw_6:
    s_waitcnt lgkmcnt(7)
    v_mfma_f32_32x32x16_bf16 v[16:31], v[96:99], v[48:51], 0
    ds_read_b128 v[48:51], v2 offset:2048
    s_waitcnt lgkmcnt(7)
    v_mfma_f32_32x32x16_bf16 v[32:47], v[96:99], v[52:55], 0
    ds_read_b128 v[52:55], v2 offset:34816
    s_waitcnt lgkmcnt(7)
    v_mfma_f32_32x32x16_bf16 v[16:31], v[100:103], v[56:59], v[16:31]
    ds_read_b128 v[56:59], v2 offset:3072
    s_waitcnt lgkmcnt(7)
    v_mfma_f32_32x32x16_bf16 v[32:47], v[100:103], v[60:63], v[32:47]
    ds_read_b128 v[60:63], v2 offset:35840
    s_waitcnt lgkmcnt(7)
    v_mfma_f32_32x32x16_bf16 v[16:31], v[112:115], v[64:67], v[16:31]
    ds_read_b128 v[64:67], v2 offset:6144
    s_waitcnt lgkmcnt(7)
    v_mfma_f32_32x32x16_bf16 v[32:47], v[112:115], v[68:71], v[32:47]
    ds_read_b128 v[68:71], v2 offset:38912
    s_waitcnt lgkmcnt(7)
    v_mfma_f32_32x32x16_bf16 v[16:31], v[116:119], v[72:75], v[16:31]
    ds_read_b128 v[72:75], v2 offset:7168
    s_waitcnt lgkmcnt(7)
    v_mfma_f32_32x32x16_bf16 v[32:47], v[116:119], v[76:79], v[32:47]
    ds_read_b128 v[76:79], v2 offset:39936
    s_waitcnt lgkmcnt(7)
    v_mfma_f32_32x32x16_bf16 v[16:31], v[104:107], v[48:51], v[16:31]
    s_waitcnt lgkmcnt(6)
    v_mfma_f32_32x32x16_bf16 v[32:47], v[104:107], v[52:55], v[32:47]
    s_waitcnt lgkmcnt(5)
    v_mfma_f32_32x32x16_bf16 v[16:31], v[108:111], v[56:59], v[16:31]
    s_waitcnt lgkmcnt(4)
    v_mfma_f32_32x32x16_bf16 v[32:47], v[108:111], v[60:63], v[32:47]
    s_waitcnt lgkmcnt(3)
    v_mfma_f32_32x32x16_bf16 v[16:31], v[120:123], v[64:67], v[16:31]
    s_waitcnt lgkmcnt(2)
    v_mfma_f32_32x32x16_bf16 v[32:47], v[120:123], v[68:71], v[32:47]
    s_waitcnt lgkmcnt(1)
    v_mfma_f32_32x32x16_bf16 v[16:31], v[124:127], v[72:75], v[16:31]
    s_waitcnt lgkmcnt(0)
    v_mfma_f32_32x32x16_bf16 v[32:47], v[124:127], v[76:79], v[32:47]
    s_mul_i32 s26, s24, 6144
    s_add_u32 s26, s26, 0x18000
    v_add_u32 v2, s26, v0
    s_mul_i32 s26, s20, 6144
    s_add_u32 s26, s26, 0x18000
    v_add_u32 v3, s26, v0
    s_lshr_b32 s27, s20, 1
    s_nop 7
L_kq_7:
    s_cmp_lg_u32 s27, 0
    s_cbranch_scc1 L_kq_8
    ds_write_b128 v2, v[24:27] offset:26624
    ds_write_b128 v2, v[28:31] offset:27648
    ds_write_b128 v2, v[32:35] offset:12288
    ds_write_b128 v2, v[36:39] offset:13312
    ds_write_b128 v2, v[40:43] offset:40960
    ds_write_b128 v2, v[44:47] offset:41984
    s_branch L_kq_11
L_kq_8:
    s_cmp_lg_u32 s27, 1
    s_cbranch_scc1 L_kq_9
    ds_write_b128 v2, v[24:27] offset:24576
    ds_write_b128 v2, v[28:31] offset:25600
    ds_write_b128 v2, v[16:19] offset:4096
    ds_write_b128 v2, v[20:23] offset:5120
    ds_write_b128 v2, v[40:43] offset:38912
    ds_write_b128 v2, v[44:47] offset:39936
    s_nop 1
    v_mov_b32 v16, v32
    v_mov_b32 v17, v33
    v_mov_b32 v18, v34
    v_mov_b32 v19, v35
    v_mov_b32 v20, v36
    v_mov_b32 v21, v37
    v_mov_b32 v22, v38
    v_mov_b32 v23, v39
    s_branch L_kq_11
L_kq_9:
    s_cmp_lg_u32 s27, 2
    s_cbranch_scc1 L_kq_10
    ds_write_b128 v2, v[16:19] offset:2048
    ds_write_b128 v2, v[20:23] offset:3072
    ds_write_b128 v2, v[40:43] offset:36864
    ds_write_b128 v2, v[44:47] offset:37888
    ds_write_b128 v2, v[32:35] offset:16384
    ds_write_b128 v2, v[36:39] offset:17408
    s_nop 1
    v_mov_b32 v16, v24
    v_mov_b32 v17, v25
    v_mov_b32 v18, v26
    v_mov_b32 v19, v27
    v_mov_b32 v20, v28
    v_mov_b32 v21, v29
    v_mov_b32 v22, v30
    v_mov_b32 v23, v31
    s_branch L_kq_11
L_kq_10:
    ds_write_b128 v2, v[16:19] offset:0
    ds_write_b128 v2, v[20:23] offset:1024
    ds_write_b128 v2, v[24:27] offset:28672
    ds_write_b128 v2, v[28:31] offset:29696
    ds_write_b128 v2, v[32:35] offset:14336
    ds_write_b128 v2, v[36:39] offset:15360
    s_nop 1
    v_mov_b32 v16, v40
    v_mov_b32 v17, v41
    v_mov_b32 v18, v42
    v_mov_b32 v19, v43
    v_mov_b32 v20, v44
    v_mov_b32 v21, v45
    v_mov_b32 v22, v46
    v_mov_b32 v23, v47
L_kq_11:
    s_lshl_b32 s26, s20, 9
    s_add_u32 s26, s26, 0x27100
    v_add_u32 v6, s26, v1
    ds_read_b128 v[160:163], v6 offset:0
    ds_read_b128 v[164:167], v6 offset:32
    s_waitcnt lgkmcnt(0)
    s_barrier
    ds_read_b128 v[24:27], v3 offset:0
    ds_read_b128 v[28:31], v3 offset:1024
    ds_read_b128 v[32:35], v3 offset:2048
    ds_read_b128 v[36:39], v3 offset:3072
    ds_read_b128 v[40:43], v3 offset:4096
    ds_read_b128 v[44:47], v3 offset:5120
    s_waitcnt lgkmcnt(4)
    v_pk_add_f32 v[16:17], v[16:17], v[24:25]
    v_pk_add_f32 v[18:19], v[18:19], v[26:27]
    v_pk_add_f32 v[20:21], v[20:21], v[28:29]
    v_pk_add_f32 v[22:23], v[22:23], v[30:31]
    s_waitcnt lgkmcnt(2)
    v_pk_add_f32 v[16:17], v[16:17], v[32:33]
    v_pk_add_f32 v[18:19], v[18:19], v[34:35]
    v_pk_add_f32 v[20:21], v[20:21], v[36:37]
    v_pk_add_f32 v[22:23], v[22:23], v[38:39]
    s_waitcnt lgkmcnt(0)
    v_pk_add_f32 v[16:17], v[16:17], v[40:41]
    v_pk_add_f32 v[18:19], v[18:19], v[42:43]
    v_pk_add_f32 v[20:21], v[20:21], v[44:45]
    v_pk_add_f32 v[22:23], v[22:23], v[46:47]
    v_fma_f32 v16, v4, v160, v16
    v_fma_f32 v17, v4, v161, v17
    v_fma_f32 v18, v4, v162, v18
    v_fma_f32 v19, v4, v163, v19
    v_fma_f32 v20, v4, v164, v20
    v_fma_f32 v21, v4, v165, v21
    v_fma_f32 v22, v4, v166, v22
    v_fma_f32 v23, v4, v167, v23
    v_mul_f32 v16, v5, v16
    v_mul_f32 v17, v5, v17
    v_mul_f32 v18, v5, v18
    v_mul_f32 v19, v5, v19
    v_mul_f32 v20, v5, v20
    v_mul_f32 v21, v5, v21
    v_mul_f32 v22, v5, v22
    v_mul_f32 v23, v5, v23
    v_cvt_pk_bf16_f32 v8, v16, v17
    v_cvt_pk_bf16_f32 v9, v18, v19
    v_cvt_pk_bf16_f32 v10, v20, v21
    v_cvt_pk_bf16_f32 v11, v22, v23
    v_lshrrev_b32 v89, 2, v0
    v_and_b32 v88, 28, v89
    v_lshlrev_b32 v91, 1, v0
    s_lshl_b32 s51, s20, 11
    s_and_b32 s50, s22, 7
    s_lshl_b32 s50, s50, 12
    s_add_u32 s55, s54, 0xc00000
    s_add_u32 s56, s54, 0x1580000
    s_add_u32 s26, s50, s55
    s_add_u32 s27, s26, 0x20000
    s_add_u32 s50, s50, 0x1000
    s_and_b32 s50, s50, 0x7fff
    s_add_u32 s55, s50, s55
    v_add_u32 v92, s51, v0
    s_add_u32 s51, s51, 0x4000
    s_mov_b32 s36, 400003
L_kp_12:
    s_and_b32 s28, s36, 3
    s_cselect_b32 s28, s27, s26
    buffer_load_dwordx4 v[40:43], v0, s[4:7], s28 offen offset:0 sc1
    buffer_load_dwordx4 v[44:47], v0, s[4:7], s28 offen offset:1024 sc1
    s_waitcnt vmcnt(0)
    v_max3_u32 v2, v40, v41, v42
    v_max3_u32 v2, v2, v43, v44
    v_max3_u32 v2, v2, v45, v46
    v_max_u32 v2, v2, v47
    v_cmp_ne_u32 vcc, -1, v2
    s_cmp_eq_u64 vcc, exec
    s_cbranch_scc1 L_kpd_13
    s_sleep 1
    s_sub_u32 s36, s36, 1
    s_cmp_lg_u32 s36, 0
    s_cbranch_scc1 L_kp_12
L_kpd_13:
    ds_write_b128 v92, v[40:43] offset:0
    ds_write_b128 v92, v[44:47] offset:1024
    s_lshr_b32 s53, s2, 4
    s_mul_i32 s53, s53, 4352
    s_add_u32 s53, s53, 0x1a89000
    v_mov_b32 v4, 0
    v_dot2_f32_bf16 v4, v8, v8, v4
    v_dot2_f32_bf16 v4, v9, v9, v4
    v_dot2_f32_bf16 v4, v10, v10, v4
    v_dot2_f32_bf16 v4, v11, v11, v4
    v_mov_b32 v24, s35
    v_mov_b32 v25, s35
    v_mov_b32 v26, s35
    v_mov_b32 v27, s35
    v_mov_b32 v28, s35
    v_mov_b32 v29, s35
    v_mov_b32 v30, s35
    v_mov_b32 v31, s35
    v_mov_b32 v32, s35
    v_mov_b32 v33, s35
    v_mov_b32 v34, s35
    v_mov_b32 v35, s35
    v_mov_b32 v36, s35
    v_mov_b32 v37, s35
    v_mov_b32 v38, s35
    v_mov_b32 v39, s35
    v_mov_b32 v72, 0
    v_mov_b32 v73, 0
    v_mov_b32 v74, 0
    v_mov_b32 v75, 0
    v_mov_b32 v76, 0
    v_mov_b32 v77, 0
    v_mov_b32 v78, 0
    v_mov_b32 v79, 0
    v_mov_b32 v80, 0
    v_mov_b32 v81, 0
    v_mov_b32 v82, 0
    v_mov_b32 v83, 0
    v_mov_b32 v84, 0
    v_mov_b32 v85, 0
    v_mov_b32 v86, 0
    v_mov_b32 v87, 0
    v_mov_b32 v6, v4
    s_nop 1
    v_permlane32_swap_b32 v4, v6
    s_nop 1
    v_add_f32 v4, v4, v6
    v_cmp_ge_f32 vcc, 0x41800000, v4
    s_mov_b32 s38, 0x0000ffff
    s_mov_b32 s39, 0x0000ffff
    s_mov_b64 s[40:41], vcc
    v_mov_b32 v2, v0
    v_add_u32 v3, 0x10000, v2
    s_waitcnt lgkmcnt(0)
    s_barrier
    ds_read_b128 v[16:19], v2 offset:0
    ds_read_b128 v[20:23], v2 offset:2048
    s_mov_b64 exec, s[38:39]
    ds_read_b128 v[24:27], v2 offset:1024
    ds_read_b128 v[28:31], v2 offset:1280
    s_mov_b64 exec, -1
    s_cmp_eq_u32 s47, 0
    s_cbranch_scc1 L_kvf_16
    v_mov_b32 v93, s47
    v_mul_u32_u24 v94, 272, v0
    s_mov_b64 exec, 0xffff
    buffer_store_dword v93, v94, s[4:7], s48 offen sc1
    s_mov_b64 exec, -1
L_kvf_16:
    s_waitcnt lgkmcnt(3)
    v_mfma_f32_32x32x16_bf16 v[40:55], v[16:19], v[8:11], 0
    s_nop 13
    s_cmp_lt_u32 s20, 4
    s_cbranch_scc1 L_pr_17
    s_setprio 1
L_pr_17:
    v_exp_f32 v40, v40
    v_exp_f32 v41, v41
    v_exp_f32 v42, v42
    v_exp_f32 v43, v43
    v_exp_f32 v44, v44
    v_exp_f32 v45, v45
    s_waitcnt lgkmcnt(0)
    v_mfma_f32_32x32x16_bf16 v[56:71], v[20:23], v[8:11], 0
    ds_read_b128 v[16:19], v2 offset:4096
    s_mov_b64 exec, s[38:39]
    ds_read_b128 v[32:35], v2 offset:3072
    ds_read_b128 v[36:39], v2 offset:3328
    s_mov_b64 exec, -1
    v_exp_f32 v46, v46
    v_exp_f32 v47, v47
    v_exp_f32 v48, v48
    v_cvt_pk_bf16_f32 v40, v40, v41
    v_cvt_pk_bf16_f32 v41, v42, v43
    v_cvt_pk_bf16_f32 v42, v44, v45
    v_cvt_pk_bf16_f32 v43, v46, v47
    v_exp_f32 v49, v49
    v_exp_f32 v50, v50
    v_exp_f32 v51, v51
    v_mfma_f32_32x32x16_bf16 v[72:87], v[24:27], v[40:43], v[72:87]
    s_add_u32 s26, s34, 0x600000
    buffer_load_dword v90, v0, s[4:7], s26 offen
    v_exp_f32 v52, v52
    v_exp_f32 v53, v53
    v_exp_f32 v54, v54
    v_exp_f32 v55, v55
    v_cvt_pk_bf16_f32 v48, v48, v49
    v_cvt_pk_bf16_f32 v49, v50, v51
    v_cvt_pk_bf16_f32 v50, v52, v53
    v_cvt_pk_bf16_f32 v51, v54, v55
    v_exp_f32 v56, v56
    v_exp_f32 v57, v57
    v_mfma_f32_32x32x16_bf16 v[72:87], v[28:31], v[48:51], v[72:87]
    v_exp_f32 v58, v58
    v_exp_f32 v59, v59
    v_exp_f32 v60, v60
    v_exp_f32 v61, v61
    s_waitcnt lgkmcnt(0)
    v_mfma_f32_32x32x16_bf16 v[40:55], v[16:19], v[8:11], 0
    ds_read_b128 v[20:23], v2 offset:6144
    s_mov_b64 exec, s[38:39]
    ds_read_b128 v[24:27], v2 offset:5120
    ds_read_b128 v[28:31], v2 offset:5376
    s_mov_b64 exec, -1
    v_exp_f32 v62, v62
    v_exp_f32 v63, v63
    v_exp_f32 v64, v64
    v_cvt_pk_bf16_f32 v56, v56, v57
    v_cvt_pk_bf16_f32 v57, v58, v59
    v_cvt_pk_bf16_f32 v58, v60, v61
    v_cvt_pk_bf16_f32 v59, v62, v63
    v_exp_f32 v65, v65
    v_exp_f32 v66, v66
    v_exp_f32 v67, v67
    v_mfma_f32_32x32x16_bf16 v[72:87], v[32:35], v[56:59], v[72:87]
    s_lshl_b32 s26, s22, 8
    s_add_u32 s26, s26, 0x1a80000
    buffer_load_dword v90, v89, s[4:7], s26 offen
    v_exp_f32 v68, v68
    v_exp_f32 v69, v69
    v_exp_f32 v70, v70
    v_exp_f32 v71, v71
    v_cvt_pk_bf16_f32 v64, v64, v65
    v_cvt_pk_bf16_f32 v65, v66, v67
    v_cvt_pk_bf16_f32 v66, v68, v69
    v_cvt_pk_bf16_f32 v67, v70, v71
    v_exp_f32 v40, v40
    v_exp_f32 v41, v41
    v_mfma_f32_32x32x16_bf16 v[72:87], v[36:39], v[64:67], v[72:87]
    v_exp_f32 v42, v42
    v_exp_f32 v43, v43
    v_exp_f32 v44, v44
    v_exp_f32 v45, v45
    s_waitcnt lgkmcnt(0)
    v_mfma_f32_32x32x16_bf16 v[56:71], v[20:23], v[8:11], 0
    ds_read_b128 v[16:19], v2 offset:8192
    s_mov_b64 exec, s[38:39]
    ds_read_b128 v[32:35], v2 offset:7168
    ds_read_b128 v[36:39], v2 offset:7424
    s_mov_b64 exec, -1
    v_exp_f32 v46, v46
    v_exp_f32 v47, v47
    v_exp_f32 v48, v48
    v_cvt_pk_bf16_f32 v40, v40, v41
    v_cvt_pk_bf16_f32 v41, v42, v43
    v_cvt_pk_bf16_f32 v42, v44, v45
    v_cvt_pk_bf16_f32 v43, v46, v47
    v_exp_f32 v49, v49
    v_exp_f32 v50, v50
    v_exp_f32 v51, v51
    v_mfma_f32_32x32x16_bf16 v[72:87], v[24:27], v[40:43], v[72:87]
    s_lshl_b32 s26, s21, 1
    s_add_u32 s26, s26, s24
    s_lshl_b32 s26, s26, 15
    s_lshl_b32 s27, s25, 14
    s_add_u32 s26, s26, s27
    s_add_u32 s26, s26, 0x80000
    buffer_load_dwordx4 v[96:99], v0, s[4:7], s26 offen offset:0
    v_exp_f32 v52, v52
    v_exp_f32 v53, v53
    v_exp_f32 v54, v54
    v_exp_f32 v55, v55
    v_cvt_pk_bf16_f32 v48, v48, v49
    v_cvt_pk_bf16_f32 v49, v50, v51
    v_cvt_pk_bf16_f32 v50, v52, v53
    v_cvt_pk_bf16_f32 v51, v54, v55
    v_exp_f32 v56, v56
    v_exp_f32 v57, v57
    v_mfma_f32_32x32x16_bf16 v[72:87], v[28:31], v[48:51], v[72:87]
    v_exp_f32 v58, v58
    v_exp_f32 v59, v59
    v_exp_f32 v60, v60
    v_exp_f32 v61, v61
    s_waitcnt lgkmcnt(0)
    v_mfma_f32_32x32x16_bf16 v[40:55], v[16:19], v[8:11], 0
    ds_read_b128 v[20:23], v2 offset:10240
    s_mov_b64 exec, s[38:39]
    ds_read_b128 v[24:27], v2 offset:9216
    ds_read_b128 v[28:31], v2 offset:9472
    s_mov_b64 exec, -1
    v_exp_f32 v62, v62
    v_exp_f32 v63, v63
    v_exp_f32 v64, v64
    v_cvt_pk_bf16_f32 v56, v56, v57
    v_cvt_pk_bf16_f32 v57, v58, v59
    v_cvt_pk_bf16_f32 v58, v60, v61
    v_cvt_pk_bf16_f32 v59, v62, v63
    v_exp_f32 v65, v65
    v_exp_f32 v66, v66
    v_exp_f32 v67, v67
    v_mfma_f32_32x32x16_bf16 v[72:87], v[32:35], v[56:59], v[72:87]
    buffer_load_dwordx4 v[100:103], v0, s[4:7], s26 offen offset:1024
    v_exp_f32 v68, v68
    v_exp_f32 v69, v69
    v_exp_f32 v70, v70
    v_exp_f32 v71, v71
    v_cvt_pk_bf16_f32 v64, v64, v65
    v_cvt_pk_bf16_f32 v65, v66, v67
    v_cvt_pk_bf16_f32 v66, v68, v69
    v_cvt_pk_bf16_f32 v67, v70, v71
    s_setprio 0
    v_exp_f32 v40, v40
    v_exp_f32 v41, v41
    v_mfma_f32_32x32x16_bf16 v[72:87], v[36:39], v[64:67], v[72:87]
    v_exp_f32 v42, v42
    v_exp_f32 v43, v43
    v_exp_f32 v44, v44
    v_exp_f32 v45, v45
    s_waitcnt lgkmcnt(0)
    v_mfma_f32_32x32x16_bf16 v[56:71], v[20:23], v[8:11], 0
    ds_read_b128 v[16:19], v2 offset:12288
    s_mov_b64 exec, s[38:39]
    ds_read_b128 v[32:35], v2 offset:11264
    ds_read_b128 v[36:39], v2 offset:11520
    s_mov_b64 exec, -1
    v_exp_f32 v46, v46
    v_exp_f32 v47, v47
    v_exp_f32 v48, v48
    v_cvt_pk_bf16_f32 v40, v40, v41
    v_cvt_pk_bf16_f32 v41, v42, v43
    v_cvt_pk_bf16_f32 v42, v44, v45
    v_cvt_pk_bf16_f32 v43, v46, v47
    v_exp_f32 v49, v49
    v_exp_f32 v50, v50
    v_exp_f32 v51, v51
    v_mfma_f32_32x32x16_bf16 v[72:87], v[24:27], v[40:43], v[72:87]
    buffer_load_dwordx4 v[104:107], v0, s[4:7], s26 offen offset:2048
    buffer_load_dwordx4 v[152:155], v0, s[4:7], s55 offen offset:0 sc1
    buffer_load_dwordx4 v[156:159], v0, s[4:7], s55 offen offset:1024 sc1
    v_exp_f32 v52, v52
    v_exp_f32 v53, v53
    v_exp_f32 v54, v54
    v_exp_f32 v55, v55
    v_cvt_pk_bf16_f32 v48, v48, v49
    v_cvt_pk_bf16_f32 v49, v50, v51
    v_cvt_pk_bf16_f32 v50, v52, v53
    v_cvt_pk_bf16_f32 v51, v54, v55
    v_exp_f32 v56, v56
    v_exp_f32 v57, v57
    v_mfma_f32_32x32x16_bf16 v[72:87], v[28:31], v[48:51], v[72:87]
    v_exp_f32 v58, v58
    v_exp_f32 v59, v59
    v_exp_f32 v60, v60
    v_exp_f32 v61, v61
    s_waitcnt lgkmcnt(0)
    v_mfma_f32_32x32x16_bf16 v[40:55], v[16:19], v[8:11], 0
    ds_read_b128 v[20:23], v2 offset:14336
    s_mov_b64 exec, s[38:39]
    ds_read_b128 v[24:27], v2 offset:13312
    ds_read_b128 v[28:31], v2 offset:13568
    s_mov_b64 exec, -1
    v_exp_f32 v62, v62
    v_exp_f32 v63, v63
    v_exp_f32 v64, v64
    v_cvt_pk_bf16_f32 v56, v56, v57
    v_cvt_pk_bf16_f32 v57, v58, v59
    v_cvt_pk_bf16_f32 v58, v60, v61
    v_cvt_pk_bf16_f32 v59, v62, v63
    v_exp_f32 v65, v65
    v_exp_f32 v66, v66
    v_exp_f32 v67, v67
    v_mfma_f32_32x32x16_bf16 v[72:87], v[32:35], v[56:59], v[72:87]
    buffer_load_dwordx4 v[108:111], v0, s[4:7], s26 offen offset:3072
    s_waitcnt vmcnt(1)
    v_max3_u32 v93, v152, v153, v154
    v_max3_u32 v93, v93, v155, v156
    v_max3_u32 v93, v93, v157, v158
    v_max_u32 v93, v93, v159
    v_cmp_ne_u32 vcc, -1, v93
    s_cmp_eq_u64 vcc, exec
    s_cbranch_scc1 L_tok_18
    s_mov_b32 s36, 200000
L_poll_19:
    buffer_load_dwordx4 v[152:155], v0, s[4:7], s55 offen offset:0 sc1
    buffer_load_dwordx4 v[156:159], v0, s[4:7], s55 offen offset:1024 sc1
    s_waitcnt vmcnt(0)
    v_max3_u32 v93, v152, v153, v154
    v_max3_u32 v93, v93, v155, v156
    v_max3_u32 v93, v93, v157, v158
    v_max_u32 v93, v93, v159
    v_cmp_ne_u32 vcc, -1, v93
    s_cmp_eq_u64 vcc, exec
    s_cbranch_scc1 L_polld_20
    s_sleep 1
    s_sub_u32 s36, s36, 1
    s_cmp_lg_u32 s36, 0
    s_cbranch_scc1 L_poll_19
L_polld_20:
L_tok_18:
    ds_write_b128 v92, v[152:155] offset:16384
    ds_write_b128 v92, v[156:159] offset:17408
    v_exp_f32 v68, v68
    v_exp_f32 v69, v69
    v_exp_f32 v70, v70
    v_exp_f32 v71, v71
    v_cvt_pk_bf16_f32 v64, v64, v65
    v_cvt_pk_bf16_f32 v65, v66, v67
    v_cvt_pk_bf16_f32 v66, v68, v69
    v_cvt_pk_bf16_f32 v67, v70, v71
    v_exp_f32 v40, v40
    v_exp_f32 v41, v41
    v_mfma_f32_32x32x16_bf16 v[72:87], v[36:39], v[64:67], v[72:87]
    v_exp_f32 v42, v42
    v_exp_f32 v43, v43
    v_exp_f32 v44, v44
    v_exp_f32 v45, v45
    s_waitcnt lgkmcnt(0)
    s_barrier
    s_waitcnt lgkmcnt(0)
    v_mfma_f32_32x32x16_bf16 v[56:71], v[20:23], v[8:11], 0
    ds_read_b128 v[16:19], v2 offset:16384
    s_mov_b64 exec, s[38:39]
    ds_read_b128 v[32:35], v2 offset:15360
    ds_read_b128 v[36:39], v2 offset:15616
    s_mov_b64 exec, -1
    v_exp_f32 v46, v46
    v_exp_f32 v47, v47
    v_exp_f32 v48, v48
    v_cvt_pk_bf16_f32 v40, v40, v41
    v_cvt_pk_bf16_f32 v41, v42, v43
    v_cvt_pk_bf16_f32 v42, v44, v45
    v_cvt_pk_bf16_f32 v43, v46, v47
    v_exp_f32 v49, v49
    v_exp_f32 v50, v50
    v_exp_f32 v51, v51
    v_mfma_f32_32x32x16_bf16 v[72:87], v[24:27], v[40:43], v[72:87]
    s_add_u32 s26, s26, 4096
    buffer_load_dwordx4 v[112:115], v0, s[4:7], s26 offen offset:0
    v_exp_f32 v52, v52
    v_exp_f32 v53, v53
    v_exp_f32 v54, v54
    v_exp_f32 v55, v55
    v_cvt_pk_bf16_f32 v48, v48, v49
    v_cvt_pk_bf16_f32 v49, v50, v51
    v_cvt_pk_bf16_f32 v50, v52, v53
    v_cvt_pk_bf16_f32 v51, v54, v55
    s_cmp_lt_u32 s20, 4
    s_cbranch_scc1 L_pr_21
    s_setprio 1
L_pr_21:
    v_exp_f32 v56, v56
    v_exp_f32 v57, v57
    v_mfma_f32_32x32x16_bf16 v[72:87], v[28:31], v[48:51], v[72:87]
    v_exp_f32 v58, v58
    v_exp_f32 v59, v59
    v_exp_f32 v60, v60
    v_exp_f32 v61, v61
    s_waitcnt lgkmcnt(0)
    v_mfma_f32_32x32x16_bf16 v[40:55], v[16:19], v[8:11], 0
    ds_read_b128 v[20:23], v2 offset:18432
    s_mov_b64 exec, s[38:39]
    ds_read_b128 v[24:27], v2 offset:17408
    ds_read_b128 v[28:31], v2 offset:17664
    s_mov_b64 exec, -1
    v_exp_f32 v62, v62
    v_exp_f32 v63, v63
    v_exp_f32 v64, v64
    v_cvt_pk_bf16_f32 v56, v56, v57
    v_cvt_pk_bf16_f32 v57, v58, v59
    v_cvt_pk_bf16_f32 v58, v60, v61
    v_cvt_pk_bf16_f32 v59, v62, v63
    v_exp_f32 v65, v65
    v_exp_f32 v66, v66
    v_exp_f32 v67, v67
    v_mfma_f32_32x32x16_bf16 v[72:87], v[32:35], v[56:59], v[72:87]
    buffer_load_dword v5, v89, s[4:7], s53 offen sc1
    v_exp_f32 v68, v68
    v_exp_f32 v69, v69
    v_exp_f32 v70, v70
    v_exp_f32 v71, v71
    v_cvt_pk_bf16_f32 v64, v64, v65
    v_cvt_pk_bf16_f32 v65, v66, v67
    v_cvt_pk_bf16_f32 v66, v68, v69
    v_cvt_pk_bf16_f32 v67, v70, v71
    v_exp_f32 v40, v40
    v_exp_f32 v41, v41
    v_mfma_f32_32x32x16_bf16 v[72:87], v[36:39], v[64:67], v[72:87]
    v_exp_f32 v42, v42
    v_exp_f32 v43, v43
    v_exp_f32 v44, v44
    v_exp_f32 v45, v45
    s_waitcnt lgkmcnt(0)
    v_mfma_f32_32x32x16_bf16 v[56:71], v[20:23], v[8:11], 0
    ds_read_b128 v[16:19], v2 offset:20480
    s_mov_b64 exec, s[38:39]
    ds_read_b128 v[32:35], v2 offset:19456
    ds_read_b128 v[36:39], v2 offset:19712
    s_mov_b64 exec, -1
    v_exp_f32 v46, v46
    v_exp_f32 v47, v47
    v_exp_f32 v48, v48
    v_cvt_pk_bf16_f32 v40, v40, v41
    v_cvt_pk_bf16_f32 v41, v42, v43
    v_cvt_pk_bf16_f32 v42, v44, v45
    v_cvt_pk_bf16_f32 v43, v46, v47
    v_exp_f32 v49, v49
    v_exp_f32 v50, v50
    v_exp_f32 v51, v51
    v_mfma_f32_32x32x16_bf16 v[72:87], v[24:27], v[40:43], v[72:87]
    buffer_load_dwordx4 v[116:119], v0, s[4:7], s26 offen offset:1024
    v_exp_f32 v52, v52
    v_exp_f32 v53, v53
    v_exp_f32 v54, v54
    v_exp_f32 v55, v55
    v_cvt_pk_bf16_f32 v48, v48, v49
    v_cvt_pk_bf16_f32 v49, v50, v51
    v_cvt_pk_bf16_f32 v50, v52, v53
    v_cvt_pk_bf16_f32 v51, v54, v55
    v_exp_f32 v56, v56
    v_exp_f32 v57, v57
    v_mfma_f32_32x32x16_bf16 v[72:87], v[28:31], v[48:51], v[72:87]
    v_exp_f32 v58, v58
    v_exp_f32 v59, v59
    v_exp_f32 v60, v60
    v_exp_f32 v61, v61
    s_waitcnt lgkmcnt(0)
    v_mfma_f32_32x32x16_bf16 v[40:55], v[16:19], v[8:11], 0
    ds_read_b128 v[20:23], v2 offset:22528
    s_mov_b64 exec, s[38:39]
    ds_read_b128 v[24:27], v2 offset:21504
    ds_read_b128 v[28:31], v2 offset:21760
    s_mov_b64 exec, -1
    v_exp_f32 v62, v62
    v_exp_f32 v63, v63
    v_exp_f32 v64, v64
    v_cvt_pk_bf16_f32 v56, v56, v57
    v_cvt_pk_bf16_f32 v57, v58, v59
    v_cvt_pk_bf16_f32 v58, v60, v61
    v_cvt_pk_bf16_f32 v59, v62, v63
    v_exp_f32 v65, v65
    v_exp_f32 v66, v66
    v_exp_f32 v67, v67
    v_mfma_f32_32x32x16_bf16 v[72:87], v[32:35], v[56:59], v[72:87]
    buffer_load_dwordx4 v[120:123], v0, s[4:7], s26 offen offset:2048
    v_exp_f32 v68, v68
    v_exp_f32 v69, v69
    v_exp_f32 v70, v70
    v_exp_f32 v71, v71
    v_cvt_pk_bf16_f32 v64, v64, v65
    v_cvt_pk_bf16_f32 v65, v66, v67
    v_cvt_pk_bf16_f32 v66, v68, v69
    v_cvt_pk_bf16_f32 v67, v70, v71
    v_exp_f32 v40, v40
    v_exp_f32 v41, v41
    v_mfma_f32_32x32x16_bf16 v[72:87], v[36:39], v[64:67], v[72:87]
    v_exp_f32 v42, v42
    v_exp_f32 v43, v43
    v_exp_f32 v44, v44
    v_exp_f32 v45, v45
    s_waitcnt lgkmcnt(0)
    v_mfma_f32_32x32x16_bf16 v[56:71], v[20:23], v[8:11], 0
    ds_read_b128 v[16:19], v2 offset:24576
    s_mov_b64 exec, s[38:39]
    ds_read_b128 v[32:35], v2 offset:23552
    ds_read_b128 v[36:39], v2 offset:23808
    s_mov_b64 exec, -1
    v_exp_f32 v46, v46
    v_exp_f32 v47, v47
    v_exp_f32 v48, v48
    v_cvt_pk_bf16_f32 v40, v40, v41
    v_cvt_pk_bf16_f32 v41, v42, v43
    v_cvt_pk_bf16_f32 v42, v44, v45
    v_cvt_pk_bf16_f32 v43, v46, v47
    v_exp_f32 v49, v49
    v_exp_f32 v50, v50
    v_exp_f32 v51, v51
    v_mfma_f32_32x32x16_bf16 v[72:87], v[24:27], v[40:43], v[72:87]
    buffer_load_dwordx4 v[124:127], v0, s[4:7], s26 offen offset:3072
    v_exp_f32 v52, v52
    v_exp_f32 v53, v53
    v_exp_f32 v54, v54
    v_exp_f32 v55, v55
    v_cvt_pk_bf16_f32 v48, v48, v49
    v_cvt_pk_bf16_f32 v49, v50, v51
    v_cvt_pk_bf16_f32 v50, v52, v53
    v_cvt_pk_bf16_f32 v51, v54, v55
    v_exp_f32 v56, v56
    v_exp_f32 v57, v57
    v_mfma_f32_32x32x16_bf16 v[72:87], v[28:31], v[48:51], v[72:87]
    v_exp_f32 v58, v58
    v_exp_f32 v59, v59
    v_exp_f32 v60, v60
    v_exp_f32 v61, v61
    s_waitcnt lgkmcnt(0)
    v_mfma_f32_32x32x16_bf16 v[40:55], v[16:19], v[8:11], 0
    ds_read_b128 v[20:23], v2 offset:26624
    s_mov_b64 exec, s[38:39]
    ds_read_b128 v[24:27], v2 offset:25600
    ds_read_b128 v[28:31], v2 offset:25856
    s_mov_b64 exec, -1
    v_exp_f32 v62, v62
    v_exp_f32 v63, v63
    v_exp_f32 v64, v64
    v_cvt_pk_bf16_f32 v56, v56, v57
    v_cvt_pk_bf16_f32 v57, v58, v59
    v_cvt_pk_bf16_f32 v58, v60, v61
    v_cvt_pk_bf16_f32 v59, v62, v63
    v_exp_f32 v65, v65
    v_exp_f32 v66, v66
    v_exp_f32 v67, v67
    v_mfma_f32_32x32x16_bf16 v[72:87], v[32:35], v[56:59], v[72:87]
    s_waitcnt vmcnt(3)
    v_cmp_ne_u32 vcc, 0, v5
    s_cmp_eq_u64 vcc, exec
    s_cbranch_scc1 L_kok_22
    s_mov_b32 s36, 200000
L_poll_23:
    buffer_load_dword v5, v89, s[4:7], s53 offen sc1
    s_waitcnt vmcnt(0)
    v_cmp_ne_u32 vcc, 0, v5
    s_cmp_eq_u64 vcc, exec
    s_cbranch_scc1 L_polld_24
    s_sleep 2
    s_sub_u32 s36, s36, 1
    s_cmp_lg_u32 s36, 0
    s_cbranch_scc1 L_poll_23
L_polld_24:
L_kok_22:
    v_cmp_eq_u32 vcc, 1, v5
    s_and_b64 vcc, vcc, s[40:41]
    s_cmp_eq_u64 vcc, exec
    s_cbranch_scc0 L_slow_14
    s_add_u32 s50, s50, 0x1000
    s_and_b32 s50, s50, 0x7fff
    s_add_u32 s51, s51, 0x4000
    s_add_u32 s52, s50, s56
    s_mov_b32 m0, s51
    s_nop 0
    buffer_load_dwordx4 v0, s[4:7], s52 offen offset:0 lds
    buffer_load_dwordx4 v0, s[4:7], s52 offen offset:1024 lds
    v_exp_f32 v68, v68
    v_exp_f32 v69, v69
    v_exp_f32 v70, v70
    v_exp_f32 v71, v71
    v_cvt_pk_bf16_f32 v64, v64, v65
    v_cvt_pk_bf16_f32 v65, v66, v67
    v_cvt_pk_bf16_f32 v66, v68, v69
    v_cvt_pk_bf16_f32 v67, v70, v71
    s_setprio 0
    v_exp_f32 v40, v40
    v_exp_f32 v41, v41
    v_mfma_f32_32x32x16_bf16 v[72:87], v[36:39], v[64:67], v[72:87]
    v_exp_f32 v42, v42
    v_exp_f32 v43, v43
    v_exp_f32 v44, v44
    v_exp_f32 v45, v45
    s_waitcnt lgkmcnt(0)
    v_mfma_f32_32x32x16_bf16 v[56:71], v[20:23], v[8:11], 0
    ds_read_b128 v[16:19], v2 offset:28672
    s_mov_b64 exec, s[38:39]
    ds_read_b128 v[32:35], v2 offset:27648
    ds_read_b128 v[36:39], v2 offset:27904
    s_mov_b64 exec, -1
    v_exp_f32 v46, v46
    v_exp_f32 v47, v47
    v_exp_f32 v48, v48
    v_cvt_pk_bf16_f32 v40, v40, v41
    v_cvt_pk_bf16_f32 v41, v42, v43
    v_cvt_pk_bf16_f32 v42, v44, v45
    v_cvt_pk_bf16_f32 v43, v46, v47
    v_exp_f32 v49, v49
    v_exp_f32 v50, v50
    v_exp_f32 v51, v51
    v_mfma_f32_32x32x16_bf16 v[72:87], v[24:27], v[40:43], v[72:87]
    s_add_u32 s50, s50, 0x1000
    s_and_b32 s50, s50, 0x7fff
    s_add_u32 s51, s51, 0x4000
    s_add_u32 s52, s50, s56
    s_mov_b32 m0, s51
    s_nop 0
    buffer_load_dwordx4 v0, s[4:7], s52 offen offset:0 lds
    buffer_load_dwordx4 v0, s[4:7], s52 offen offset:1024 lds
    v_exp_f32 v52, v52
    v_exp_f32 v53, v53
    v_exp_f32 v54, v54
    v_exp_f32 v55, v55
    v_cvt_pk_bf16_f32 v48, v48, v49
    v_cvt_pk_bf16_f32 v49, v50, v51
    v_cvt_pk_bf16_f32 v50, v52, v53
    v_cvt_pk_bf16_f32 v51, v54, v55
    v_exp_f32 v56, v56
    v_exp_f32 v57, v57
    v_mfma_f32_32x32x16_bf16 v[72:87], v[28:31], v[48:51], v[72:87]
    v_exp_f32 v58, v58
    v_exp_f32 v59, v59
    v_exp_f32 v60, v60
    v_exp_f32 v61, v61
    s_waitcnt lgkmcnt(0)
    v_mfma_f32_32x32x16_bf16 v[40:55], v[16:19], v[8:11], 0
    ds_read_b128 v[20:23], v2 offset:30720
    s_mov_b64 exec, s[38:39]
    ds_read_b128 v[24:27], v2 offset:29696
    ds_read_b128 v[28:31], v2 offset:29952
    s_mov_b64 exec, -1
    v_exp_f32 v62, v62
    v_exp_f32 v63, v63
    v_exp_f32 v64, v64
    v_cvt_pk_bf16_f32 v56, v56, v57
    v_cvt_pk_bf16_f32 v57, v58, v59
    v_cvt_pk_bf16_f32 v58, v60, v61
    v_cvt_pk_bf16_f32 v59, v62, v63
    v_exp_f32 v65, v65
    v_exp_f32 v66, v66
    v_exp_f32 v67, v67
    v_mfma_f32_32x32x16_bf16 v[72:87], v[32:35], v[56:59], v[72:87]
    s_add_u32 s50, s50, 0x1000
    s_and_b32 s50, s50, 0x7fff
    s_add_u32 s51, s51, 0x4000
    s_add_u32 s52, s50, s56
    s_mov_b32 m0, s51
    s_nop 0
    buffer_load_dwordx4 v0, s[4:7], s52 offen offset:0 lds
    buffer_load_dwordx4 v0, s[4:7], s52 offen offset:1024 lds
    v_exp_f32 v68, v68
    v_exp_f32 v69, v69
    v_exp_f32 v70, v70
    v_exp_f32 v71, v71
    v_cvt_pk_bf16_f32 v64, v64, v65
    v_cvt_pk_bf16_f32 v65, v66, v67
    v_cvt_pk_bf16_f32 v66, v68, v69
    v_cvt_pk_bf16_f32 v67, v70, v71
    v_exp_f32 v40, v40
    v_exp_f32 v41, v41
    v_mfma_f32_32x32x16_bf16 v[72:87], v[36:39], v[64:67], v[72:87]
    v_exp_f32 v42, v42
    v_exp_f32 v43, v43
    v_exp_f32 v44, v44
    v_exp_f32 v45, v45
    s_waitcnt vmcnt(4)
    s_barrier
    s_waitcnt lgkmcnt(0)
    v_mfma_f32_32x32x16_bf16 v[56:71], v[20:23], v[8:11], 0
    ds_read_b128 v[16:19], v2 offset:32768
    s_mov_b64 exec, s[38:39]
    ds_read_b128 v[32:35], v2 offset:31744
    ds_read_b128 v[36:39], v2 offset:32000
    s_mov_b64 exec, -1
    v_exp_f32 v46, v46
    v_exp_f32 v47, v47
    v_exp_f32 v48, v48
    v_cvt_pk_bf16_f32 v40, v40, v41
    v_cvt_pk_bf16_f32 v41, v42, v43
    v_cvt_pk_bf16_f32 v42, v44, v45
    v_cvt_pk_bf16_f32 v43, v46, v47
    v_exp_f32 v49, v49
    v_exp_f32 v50, v50
    v_exp_f32 v51, v51
    v_mfma_f32_32x32x16_bf16 v[72:87], v[24:27], v[40:43], v[72:87]
    s_add_u32 s50, s50, 0x1000
    s_and_b32 s50, s50, 0x7fff
    s_add_u32 s51, s51, 0x4000
    s_add_u32 s52, s50, s56
    s_mov_b32 m0, s51
    s_nop 0
    buffer_load_dwordx4 v0, s[4:7], s52 offen offset:0 lds
    buffer_load_dwordx4 v0, s[4:7], s52 offen offset:1024 lds
    v_exp_f32 v52, v52
    v_exp_f32 v53, v53
    v_exp_f32 v54, v54
    v_exp_f32 v55, v55
    v_cvt_pk_bf16_f32 v48, v48, v49
    v_cvt_pk_bf16_f32 v49, v50, v51
    v_cvt_pk_bf16_f32 v50, v52, v53
    v_cvt_pk_bf16_f32 v51, v54, v55
    s_cmp_lt_u32 s20, 4
    s_cbranch_scc1 L_pr_25
    s_setprio 1
L_pr_25:
    v_exp_f32 v56, v56
    v_exp_f32 v57, v57
    v_mfma_f32_32x32x16_bf16 v[72:87], v[28:31], v[48:51], v[72:87]
    v_exp_f32 v58, v58
    v_exp_f32 v59, v59
    v_exp_f32 v60, v60
    v_exp_f32 v61, v61
    s_waitcnt lgkmcnt(0)
    v_mfma_f32_32x32x16_bf16 v[40:55], v[16:19], v[8:11], 0
    ds_read_b128 v[20:23], v2 offset:34816
    s_mov_b64 exec, s[38:39]
    ds_read_b128 v[24:27], v2 offset:33792
    ds_read_b128 v[28:31], v2 offset:34048
    s_mov_b64 exec, -1
    v_exp_f32 v62, v62
    v_exp_f32 v63, v63
    v_exp_f32 v64, v64
    v_cvt_pk_bf16_f32 v56, v56, v57
    v_cvt_pk_bf16_f32 v57, v58, v59
    v_cvt_pk_bf16_f32 v58, v60, v61
    v_cvt_pk_bf16_f32 v59, v62, v63
    v_exp_f32 v65, v65
    v_exp_f32 v66, v66
    v_exp_f32 v67, v67
    v_mfma_f32_32x32x16_bf16 v[72:87], v[32:35], v[56:59], v[72:87]
    s_add_u32 s50, s50, 0x1000
    s_and_b32 s50, s50, 0x7fff
    s_add_u32 s51, s51, 0x4000
    s_add_u32 s52, s50, s56
    s_mov_b32 m0, s51
    s_nop 0
    buffer_load_dwordx4 v0, s[4:7], s52 offen offset:0 lds
    buffer_load_dwordx4 v0, s[4:7], s52 offen offset:1024 lds
    v_exp_f32 v68, v68
    v_exp_f32 v69, v69
    v_exp_f32 v70, v70
    v_exp_f32 v71, v71
    v_cvt_pk_bf16_f32 v64, v64, v65
    v_cvt_pk_bf16_f32 v65, v66, v67
    v_cvt_pk_bf16_f32 v66, v68, v69
    v_cvt_pk_bf16_f32 v67, v70, v71
    v_exp_f32 v40, v40
    v_exp_f32 v41, v41
    v_mfma_f32_32x32x16_bf16 v[72:87], v[36:39], v[64:67], v[72:87]
    v_exp_f32 v42, v42
    v_exp_f32 v43, v43
    v_exp_f32 v44, v44
    v_exp_f32 v45, v45
    s_waitcnt lgkmcnt(0)
    v_mfma_f32_32x32x16_bf16 v[56:71], v[20:23], v[8:11], 0
    ds_read_b128 v[16:19], v2 offset:36864
    s_mov_b64 exec, s[38:39]
    ds_read_b128 v[32:35], v2 offset:35840
    ds_read_b128 v[36:39], v2 offset:36096
    s_mov_b64 exec, -1
    v_exp_f32 v46, v46
    v_exp_f32 v47, v47
    v_exp_f32 v48, v48
    v_cvt_pk_bf16_f32 v40, v40, v41
    v_cvt_pk_bf16_f32 v41, v42, v43
    v_cvt_pk_bf16_f32 v42, v44, v45
    v_cvt_pk_bf16_f32 v43, v46, v47
    v_exp_f32 v49, v49
    v_exp_f32 v50, v50
    v_exp_f32 v51, v51
    v_mfma_f32_32x32x16_bf16 v[72:87], v[24:27], v[40:43], v[72:87]
    s_add_u32 s50, s50, 0x1000
    s_and_b32 s50, s50, 0x7fff
    s_add_u32 s51, s51, 0x4000
    s_add_u32 s52, s50, s56
    s_mov_b32 m0, s51
    s_nop 0
    buffer_load_dwordx4 v0, s[4:7], s52 offen offset:0 lds
    buffer_load_dwordx4 v0, s[4:7], s52 offen offset:1024 lds
    v_exp_f32 v52, v52
    v_exp_f32 v53, v53
    v_exp_f32 v54, v54
    v_exp_f32 v55, v55
    v_cvt_pk_bf16_f32 v48, v48, v49
    v_cvt_pk_bf16_f32 v49, v50, v51
    v_cvt_pk_bf16_f32 v50, v52, v53
    v_cvt_pk_bf16_f32 v51, v54, v55
    v_exp_f32 v56, v56
    v_exp_f32 v57, v57
    v_mfma_f32_32x32x16_bf16 v[72:87], v[28:31], v[48:51], v[72:87]
    v_exp_f32 v58, v58
    v_exp_f32 v59, v59
    v_exp_f32 v60, v60
    v_exp_f32 v61, v61
    s_waitcnt lgkmcnt(0)
    v_mfma_f32_32x32x16_bf16 v[40:55], v[16:19], v[8:11], 0
    ds_read_b128 v[20:23], v2 offset:38912
    s_mov_b64 exec, s[38:39]
    ds_read_b128 v[24:27], v2 offset:37888
    ds_read_b128 v[28:31], v2 offset:38144
    s_mov_b64 exec, -1
    v_exp_f32 v62, v62
    v_exp_f32 v63, v63
    v_exp_f32 v64, v64
    v_cvt_pk_bf16_f32 v56, v56, v57
    v_cvt_pk_bf16_f32 v57, v58, v59
    v_cvt_pk_bf16_f32 v58, v60, v61
    v_cvt_pk_bf16_f32 v59, v62, v63
    v_exp_f32 v65, v65
    v_exp_f32 v66, v66
    v_exp_f32 v67, v67
    v_mfma_f32_32x32x16_bf16 v[72:87], v[32:35], v[56:59], v[72:87]
    s_add_u32 s26, s26, 4096
    buffer_load_dwordx4 v[128:131], v0, s[4:7], s26 offen offset:0
    buffer_load_dwordx4 v[132:135], v0, s[4:7], s26 offen offset:1024
    v_exp_f32 v68, v68
    v_exp_f32 v69, v69
    v_exp_f32 v70, v70
    v_exp_f32 v71, v71
    v_cvt_pk_bf16_f32 v64, v64, v65
    v_cvt_pk_bf16_f32 v65, v66, v67
    v_cvt_pk_bf16_f32 v66, v68, v69
    v_cvt_pk_bf16_f32 v67, v70, v71
    v_exp_f32 v40, v40
    v_exp_f32 v41, v41
    v_mfma_f32_32x32x16_bf16 v[72:87], v[36:39], v[64:67], v[72:87]
    v_exp_f32 v42, v42
    v_exp_f32 v43, v43
    v_exp_f32 v44, v44
    v_exp_f32 v45, v45
    s_waitcnt lgkmcnt(0)
    v_mfma_f32_32x32x16_bf16 v[56:71], v[20:23], v[8:11], 0
    ds_read_b128 v[16:19], v2 offset:40960
    s_mov_b64 exec, s[38:39]
    ds_read_b128 v[32:35], v2 offset:39936
    ds_read_b128 v[36:39], v2 offset:40192
    s_mov_b64 exec, -1
    v_exp_f32 v46, v46
    v_exp_f32 v47, v47
    v_exp_f32 v48, v48
    v_cvt_pk_bf16_f32 v40, v40, v41
    v_cvt_pk_bf16_f32 v41, v42, v43
    v_cvt_pk_bf16_f32 v42, v44, v45
    v_cvt_pk_bf16_f32 v43, v46, v47
    v_exp_f32 v49, v49
    v_exp_f32 v50, v50
    v_exp_f32 v51, v51
    v_mfma_f32_32x32x16_bf16 v[72:87], v[24:27], v[40:43], v[72:87]
    buffer_load_dwordx4 v[136:139], v0, s[4:7], s26 offen offset:2048
    buffer_load_dwordx4 v[140:143], v0, s[4:7], s26 offen offset:3072
    v_exp_f32 v52, v52
    v_exp_f32 v53, v53
    v_exp_f32 v54, v54
    v_exp_f32 v55, v55
    v_cvt_pk_bf16_f32 v48, v48, v49
    v_cvt_pk_bf16_f32 v49, v50, v51
    v_cvt_pk_bf16_f32 v50, v52, v53
    v_cvt_pk_bf16_f32 v51, v54, v55
    v_exp_f32 v56, v56
    v_exp_f32 v57, v57
    v_mfma_f32_32x32x16_bf16 v[72:87], v[28:31], v[48:51], v[72:87]
    v_exp_f32 v58, v58
    v_exp_f32 v59, v59
    v_exp_f32 v60, v60
    v_exp_f32 v61, v61
    s_waitcnt lgkmcnt(0)
    v_mfma_f32_32x32x16_bf16 v[40:55], v[16:19], v[8:11], 0
    ds_read_b128 v[20:23], v2 offset:43008
    s_mov_b64 exec, s[38:39]
    ds_read_b128 v[24:27], v2 offset:41984
    ds_read_b128 v[28:31], v2 offset:42240
    s_mov_b64 exec, -1
    v_exp_f32 v62, v62
    v_exp_f32 v63, v63
    v_exp_f32 v64, v64
    v_cvt_pk_bf16_f32 v56, v56, v57
    v_cvt_pk_bf16_f32 v57, v58, v59
    v_cvt_pk_bf16_f32 v58, v60, v61
    v_cvt_pk_bf16_f32 v59, v62, v63
    v_exp_f32 v65, v65
    v_exp_f32 v66, v66
    v_exp_f32 v67, v67
    v_mfma_f32_32x32x16_bf16 v[72:87], v[32:35], v[56:59], v[72:87]
    s_add_u32 s26, s26, 4096
    buffer_load_dwordx4 v[144:147], v0, s[4:7], s26 offen offset:0
    buffer_load_dwordx4 v[148:151], v0, s[4:7], s26 offen offset:1024
    v_exp_f32 v68, v68
    v_exp_f32 v69, v69
    v_exp_f32 v70, v70
    v_exp_f32 v71, v71
    v_cvt_pk_bf16_f32 v64, v64, v65
    v_cvt_pk_bf16_f32 v65, v66, v67
    v_cvt_pk_bf16_f32 v66, v68, v69
    v_cvt_pk_bf16_f32 v67, v70, v71
    s_setprio 0
    v_exp_f32 v40, v40
    v_exp_f32 v41, v41
    v_mfma_f32_32x32x16_bf16 v[72:87], v[36:39], v[64:67], v[72:87]
    v_exp_f32 v42, v42
    v_exp_f32 v43, v43
    v_exp_f32 v44, v44
    v_exp_f32 v45, v45
    s_waitcnt lgkmcnt(0)
    v_mfma_f32_32x32x16_bf16 v[56:71], v[20:23], v[8:11], 0
    ds_read_b128 v[16:19], v2 offset:45056
    s_mov_b64 exec, s[38:39]
    ds_read_b128 v[32:35], v2 offset:44032
    ds_read_b128 v[36:39], v2 offset:44288
    s_mov_b64 exec, -1
    v_exp_f32 v46, v46
    v_exp_f32 v47, v47
    v_exp_f32 v48, v48
    v_cvt_pk_bf16_f32 v40, v40, v41
    v_cvt_pk_bf16_f32 v41, v42, v43
    v_cvt_pk_bf16_f32 v42, v44, v45
    v_cvt_pk_bf16_f32 v43, v46, v47
    v_exp_f32 v49, v49
    v_exp_f32 v50, v50
    v_exp_f32 v51, v51
    v_mfma_f32_32x32x16_bf16 v[72:87], v[24:27], v[40:43], v[72:87]
    buffer_load_dwordx4 v[152:155], v0, s[4:7], s26 offen offset:2048
    buffer_load_dwordx4 v[156:159], v0, s[4:7], s26 offen offset:3072
    v_exp_f32 v52, v52
    v_exp_f32 v53, v53
    v_exp_f32 v54, v54
    v_exp_f32 v55, v55
    v_cvt_pk_bf16_f32 v48, v48, v49
    v_cvt_pk_bf16_f32 v49, v50, v51
    v_cvt_pk_bf16_f32 v50, v52, v53
    v_cvt_pk_bf16_f32 v51, v54, v55
    v_exp_f32 v56, v56
    v_exp_f32 v57, v57
    v_mfma_f32_32x32x16_bf16 v[72:87], v[28:31], v[48:51], v[72:87]
    v_exp_f32 v58, v58
    v_exp_f32 v59, v59
    v_exp_f32 v60, v60
    v_exp_f32 v61, v61
    s_waitcnt lgkmcnt(0)
    v_mfma_f32_32x32x16_bf16 v[40:55], v[16:19], v[8:11], 0
    ds_read_b128 v[20:23], v2 offset:47104
    s_mov_b64 exec, s[38:39]
    ds_read_b128 v[24:27], v2 offset:46080
    ds_read_b128 v[28:31], v2 offset:46336
    s_mov_b64 exec, -1
    v_exp_f32 v62, v62
    v_exp_f32 v63, v63
    v_exp_f32 v64, v64
    v_cvt_pk_bf16_f32 v56, v56, v57
    v_cvt_pk_bf16_f32 v57, v58, v59
    v_cvt_pk_bf16_f32 v58, v60, v61
    v_cvt_pk_bf16_f32 v59, v62, v63
    v_exp_f32 v65, v65
    v_exp_f32 v66, v66
    v_exp_f32 v67, v67
    v_mfma_f32_32x32x16_bf16 v[72:87], v[32:35], v[56:59], v[72:87]
    s_lshl_b32 s28, s32, 15
    s_add_u32 s28, s28, 0x100000
    buffer_load_dwordx4 v[160:163], v0, s[4:7], s28 offen offset:0
    buffer_load_dwordx4 v[164:167], v0, s[4:7], s28 offen offset:1024
    v_exp_f32 v68, v68
    v_exp_f32 v69, v69
    v_exp_f32 v70, v70
    v_exp_f32 v71, v71
    v_cvt_pk_bf16_f32 v64, v64, v65
    v_cvt_pk_bf16_f32 v65, v66, v67
    v_cvt_pk_bf16_f32 v66, v68, v69
    v_cvt_pk_bf16_f32 v67, v70, v71
    v_exp_f32 v40, v40
    v_exp_f32 v41, v41
    v_mfma_f32_32x32x16_bf16 v[72:87], v[36:39], v[64:67], v[72:87]
    v_exp_f32 v42, v42
    v_exp_f32 v43, v43
    v_exp_f32 v44, v44
    v_exp_f32 v45, v45
    s_waitcnt vmcnt(10)
    s_barrier
    s_waitcnt lgkmcnt(0)
    v_mfma_f32_32x32x16_bf16 v[56:71], v[20:23], v[8:11], 0
    ds_read_b128 v[16:19], v2 offset:49152
    s_mov_b64 exec, s[38:39]
    ds_read_b128 v[32:35], v2 offset:48128
    ds_read_b128 v[36:39], v2 offset:48384
    s_mov_b64 exec, -1
    v_exp_f32 v46, v46
    v_exp_f32 v47, v47
    v_exp_f32 v48, v48
    v_cvt_pk_bf16_f32 v40, v40, v41
    v_cvt_pk_bf16_f32 v41, v42, v43
    v_cvt_pk_bf16_f32 v42, v44, v45
    v_cvt_pk_bf16_f32 v43, v46, v47
    v_exp_f32 v49, v49
    v_exp_f32 v50, v50
    v_exp_f32 v51, v51
    v_mfma_f32_32x32x16_bf16 v[72:87], v[24:27], v[40:43], v[72:87]
    buffer_load_dwordx4 v[224:227], v0, s[4:7], s28 offen offset:2048
    buffer_load_dwordx4 v[228:231], v0, s[4:7], s28 offen offset:3072
    v_exp_f32 v52, v52
    v_exp_f32 v53, v53
    v_exp_f32 v54, v54
    v_exp_f32 v55, v55
    v_cvt_pk_bf16_f32 v48, v48, v49
    v_cvt_pk_bf16_f32 v49, v50, v51
    v_cvt_pk_bf16_f32 v50, v52, v53
    v_cvt_pk_bf16_f32 v51, v54, v55
    s_cmp_lt_u32 s20, 4
    s_cbranch_scc1 L_pr_26
    s_setprio 1
L_pr_26:
    v_exp_f32 v56, v56
    v_exp_f32 v57, v57
    v_mfma_f32_32x32x16_bf16 v[72:87], v[28:31], v[48:51], v[72:87]
    v_exp_f32 v58, v58
    v_exp_f32 v59, v59
    v_exp_f32 v60, v60
    v_exp_f32 v61, v61
    s_waitcnt lgkmcnt(0)
    v_mfma_f32_32x32x16_bf16 v[40:55], v[16:19], v[8:11], 0
    ds_read_b128 v[20:23], v2 offset:51200
    s_mov_b64 exec, s[38:39]
    ds_read_b128 v[24:27], v2 offset:50176
    ds_read_b128 v[28:31], v2 offset:50432
    s_mov_b64 exec, -1
    v_exp_f32 v62, v62
    v_exp_f32 v63, v63
    v_exp_f32 v64, v64
    v_cvt_pk_bf16_f32 v56, v56, v57
    v_cvt_pk_bf16_f32 v57, v58, v59
    v_cvt_pk_bf16_f32 v58, v60, v61
    v_cvt_pk_bf16_f32 v59, v62, v63
    v_exp_f32 v65, v65
    v_exp_f32 v66, v66
    v_exp_f32 v67, v67
    v_mfma_f32_32x32x16_bf16 v[72:87], v[32:35], v[56:59], v[72:87]
    s_add_u32 s28, s28, 4096
    buffer_load_dwordx4 v[168:171], v0, s[4:7], s28 offen offset:0
    buffer_load_dwordx4 v[172:175], v0, s[4:7], s28 offen offset:1024
    v_exp_f32 v68, v68
    v_exp_f32 v69, v69
    v_exp_f32 v70, v70
    v_exp_f32 v71, v71
    v_cvt_pk_bf16_f32 v64, v64, v65
    v_cvt_pk_bf16_f32 v65, v66, v67
    v_cvt_pk_bf16_f32 v66, v68, v69
    v_cvt_pk_bf16_f32 v67, v70, v71
    v_exp_f32 v40, v40
    v_exp_f32 v41, v41
    v_mfma_f32_32x32x16_bf16 v[72:87], v[36:39], v[64:67], v[72:87]
    v_exp_f32 v42, v42
    v_exp_f32 v43, v43
    v_exp_f32 v44, v44
    v_exp_f32 v45, v45
    s_waitcnt lgkmcnt(0)
    v_mfma_f32_32x32x16_bf16 v[56:71], v[20:23], v[8:11], 0
    ds_read_b128 v[16:19], v2 offset:53248
    s_mov_b64 exec, s[38:39]
    ds_read_b128 v[32:35], v2 offset:52224
    ds_read_b128 v[36:39], v2 offset:52480
    s_mov_b64 exec, -1
    v_exp_f32 v46, v46
    v_exp_f32 v47, v47
    v_exp_f32 v48, v48
    v_cvt_pk_bf16_f32 v40, v40, v41
    v_cvt_pk_bf16_f32 v41, v42, v43
    v_cvt_pk_bf16_f32 v42, v44, v45
    v_cvt_pk_bf16_f32 v43, v46, v47
    v_exp_f32 v49, v49
    v_exp_f32 v50, v50
    v_exp_f32 v51, v51
    v_mfma_f32_32x32x16_bf16 v[72:87], v[24:27], v[40:43], v[72:87]
    buffer_load_dwordx4 v[232:235], v0, s[4:7], s28 offen offset:2048
    buffer_load_dwordx4 v[236:239], v0, s[4:7], s28 offen offset:3072
    v_exp_f32 v52, v52
    v_exp_f32 v53, v53
    v_exp_f32 v54, v54
    v_exp_f32 v55, v55
    v_cvt_pk_bf16_f32 v48, v48, v49
    v_cvt_pk_bf16_f32 v49, v50, v51
    v_cvt_pk_bf16_f32 v50, v52, v53
    v_cvt_pk_bf16_f32 v51, v54, v55
    v_exp_f32 v56, v56
    v_exp_f32 v57, v57
    v_mfma_f32_32x32x16_bf16 v[72:87], v[28:31], v[48:51], v[72:87]
    v_exp_f32 v58, v58
    v_exp_f32 v59, v59
    v_exp_f32 v60, v60
    v_exp_f32 v61, v61
    s_waitcnt lgkmcnt(0)
    v_mfma_f32_32x32x16_bf16 v[40:55], v[16:19], v[8:11], 0
    ds_read_b128 v[20:23], v2 offset:55296
    s_mov_b64 exec, s[38:39]
    ds_read_b128 v[24:27], v2 offset:54272
    ds_read_b128 v[28:31], v2 offset:54528
    s_mov_b64 exec, -1
    v_exp_f32 v62, v62
    v_exp_f32 v63, v63
    v_exp_f32 v64, v64
    v_cvt_pk_bf16_f32 v56, v56, v57
    v_cvt_pk_bf16_f32 v57, v58, v59
    v_cvt_pk_bf16_f32 v58, v60, v61
    v_cvt_pk_bf16_f32 v59, v62, v63
    v_exp_f32 v65, v65
    v_exp_f32 v66, v66
    v_exp_f32 v67, v67
    v_mfma_f32_32x32x16_bf16 v[72:87], v[32:35], v[56:59], v[72:87]
    s_add_u32 s28, s28, 4096
    buffer_load_dwordx4 v[176:179], v0, s[4:7], s28 offen offset:0
    buffer_load_dwordx4 v[180:183], v0, s[4:7], s28 offen offset:1024
    v_exp_f32 v68, v68
    v_exp_f32 v69, v69
    v_exp_f32 v70, v70
    v_exp_f32 v71, v71
    v_cvt_pk_bf16_f32 v64, v64, v65
    v_cvt_pk_bf16_f32 v65, v66, v67
    v_cvt_pk_bf16_f32 v66, v68, v69
    v_cvt_pk_bf16_f32 v67, v70, v71
    v_exp_f32 v40, v40
    v_exp_f32 v41, v41
    v_mfma_f32_32x32x16_bf16 v[72:87], v[36:39], v[64:67], v[72:87]
    v_exp_f32 v42, v42
    v_exp_f32 v43, v43
    v_exp_f32 v44, v44
    v_exp_f32 v45, v45
    s_waitcnt lgkmcnt(0)
    v_mfma_f32_32x32x16_bf16 v[56:71], v[20:23], v[8:11], 0
    ds_read_b128 v[16:19], v2 offset:57344
    s_mov_b64 exec, s[38:39]
    ds_read_b128 v[32:35], v2 offset:56320
    ds_read_b128 v[36:39], v2 offset:56576
    s_mov_b64 exec, -1
    v_exp_f32 v46, v46
    v_exp_f32 v47, v47
    v_exp_f32 v48, v48
    v_cvt_pk_bf16_f32 v40, v40, v41
    v_cvt_pk_bf16_f32 v41, v42, v43
    v_cvt_pk_bf16_f32 v42, v44, v45
    v_cvt_pk_bf16_f32 v43, v46, v47
    v_exp_f32 v49, v49
    v_exp_f32 v50, v50
    v_exp_f32 v51, v51
    v_mfma_f32_32x32x16_bf16 v[72:87], v[24:27], v[40:43], v[72:87]
    buffer_load_dwordx4 v[240:243], v0, s[4:7], s28 offen offset:2048
    buffer_load_dwordx4 v[244:247], v0, s[4:7], s28 offen offset:3072
    v_exp_f32 v52, v52
    v_exp_f32 v53, v53
    v_exp_f32 v54, v54
    v_exp_f32 v55, v55
    v_cvt_pk_bf16_f32 v48, v48, v49
    v_cvt_pk_bf16_f32 v49, v50, v51
    v_cvt_pk_bf16_f32 v50, v52, v53
    v_cvt_pk_bf16_f32 v51, v54, v55
    v_exp_f32 v56, v56
    v_exp_f32 v57, v57
    v_mfma_f32_32x32x16_bf16 v[72:87], v[28:31], v[48:51], v[72:87]
    v_exp_f32 v58, v58
    v_exp_f32 v59, v59
    v_exp_f32 v60, v60
    v_exp_f32 v61, v61
    s_waitcnt lgkmcnt(0)
    v_mfma_f32_32x32x16_bf16 v[40:55], v[16:19], v[8:11], 0
    ds_read_b128 v[20:23], v2 offset:59392
    s_mov_b64 exec, s[38:39]
    ds_read_b128 v[24:27], v2 offset:58368
    ds_read_b128 v[28:31], v2 offset:58624
    s_mov_b64 exec, -1
    v_exp_f32 v62, v62
    v_exp_f32 v63, v63
    v_exp_f32 v64, v64
    v_cvt_pk_bf16_f32 v56, v56, v57
    v_cvt_pk_bf16_f32 v57, v58, v59
    v_cvt_pk_bf16_f32 v58, v60, v61
    v_cvt_pk_bf16_f32 v59, v62, v63
    v_exp_f32 v65, v65
    v_exp_f32 v66, v66
    v_exp_f32 v67, v67
    v_mfma_f32_32x32x16_bf16 v[72:87], v[32:35], v[56:59], v[72:87]
    s_add_u32 s28, s28, 4096
    buffer_load_dwordx4 v[184:187], v0, s[4:7], s28 offen offset:0
    buffer_load_dwordx4 v[188:191], v0, s[4:7], s28 offen offset:1024
    v_exp_f32 v68, v68
    v_exp_f32 v69, v69
    v_exp_f32 v70, v70
    v_exp_f32 v71, v71
    v_cvt_pk_bf16_f32 v64, v64, v65
    v_cvt_pk_bf16_f32 v65, v66, v67
    v_cvt_pk_bf16_f32 v66, v68, v69
    v_cvt_pk_bf16_f32 v67, v70, v71
    v_exp_f32 v40, v40
    v_exp_f32 v41, v41
    v_mfma_f32_32x32x16_bf16 v[72:87], v[36:39], v[64:67], v[72:87]
    v_exp_f32 v42, v42
    v_exp_f32 v43, v43
    v_exp_f32 v44, v44
    v_exp_f32 v45, v45
    s_waitcnt lgkmcnt(0)
    v_mfma_f32_32x32x16_bf16 v[56:71], v[20:23], v[8:11], 0
    ds_read_b128 v[16:19], v2 offset:61440
    s_mov_b64 exec, s[38:39]
    ds_read_b128 v[32:35], v2 offset:60416
    ds_read_b128 v[36:39], v2 offset:60672
    s_mov_b64 exec, -1
    v_exp_f32 v46, v46
    v_exp_f32 v47, v47
    v_exp_f32 v48, v48
    v_cvt_pk_bf16_f32 v40, v40, v41
    v_cvt_pk_bf16_f32 v41, v42, v43
    v_cvt_pk_bf16_f32 v42, v44, v45
    v_cvt_pk_bf16_f32 v43, v46, v47
    v_exp_f32 v49, v49
    v_exp_f32 v50, v50
    v_exp_f32 v51, v51
    v_mfma_f32_32x32x16_bf16 v[72:87], v[24:27], v[40:43], v[72:87]
    buffer_load_dwordx4 v[248:251], v0, s[4:7], s28 offen offset:2048
    buffer_load_dwordx4 v[252:255], v0, s[4:7], s28 offen offset:3072
    v_exp_f32 v52, v52
    v_exp_f32 v53, v53
    v_exp_f32 v54, v54
    v_exp_f32 v55, v55
    v_cvt_pk_bf16_f32 v48, v48, v49
    v_cvt_pk_bf16_f32 v49, v50, v51
    v_cvt_pk_bf16_f32 v50, v52, v53
    v_cvt_pk_bf16_f32 v51, v54, v55
    v_exp_f32 v56, v56
    v_exp_f32 v57, v57
    v_mfma_f32_32x32x16_bf16 v[72:87], v[28:31], v[48:51], v[72:87]
    v_exp_f32 v58, v58
    v_exp_f32 v59, v59
    v_exp_f32 v60, v60
    v_exp_f32 v61, v61
    s_waitcnt lgkmcnt(0)
    v_mfma_f32_32x32x16_bf16 v[40:55], v[16:19], v[8:11], 0
    ds_read_b128 v[20:23], v2 offset:63488
    s_mov_b64 exec, s[38:39]
    ds_read_b128 v[24:27], v2 offset:62464
    ds_read_b128 v[28:31], v2 offset:62720
    s_mov_b64 exec, -1
    v_exp_f32 v62, v62
    v_exp_f32 v63, v63
    v_exp_f32 v64, v64
    v_cvt_pk_bf16_f32 v56, v56, v57
    v_cvt_pk_bf16_f32 v57, v58, v59
    v_cvt_pk_bf16_f32 v58, v60, v61
    v_cvt_pk_bf16_f32 v59, v62, v63
    v_exp_f32 v65, v65
    v_exp_f32 v66, v66
    v_exp_f32 v67, v67
    v_mfma_f32_32x32x16_bf16 v[72:87], v[32:35], v[56:59], v[72:87]
    s_add_u32 s28, s28, 4096
    buffer_load_dwordx4 v[192:195], v0, s[4:7], s28 offen offset:0
    buffer_load_dwordx4 v[196:199], v0, s[4:7], s28 offen offset:1024
    v_exp_f32 v68, v68
    v_exp_f32 v69, v69
    v_exp_f32 v70, v70
    v_exp_f32 v71, v71
    v_cvt_pk_bf16_f32 v64, v64, v65
    v_cvt_pk_bf16_f32 v65, v66, v67
    v_cvt_pk_bf16_f32 v66, v68, v69
    v_cvt_pk_bf16_f32 v67, v70, v71
    v_exp_f32 v40, v40
    v_exp_f32 v41, v41
    v_mfma_f32_32x32x16_bf16 v[72:87], v[36:39], v[64:67], v[72:87]
    v_exp_f32 v42, v42
    v_exp_f32 v43, v43
    v_exp_f32 v44, v44
    v_exp_f32 v45, v45
    s_waitcnt lgkmcnt(0)
    v_mfma_f32_32x32x16_bf16 v[56:71], v[20:23], v[8:11], 0
    ds_read_b128 v[16:19], v3 offset:0
    s_mov_b64 exec, s[38:39]
    ds_read_b128 v[32:35], v2 offset:64512
    ds_read_b128 v[36:39], v2 offset:64768
    s_mov_b64 exec, -1
    v_exp_f32 v46, v46
    v_exp_f32 v47, v47
    v_exp_f32 v48, v48
    v_cvt_pk_bf16_f32 v40, v40, v41
    v_cvt_pk_bf16_f32 v41, v42, v43
    v_cvt_pk_bf16_f32 v42, v44, v45
    v_cvt_pk_bf16_f32 v43, v46, v47
    v_exp_f32 v49, v49
    v_exp_f32 v50, v50
    v_exp_f32 v51, v51
    v_mfma_f32_32x32x16_bf16 v[72:87], v[24:27], v[40:43], v[72:87]
    s_add_u32 s28, s28, 4096
    buffer_load_dwordx4 v[200:203], v0, s[4:7], s28 offen offset:0
    buffer_load_dwordx4 v[204:207], v0, s[4:7], s28 offen offset:1024
    v_exp_f32 v52, v52
    v_exp_f32 v53, v53
    v_exp_f32 v54, v54
    v_exp_f32 v55, v55
    v_cvt_pk_bf16_f32 v48, v48, v49
    v_cvt_pk_bf16_f32 v49, v50, v51
    v_cvt_pk_bf16_f32 v50, v52, v53
    v_cvt_pk_bf16_f32 v51, v54, v55
    v_exp_f32 v56, v56
    v_exp_f32 v57, v57
    v_mfma_f32_32x32x16_bf16 v[72:87], v[28:31], v[48:51], v[72:87]
    v_exp_f32 v58, v58
    v_exp_f32 v59, v59
    v_exp_f32 v60, v60
    v_exp_f32 v61, v61
    s_waitcnt lgkmcnt(0)
    v_mfma_f32_32x32x16_bf16 v[40:55], v[16:19], v[8:11], 0
    ds_read_b128 v[20:23], v3 offset:2048
    s_mov_b64 exec, s[38:39]
    ds_read_b128 v[24:27], v3 offset:1024
    ds_read_b128 v[28:31], v3 offset:1280
    s_mov_b64 exec, -1
    v_exp_f32 v62, v62
    v_exp_f32 v63, v63
    v_exp_f32 v64, v64
    v_cvt_pk_bf16_f32 v56, v56, v57
    v_cvt_pk_bf16_f32 v57, v58, v59
    v_cvt_pk_bf16_f32 v58, v60, v61
    v_cvt_pk_bf16_f32 v59, v62, v63
    v_exp_f32 v65, v65
    v_exp_f32 v66, v66
    v_exp_f32 v67, v67
    v_mfma_f32_32x32x16_bf16 v[72:87], v[32:35], v[56:59], v[72:87]
    s_add_u32 s28, s28, 4096
    buffer_load_dwordx4 v[208:211], v0, s[4:7], s28 offen offset:0
    buffer_load_dwordx4 v[212:215], v0, s[4:7], s28 offen offset:1024
    v_exp_f32 v68, v68
    v_exp_f32 v69, v69
    v_exp_f32 v70, v70
    v_exp_f32 v71, v71
    v_cvt_pk_bf16_f32 v64, v64, v65
    v_cvt_pk_bf16_f32 v65, v66, v67
    v_cvt_pk_bf16_f32 v66, v68, v69
    v_cvt_pk_bf16_f32 v67, v70, v71
    v_exp_f32 v40, v40
    v_exp_f32 v41, v41
    v_mfma_f32_32x32x16_bf16 v[72:87], v[36:39], v[64:67], v[72:87]
    v_exp_f32 v42, v42
    v_exp_f32 v43, v43
    v_exp_f32 v44, v44
    v_exp_f32 v45, v45
    s_waitcnt lgkmcnt(0)
    v_mfma_f32_32x32x16_bf16 v[56:71], v[20:23], v[8:11], 0
    ds_read_b128 v[16:19], v3 offset:4096
    s_mov_b64 exec, s[38:39]
    ds_read_b128 v[32:35], v3 offset:3072
    ds_read_b128 v[36:39], v3 offset:3328
    s_mov_b64 exec, -1
    v_exp_f32 v46, v46
    v_exp_f32 v47, v47
    v_exp_f32 v48, v48
    v_cvt_pk_bf16_f32 v40, v40, v41
    v_cvt_pk_bf16_f32 v41, v42, v43
    v_cvt_pk_bf16_f32 v42, v44, v45
    v_cvt_pk_bf16_f32 v43, v46, v47
    v_exp_f32 v49, v49
    v_exp_f32 v50, v50
    v_exp_f32 v51, v51
    v_mfma_f32_32x32x16_bf16 v[72:87], v[24:27], v[40:43], v[72:87]
    s_add_u32 s28, s28, 4096
    buffer_load_dwordx4 v[216:219], v0, s[4:7], s28 offen offset:0
    buffer_load_dwordx4 v[220:223], v0, s[4:7], s28 offen offset:1024
    v_exp_f32 v52, v52
    v_exp_f32 v53, v53
    v_exp_f32 v54, v54
    v_exp_f32 v55, v55
    v_cvt_pk_bf16_f32 v48, v48, v49
    v_cvt_pk_bf16_f32 v49, v50, v51
    v_cvt_pk_bf16_f32 v50, v52, v53
    v_cvt_pk_bf16_f32 v51, v54, v55
    v_exp_f32 v56, v56
    v_exp_f32 v57, v57
    v_mfma_f32_32x32x16_bf16 v[72:87], v[28:31], v[48:51], v[72:87]
    v_exp_f32 v58, v58
    v_exp_f32 v59, v59
    v_exp_f32 v60, v60
    v_exp_f32 v61, v61
    s_waitcnt lgkmcnt(0)
    v_mfma_f32_32x32x16_bf16 v[40:55], v[16:19], v[8:11], 0
    ds_read_b128 v[20:23], v3 offset:6144
    s_mov_b64 exec, s[38:39]
    ds_read_b128 v[24:27], v3 offset:5120
    ds_read_b128 v[28:31], v3 offset:5376
    s_mov_b64 exec, -1
    v_exp_f32 v62, v62
    v_exp_f32 v63, v63
    v_exp_f32 v64, v64
    v_cvt_pk_bf16_f32 v56, v56, v57
    v_cvt_pk_bf16_f32 v57, v58, v59
    v_cvt_pk_bf16_f32 v58, v60, v61
    v_cvt_pk_bf16_f32 v59, v62, v63
    v_exp_f32 v65, v65
    v_exp_f32 v66, v66
    v_exp_f32 v67, v67
    v_mfma_f32_32x32x16_bf16 v[72:87], v[32:35], v[56:59], v[72:87]
    s_mul_i32 s27, s22, 176128
    s_add_u32 s27, s27, 0x1000000
    s_lshl_b32 s26, s32, 11
    s_add_u32 s26, s26, s27
    buffer_load_dword v90, v91, s[4:7], s26 offen
    s_add_u32 s26, s26, 88064
    buffer_load_dword v90, v91, s[4:7], s26 offen
    v_exp_f32 v68, v68
    v_exp_f32 v69, v69
    v_exp_f32 v70, v70
    v_exp_f32 v71, v71
    v_cvt_pk_bf16_f32 v64, v64, v65
    v_cvt_pk_bf16_f32 v65, v66, v67
    v_cvt_pk_bf16_f32 v66, v68, v69
    v_cvt_pk_bf16_f32 v67, v70, v71
    v_exp_f32 v40, v40
    v_exp_f32 v41, v41
    v_mfma_f32_32x32x16_bf16 v[72:87], v[36:39], v[64:67], v[72:87]
    v_exp_f32 v42, v42
    v_exp_f32 v43, v43
    v_exp_f32 v44, v44
    v_exp_f32 v45, v45
    s_waitcnt lgkmcnt(0)
    v_mfma_f32_32x32x16_bf16 v[56:71], v[20:23], v[8:11], 0
    ds_read_b128 v[16:19], v3 offset:8192
    s_mov_b64 exec, s[38:39]
    ds_read_b128 v[32:35], v3 offset:7168
    ds_read_b128 v[36:39], v3 offset:7424
    s_mov_b64 exec, -1
    v_exp_f32 v46, v46
    v_exp_f32 v47, v47
    v_exp_f32 v48, v48
    v_cvt_pk_bf16_f32 v40, v40, v41
    v_cvt_pk_bf16_f32 v41, v42, v43
    v_cvt_pk_bf16_f32 v42, v44, v45
    v_cvt_pk_bf16_f32 v43, v46, v47
    v_exp_f32 v49, v49
    v_exp_f32 v50, v50
    v_exp_f32 v51, v51
    v_mfma_f32_32x32x16_bf16 v[72:87], v[24:27], v[40:43], v[72:87]
    s_add_u32 s26, s34, 0x400000
    buffer_load_dword v90, v0, s[4:7], s26 offen
    s_and_b32 s57, s22, 7
    s_lshl_b32 s57, s57, 12
    s_add_u32 s57, s57, s54
    s_add_u32 s57, s57, 0xe20000
    buffer_load_dword v90, v91, s[4:7], s57 offen
    v_exp_f32 v52, v52
    v_exp_f32 v53, v53
    v_exp_f32 v54, v54
    v_exp_f32 v55, v55
    v_cvt_pk_bf16_f32 v48, v48, v49
    v_cvt_pk_bf16_f32 v49, v50, v51
    v_cvt_pk_bf16_f32 v50, v52, v53
    v_cvt_pk_bf16_f32 v51, v54, v55
    v_exp_f32 v56, v56
    v_exp_f32 v57, v57
    v_mfma_f32_32x32x16_bf16 v[72:87], v[28:31], v[48:51], v[72:87]
    v_exp_f32 v58, v58
    v_exp_f32 v59, v59
    v_exp_f32 v60, v60
    v_exp_f32 v61, v61
    s_waitcnt lgkmcnt(0)
    v_mfma_f32_32x32x16_bf16 v[40:55], v[16:19], v[8:11], 0
    ds_read_b128 v[20:23], v3 offset:10240
    s_mov_b64 exec, s[38:39]
    ds_read_b128 v[24:27], v3 offset:9216
    ds_read_b128 v[28:31], v3 offset:9472
    s_mov_b64 exec, -1
    v_exp_f32 v62, v62
    v_exp_f32 v63, v63
    v_exp_f32 v64, v64
    v_cvt_pk_bf16_f32 v56, v56, v57
    v_cvt_pk_bf16_f32 v57, v58, v59
    v_cvt_pk_bf16_f32 v58, v60, v61
    v_cvt_pk_bf16_f32 v59, v62, v63
    v_exp_f32 v65, v65
    v_exp_f32 v66, v66
    v_exp_f32 v67, v67
    v_mfma_f32_32x32x16_bf16 v[72:87], v[32:35], v[56:59], v[72:87]
    s_andn2_b32 s26, s31, 0x3ff
    s_add_u32 s26, s26, 0x1900000
    buffer_load_dword v90, v0, s[4:7], s26 offen
    s_andn2_b32 s26, s31, 0x3ff
    s_add_u32 s26, s26, 0x1980000
    buffer_load_dword v90, v0, s[4:7], s26 offen
    v_exp_f32 v68, v68
    v_exp_f32 v69, v69
    v_exp_f32 v70, v70
    v_exp_f32 v71, v71
    v_cvt_pk_bf16_f32 v64, v64, v65
    v_cvt_pk_bf16_f32 v65, v66, v67
    v_cvt_pk_bf16_f32 v66, v68, v69
    v_cvt_pk_bf16_f32 v67, v70, v71
    v_exp_f32 v40, v40
    v_exp_f32 v41, v41
    v_mfma_f32_32x32x16_bf16 v[72:87], v[36:39], v[64:67], v[72:87]
    v_exp_f32 v42, v42
    v_exp_f32 v43, v43
    v_exp_f32 v44, v44
    v_exp_f32 v45, v45
    s_waitcnt lgkmcnt(0)
    v_mfma_f32_32x32x16_bf16 v[56:71], v[20:23], v[8:11], 0
    ds_read_b128 v[16:19], v3 offset:12288
    s_mov_b64 exec, s[38:39]
    ds_read_b128 v[32:35], v3 offset:11264
    ds_read_b128 v[36:39], v3 offset:11520
    s_mov_b64 exec, -1
    v_exp_f32 v46, v46
    v_exp_f32 v47, v47
    v_exp_f32 v48, v48
    v_cvt_pk_bf16_f32 v40, v40, v41
    v_cvt_pk_bf16_f32 v41, v42, v43
    v_cvt_pk_bf16_f32 v42, v44, v45
    v_cvt_pk_bf16_f32 v43, v46, v47
    v_exp_f32 v49, v49
    v_exp_f32 v50, v50
    v_exp_f32 v51, v51
    v_mfma_f32_32x32x16_bf16 v[72:87], v[24:27], v[40:43], v[72:87]
    s_lshl_b32 s26, s22, 8
    s_add_u32 s26, s26, 0x1a82000
    buffer_load_dword v90, v89, s[4:7], s26 offen
    v_exp_f32 v52, v52
    v_exp_f32 v53, v53
    v_exp_f32 v54, v54
    v_exp_f32 v55, v55
    v_cvt_pk_bf16_f32 v48, v48, v49
    v_cvt_pk_bf16_f32 v49, v50, v51
    v_cvt_pk_bf16_f32 v50, v52, v53
    v_cvt_pk_bf16_f32 v51, v54, v55
    v_exp_f32 v56, v56
    v_exp_f32 v57, v57
    v_mfma_f32_32x32x16_bf16 v[72:87], v[28:31], v[48:51], v[72:87]
    v_exp_f32 v58, v58
    v_exp_f32 v59, v59
    v_exp_f32 v60, v60
    v_exp_f32 v61, v61
    s_waitcnt lgkmcnt(0)
    v_mfma_f32_32x32x16_bf16 v[40:55], v[16:19], v[8:11], 0
    ds_read_b128 v[20:23], v3 offset:14336
    s_mov_b64 exec, s[38:39]
    ds_read_b128 v[24:27], v3 offset:13312
    ds_read_b128 v[28:31], v3 offset:13568
    s_mov_b64 exec, -1
    v_exp_f32 v62, v62
    v_exp_f32 v63, v63
    v_exp_f32 v64, v64
    v_cvt_pk_bf16_f32 v56, v56, v57
    v_cvt_pk_bf16_f32 v57, v58, v59
    v_cvt_pk_bf16_f32 v58, v60, v61
    v_cvt_pk_bf16_f32 v59, v62, v63
    v_exp_f32 v65, v65
    v_exp_f32 v66, v66
    v_exp_f32 v67, v67
    v_mfma_f32_32x32x16_bf16 v[72:87], v[32:35], v[56:59], v[72:87]
    v_exp_f32 v68, v68
    v_exp_f32 v69, v69
    v_exp_f32 v70, v70
    v_exp_f32 v71, v71
    v_cvt_pk_bf16_f32 v64, v64, v65
    v_cvt_pk_bf16_f32 v65, v66, v67
    v_cvt_pk_bf16_f32 v66, v68, v69
    v_cvt_pk_bf16_f32 v67, v70, v71
    v_exp_f32 v40, v40
    v_exp_f32 v41, v41
    v_mfma_f32_32x32x16_bf16 v[72:87], v[36:39], v[64:67], v[72:87]
    v_exp_f32 v42, v42
    v_exp_f32 v43, v43
    v_exp_f32 v44, v44
    v_exp_f32 v45, v45
    s_waitcnt lgkmcnt(0)
    v_mfma_f32_32x32x16_bf16 v[56:71], v[20:23], v[8:11], 0
    ds_read_b128 v[16:19], v3 offset:16384
    s_mov_b64 exec, s[38:39]
    ds_read_b128 v[32:35], v3 offset:15360
    ds_read_b128 v[36:39], v3 offset:15616
    s_mov_b64 exec, -1
    v_exp_f32 v46, v46
    v_exp_f32 v47, v47
    v_exp_f32 v48, v48
    v_cvt_pk_bf16_f32 v40, v40, v41
    v_cvt_pk_bf16_f32 v41, v42, v43
    v_cvt_pk_bf16_f32 v42, v44, v45
    v_cvt_pk_bf16_f32 v43, v46, v47
    v_exp_f32 v49, v49
    v_exp_f32 v50, v50
    v_exp_f32 v51, v51
    v_mfma_f32_32x32x16_bf16 v[72:87], v[24:27], v[40:43], v[72:87]
    v_exp_f32 v52, v52
    v_exp_f32 v53, v53
    v_exp_f32 v54, v54
    v_exp_f32 v55, v55
    v_cvt_pk_bf16_f32 v48, v48, v49
    v_cvt_pk_bf16_f32 v49, v50, v51
    v_cvt_pk_bf16_f32 v50, v52, v53
    v_cvt_pk_bf16_f32 v51, v54, v55
    v_exp_f32 v56, v56
    v_exp_f32 v57, v57
    v_mfma_f32_32x32x16_bf16 v[72:87], v[28:31], v[48:51], v[72:87]
    v_exp_f32 v58, v58
    v_exp_f32 v59, v59
    v_exp_f32 v60, v60
    v_exp_f32 v61, v61
    s_waitcnt lgkmcnt(0)
    v_mfma_f32_32x32x16_bf16 v[40:55], v[16:19], v[8:11], 0
    ds_read_b128 v[20:23], v3 offset:18432
    s_mov_b64 exec, s[38:39]
    ds_read_b128 v[24:27], v3 offset:17408
    ds_read_b128 v[28:31], v3 offset:17664
    s_mov_b64 exec, -1
    v_exp_f32 v62, v62
    v_exp_f32 v63, v63
    v_exp_f32 v64, v64
    v_cvt_pk_bf16_f32 v56, v56, v57
    v_cvt_pk_bf16_f32 v57, v58, v59
    v_cvt_pk_bf16_f32 v58, v60, v61
    v_cvt_pk_bf16_f32 v59, v62, v63
    v_exp_f32 v65, v65
    v_exp_f32 v66, v66
    v_exp_f32 v67, v67
    v_mfma_f32_32x32x16_bf16 v[72:87], v[32:35], v[56:59], v[72:87]
    v_exp_f32 v68, v68
    v_exp_f32 v69, v69
    v_exp_f32 v70, v70
    v_exp_f32 v71, v71
    v_cvt_pk_bf16_f32 v64, v64, v65
    v_cvt_pk_bf16_f32 v65, v66, v67
    v_cvt_pk_bf16_f32 v66, v68, v69
    v_cvt_pk_bf16_f32 v67, v70, v71
    v_exp_f32 v40, v40
    v_exp_f32 v41, v41
    v_mfma_f32_32x32x16_bf16 v[72:87], v[36:39], v[64:67], v[72:87]
    v_exp_f32 v42, v42
    v_exp_f32 v43, v43
    v_exp_f32 v44, v44
    v_exp_f32 v45, v45
    s_waitcnt lgkmcnt(0)
    v_mfma_f32_32x32x16_bf16 v[56:71], v[20:23], v[8:11], 0
    ds_read_b128 v[16:19], v3 offset:20480
    s_mov_b64 exec, s[38:39]
    ds_read_b128 v[32:35], v3 offset:19456
    ds_read_b128 v[36:39], v3 offset:19712
    s_mov_b64 exec, -1
    v_exp_f32 v46, v46
    v_exp_f32 v47, v47
    v_exp_f32 v48, v48
    v_cvt_pk_bf16_f32 v40, v40, v41
    v_cvt_pk_bf16_f32 v41, v42, v43
    v_cvt_pk_bf16_f32 v42, v44, v45
    v_cvt_pk_bf16_f32 v43, v46, v47
    v_exp_f32 v49, v49
    v_exp_f32 v50, v50
    v_exp_f32 v51, v51
    v_mfma_f32_32x32x16_bf16 v[72:87], v[24:27], v[40:43], v[72:87]
    v_exp_f32 v52, v52
    v_exp_f32 v53, v53
    v_exp_f32 v54, v54
    v_exp_f32 v55, v55
    v_cvt_pk_bf16_f32 v48, v48, v49
    v_cvt_pk_bf16_f32 v49, v50, v51
    v_cvt_pk_bf16_f32 v50, v52, v53
    v_cvt_pk_bf16_f32 v51, v54, v55
    v_exp_f32 v56, v56
    v_exp_f32 v57, v57
    v_mfma_f32_32x32x16_bf16 v[72:87], v[28:31], v[48:51], v[72:87]
    v_exp_f32 v58, v58
    v_exp_f32 v59, v59
    v_exp_f32 v60, v60
    v_exp_f32 v61, v61
    s_waitcnt lgkmcnt(0)
    v_mfma_f32_32x32x16_bf16 v[40:55], v[16:19], v[8:11], 0
    ds_read_b128 v[20:23], v3 offset:22528
    s_mov_b64 exec, s[38:39]
    ds_read_b128 v[24:27], v3 offset:21504
    ds_read_b128 v[28:31], v3 offset:21760
    s_mov_b64 exec, -1
    v_exp_f32 v62, v62
    v_exp_f32 v63, v63
    v_exp_f32 v64, v64
    v_cvt_pk_bf16_f32 v56, v56, v57
    v_cvt_pk_bf16_f32 v57, v58, v59
    v_cvt_pk_bf16_f32 v58, v60, v61
    v_cvt_pk_bf16_f32 v59, v62, v63
    v_exp_f32 v65, v65
    v_exp_f32 v66, v66
    v_exp_f32 v67, v67
    v_mfma_f32_32x32x16_bf16 v[72:87], v[32:35], v[56:59], v[72:87]
    v_exp_f32 v68, v68
    v_exp_f32 v69, v69
    v_exp_f32 v70, v70
    v_exp_f32 v71, v71
    v_cvt_pk_bf16_f32 v64, v64, v65
    v_cvt_pk_bf16_f32 v65, v66, v67
    v_cvt_pk_bf16_f32 v66, v68, v69
    v_cvt_pk_bf16_f32 v67, v70, v71
    v_exp_f32 v40, v40
    v_exp_f32 v41, v41
    v_mfma_f32_32x32x16_bf16 v[72:87], v[36:39], v[64:67], v[72:87]
    v_exp_f32 v42, v42
    v_exp_f32 v43, v43
    v_exp_f32 v44, v44
    v_exp_f32 v45, v45
    s_waitcnt lgkmcnt(0)
    v_mfma_f32_32x32x16_bf16 v[56:71], v[20:23], v[8:11], 0
    ds_read_b128 v[16:19], v3 offset:24576
    s_mov_b64 exec, s[38:39]
    ds_read_b128 v[32:35], v3 offset:23552
    ds_read_b128 v[36:39], v3 offset:23808
    s_mov_b64 exec, -1
    v_exp_f32 v46, v46
    v_exp_f32 v47, v47
    v_exp_f32 v48, v48
    v_cvt_pk_bf16_f32 v40, v40, v41
    v_cvt_pk_bf16_f32 v41, v42, v43
    v_cvt_pk_bf16_f32 v42, v44, v45
    v_cvt_pk_bf16_f32 v43, v46, v47
    v_exp_f32 v49, v49
    v_exp_f32 v50, v50
    v_exp_f32 v51, v51
    v_mfma_f32_32x32x16_bf16 v[72:87], v[24:27], v[40:43], v[72:87]
    v_exp_f32 v52, v52
    v_exp_f32 v53, v53
    v_exp_f32 v54, v54
    v_exp_f32 v55, v55
    v_cvt_pk_bf16_f32 v48, v48, v49
    v_cvt_pk_bf16_f32 v49, v50, v51
    v_cvt_pk_bf16_f32 v50, v52, v53
    v_cvt_pk_bf16_f32 v51, v54, v55
    v_exp_f32 v56, v56
    v_exp_f32 v57, v57
    v_mfma_f32_32x32x16_bf16 v[72:87], v[28:31], v[48:51], v[72:87]
    v_exp_f32 v58, v58
    v_exp_f32 v59, v59
    v_exp_f32 v60, v60
    v_exp_f32 v61, v61
    s_waitcnt lgkmcnt(0)
    v_mfma_f32_32x32x16_bf16 v[40:55], v[16:19], v[8:11], 0
    ds_read_b128 v[20:23], v3 offset:26624
    s_mov_b64 exec, s[38:39]
    ds_read_b128 v[24:27], v3 offset:25600
    ds_read_b128 v[28:31], v3 offset:25856
    s_mov_b64 exec, -1
    v_exp_f32 v62, v62
    v_exp_f32 v63, v63
    v_exp_f32 v64, v64
    v_cvt_pk_bf16_f32 v56, v56, v57
    v_cvt_pk_bf16_f32 v57, v58, v59
    v_cvt_pk_bf16_f32 v58, v60, v61
    v_cvt_pk_bf16_f32 v59, v62, v63
    v_exp_f32 v65, v65
    v_exp_f32 v66, v66
    v_exp_f32 v67, v67
    v_mfma_f32_32x32x16_bf16 v[72:87], v[32:35], v[56:59], v[72:87]
    v_exp_f32 v68, v68
    v_exp_f32 v69, v69
    v_exp_f32 v70, v70
    v_exp_f32 v71, v71
    v_cvt_pk_bf16_f32 v64, v64, v65
    v_cvt_pk_bf16_f32 v65, v66, v67
    v_cvt_pk_bf16_f32 v66, v68, v69
    v_cvt_pk_bf16_f32 v67, v70, v71
    v_exp_f32 v40, v40
    v_exp_f32 v41, v41
    v_mfma_f32_32x32x16_bf16 v[72:87], v[36:39], v[64:67], v[72:87]
    v_exp_f32 v42, v42
    v_exp_f32 v43, v43
    v_exp_f32 v44, v44
    v_exp_f32 v45, v45
    s_waitcnt lgkmcnt(0)
    v_mfma_f32_32x32x16_bf16 v[56:71], v[20:23], v[8:11], 0
    ds_read_b128 v[16:19], v3 offset:28672
    s_mov_b64 exec, s[38:39]
    ds_read_b128 v[32:35], v3 offset:27648
    ds_read_b128 v[36:39], v3 offset:27904
    s_mov_b64 exec, -1
    v_exp_f32 v46, v46
    v_exp_f32 v47, v47
    v_exp_f32 v48, v48
    v_cvt_pk_bf16_f32 v40, v40, v41
    v_cvt_pk_bf16_f32 v41, v42, v43
    v_cvt_pk_bf16_f32 v42, v44, v45
    v_cvt_pk_bf16_f32 v43, v46, v47
    v_exp_f32 v49, v49
    v_exp_f32 v50, v50
    v_exp_f32 v51, v51
    v_mfma_f32_32x32x16_bf16 v[72:87], v[24:27], v[40:43], v[72:87]
    v_exp_f32 v52, v52
    v_exp_f32 v53, v53
    v_exp_f32 v54, v54
    v_exp_f32 v55, v55
    v_cvt_pk_bf16_f32 v48, v48, v49
    v_cvt_pk_bf16_f32 v49, v50, v51
    v_cvt_pk_bf16_f32 v50, v52, v53
    v_cvt_pk_bf16_f32 v51, v54, v55
    v_exp_f32 v56, v56
    v_exp_f32 v57, v57
    v_mfma_f32_32x32x16_bf16 v[72:87], v[28:31], v[48:51], v[72:87]
    v_exp_f32 v58, v58
    v_exp_f32 v59, v59
    v_exp_f32 v60, v60
    v_exp_f32 v61, v61
    s_waitcnt lgkmcnt(0)
    v_mfma_f32_32x32x16_bf16 v[40:55], v[16:19], v[8:11], 0
    ds_read_b128 v[20:23], v3 offset:30720
    s_mov_b64 exec, s[38:39]
    ds_read_b128 v[24:27], v3 offset:29696
    ds_read_b128 v[28:31], v3 offset:29952
    s_mov_b64 exec, -1
    v_exp_f32 v62, v62
    v_exp_f32 v63, v63
    v_exp_f32 v64, v64
    v_cvt_pk_bf16_f32 v56, v56, v57
    v_cvt_pk_bf16_f32 v57, v58, v59
    v_cvt_pk_bf16_f32 v58, v60, v61
    v_cvt_pk_bf16_f32 v59, v62, v63
    v_exp_f32 v65, v65
    v_exp_f32 v66, v66
    v_exp_f32 v67, v67
    v_mfma_f32_32x32x16_bf16 v[72:87], v[32:35], v[56:59], v[72:87]
    v_exp_f32 v68, v68
    v_exp_f32 v69, v69
    v_exp_f32 v70, v70
    v_exp_f32 v71, v71
    v_cvt_pk_bf16_f32 v64, v64, v65
    v_cvt_pk_bf16_f32 v65, v66, v67
    v_cvt_pk_bf16_f32 v66, v68, v69
    v_cvt_pk_bf16_f32 v67, v70, v71
    v_exp_f32 v40, v40
    v_exp_f32 v41, v41
    v_mfma_f32_32x32x16_bf16 v[72:87], v[36:39], v[64:67], v[72:87]
    v_exp_f32 v42, v42
    v_exp_f32 v43, v43
    v_exp_f32 v44, v44
    v_exp_f32 v45, v45
    s_waitcnt lgkmcnt(0)
    v_mfma_f32_32x32x16_bf16 v[56:71], v[20:23], v[8:11], 0
    ds_read_b128 v[16:19], v3 offset:32768
    s_mov_b64 exec, s[38:39]
    ds_read_b128 v[32:35], v3 offset:31744
    ds_read_b128 v[36:39], v3 offset:32000
    s_mov_b64 exec, -1
    v_exp_f32 v46, v46
    v_exp_f32 v47, v47
    v_exp_f32 v48, v48
    v_cvt_pk_bf16_f32 v40, v40, v41
    v_cvt_pk_bf16_f32 v41, v42, v43
    v_cvt_pk_bf16_f32 v42, v44, v45
    v_cvt_pk_bf16_f32 v43, v46, v47
    v_exp_f32 v49, v49
    v_exp_f32 v50, v50
    v_exp_f32 v51, v51
    v_mfma_f32_32x32x16_bf16 v[72:87], v[24:27], v[40:43], v[72:87]
    v_exp_f32 v52, v52
    v_exp_f32 v53, v53
    v_exp_f32 v54, v54
    v_exp_f32 v55, v55
    v_cvt_pk_bf16_f32 v48, v48, v49
    v_cvt_pk_bf16_f32 v49, v50, v51
    v_cvt_pk_bf16_f32 v50, v52, v53
    v_cvt_pk_bf16_f32 v51, v54, v55
    v_exp_f32 v56, v56
    v_exp_f32 v57, v57
    v_mfma_f32_32x32x16_bf16 v[72:87], v[28:31], v[48:51], v[72:87]
    v_exp_f32 v58, v58
    v_exp_f32 v59, v59
    v_exp_f32 v60, v60
    v_exp_f32 v61, v61
    s_waitcnt lgkmcnt(0)
    v_mfma_f32_32x32x16_bf16 v[40:55], v[16:19], v[8:11], 0
    ds_read_b128 v[20:23], v3 offset:34816
    s_mov_b64 exec, s[38:39]
    ds_read_b128 v[24:27], v3 offset:33792
    ds_read_b128 v[28:31], v3 offset:34048
    s_mov_b64 exec, -1
    v_exp_f32 v62, v62
    v_exp_f32 v63, v63
    v_exp_f32 v64, v64
    v_cvt_pk_bf16_f32 v56, v56, v57
    v_cvt_pk_bf16_f32 v57, v58, v59
    v_cvt_pk_bf16_f32 v58, v60, v61
    v_cvt_pk_bf16_f32 v59, v62, v63
    v_exp_f32 v65, v65
    v_exp_f32 v66, v66
    v_exp_f32 v67, v67
    v_mfma_f32_32x32x16_bf16 v[72:87], v[32:35], v[56:59], v[72:87]
    v_exp_f32 v68, v68
    v_exp_f32 v69, v69
    v_exp_f32 v70, v70
    v_exp_f32 v71, v71
    v_cvt_pk_bf16_f32 v64, v64, v65
    v_cvt_pk_bf16_f32 v65, v66, v67
    v_cvt_pk_bf16_f32 v66, v68, v69
    v_cvt_pk_bf16_f32 v67, v70, v71
    v_exp_f32 v40, v40
    v_exp_f32 v41, v41
    v_mfma_f32_32x32x16_bf16 v[72:87], v[36:39], v[64:67], v[72:87]
    v_exp_f32 v42, v42
    v_exp_f32 v43, v43
    v_exp_f32 v44, v44
    v_exp_f32 v45, v45
    s_waitcnt lgkmcnt(0)
    v_mfma_f32_32x32x16_bf16 v[56:71], v[20:23], v[8:11], 0
    ds_read_b128 v[16:19], v3 offset:36864
    s_mov_b64 exec, s[38:39]
    ds_read_b128 v[32:35], v3 offset:35840
    ds_read_b128 v[36:39], v3 offset:36096
    s_mov_b64 exec, -1
    v_exp_f32 v46, v46
    v_exp_f32 v47, v47
    v_exp_f32 v48, v48
    v_cvt_pk_bf16_f32 v40, v40, v41
    v_cvt_pk_bf16_f32 v41, v42, v43
    v_cvt_pk_bf16_f32 v42, v44, v45
    v_cvt_pk_bf16_f32 v43, v46, v47
    v_exp_f32 v49, v49
    v_exp_f32 v50, v50
    v_exp_f32 v51, v51
    v_mfma_f32_32x32x16_bf16 v[72:87], v[24:27], v[40:43], v[72:87]
    v_exp_f32 v52, v52
    v_exp_f32 v53, v53
    v_exp_f32 v54, v54
    v_exp_f32 v55, v55
    v_cvt_pk_bf16_f32 v48, v48, v49
    v_cvt_pk_bf16_f32 v49, v50, v51
    v_cvt_pk_bf16_f32 v50, v52, v53
    v_cvt_pk_bf16_f32 v51, v54, v55
    v_exp_f32 v56, v56
    v_exp_f32 v57, v57
    v_mfma_f32_32x32x16_bf16 v[72:87], v[28:31], v[48:51], v[72:87]
    v_exp_f32 v58, v58
    v_exp_f32 v59, v59
    v_exp_f32 v60, v60
    v_exp_f32 v61, v61
    s_waitcnt lgkmcnt(0)
    v_mfma_f32_32x32x16_bf16 v[40:55], v[16:19], v[8:11], 0
    ds_read_b128 v[20:23], v3 offset:38912
    s_mov_b64 exec, s[38:39]
    ds_read_b128 v[24:27], v3 offset:37888
    ds_read_b128 v[28:31], v3 offset:38144
    s_mov_b64 exec, -1
    v_exp_f32 v62, v62
    v_exp_f32 v63, v63
    v_exp_f32 v64, v64
    v_cvt_pk_bf16_f32 v56, v56, v57
    v_cvt_pk_bf16_f32 v57, v58, v59
    v_cvt_pk_bf16_f32 v58, v60, v61
    v_cvt_pk_bf16_f32 v59, v62, v63
    v_exp_f32 v65, v65
    v_exp_f32 v66, v66
    v_exp_f32 v67, v67
    v_mfma_f32_32x32x16_bf16 v[72:87], v[32:35], v[56:59], v[72:87]
    v_exp_f32 v68, v68
    v_exp_f32 v69, v69
    v_exp_f32 v70, v70
    v_exp_f32 v71, v71
    v_cvt_pk_bf16_f32 v64, v64, v65
    v_cvt_pk_bf16_f32 v65, v66, v67
    v_cvt_pk_bf16_f32 v66, v68, v69
    v_cvt_pk_bf16_f32 v67, v70, v71
    v_exp_f32 v40, v40
    v_exp_f32 v41, v41
    v_mfma_f32_32x32x16_bf16 v[72:87], v[36:39], v[64:67], v[72:87]
    v_exp_f32 v42, v42
    v_exp_f32 v43, v43
    v_exp_f32 v44, v44
    v_exp_f32 v45, v45
    s_waitcnt lgkmcnt(0)
    v_mfma_f32_32x32x16_bf16 v[56:71], v[20:23], v[8:11], 0
    ds_read_b128 v[16:19], v3 offset:40960
    s_mov_b64 exec, s[38:39]
    ds_read_b128 v[32:35], v3 offset:39936
    ds_read_b128 v[36:39], v3 offset:40192
    s_mov_b64 exec, -1
    v_exp_f32 v46, v46
    v_exp_f32 v47, v47
    v_exp_f32 v48, v48
    v_cvt_pk_bf16_f32 v40, v40, v41
    v_cvt_pk_bf16_f32 v41, v42, v43
    v_cvt_pk_bf16_f32 v42, v44, v45
    v_cvt_pk_bf16_f32 v43, v46, v47
    v_exp_f32 v49, v49
    v_exp_f32 v50, v50
    v_exp_f32 v51, v51
    v_mfma_f32_32x32x16_bf16 v[72:87], v[24:27], v[40:43], v[72:87]
    v_exp_f32 v52, v52
    v_exp_f32 v53, v53
    v_exp_f32 v54, v54
    v_exp_f32 v55, v55
    v_cvt_pk_bf16_f32 v48, v48, v49
    v_cvt_pk_bf16_f32 v49, v50, v51
    v_cvt_pk_bf16_f32 v50, v52, v53
    v_cvt_pk_bf16_f32 v51, v54, v55
    v_exp_f32 v56, v56
    v_exp_f32 v57, v57
    v_mfma_f32_32x32x16_bf16 v[72:87], v[28:31], v[48:51], v[72:87]
    v_exp_f32 v58, v58
    v_exp_f32 v59, v59
    v_exp_f32 v60, v60
    v_exp_f32 v61, v61
    s_waitcnt lgkmcnt(0)
    v_mfma_f32_32x32x16_bf16 v[40:55], v[16:19], v[8:11], 0
    ds_read_b128 v[20:23], v3 offset:43008
    s_mov_b64 exec, s[38:39]
    ds_read_b128 v[24:27], v3 offset:41984
    ds_read_b128 v[28:31], v3 offset:42240
    s_mov_b64 exec, -1
    v_exp_f32 v62, v62
    v_exp_f32 v63, v63
    v_exp_f32 v64, v64
    v_cvt_pk_bf16_f32 v56, v56, v57
    v_cvt_pk_bf16_f32 v57, v58, v59
    v_cvt_pk_bf16_f32 v58, v60, v61
    v_cvt_pk_bf16_f32 v59, v62, v63
    v_exp_f32 v65, v65
    v_exp_f32 v66, v66
    v_exp_f32 v67, v67
    v_mfma_f32_32x32x16_bf16 v[72:87], v[32:35], v[56:59], v[72:87]
    v_exp_f32 v68, v68
    v_exp_f32 v69, v69
    v_exp_f32 v70, v70
    v_exp_f32 v71, v71
    v_cvt_pk_bf16_f32 v64, v64, v65
    v_cvt_pk_bf16_f32 v65, v66, v67
    v_cvt_pk_bf16_f32 v66, v68, v69
    v_cvt_pk_bf16_f32 v67, v70, v71
    v_exp_f32 v40, v40
    v_exp_f32 v41, v41
    v_mfma_f32_32x32x16_bf16 v[72:87], v[36:39], v[64:67], v[72:87]
    v_exp_f32 v42, v42
    v_exp_f32 v43, v43
    v_exp_f32 v44, v44
    v_exp_f32 v45, v45
    s_waitcnt lgkmcnt(0)
    v_mfma_f32_32x32x16_bf16 v[56:71], v[20:23], v[8:11], 0
    ds_read_b128 v[16:19], v3 offset:45056
    s_mov_b64 exec, s[38:39]
    ds_read_b128 v[32:35], v3 offset:44032
    ds_read_b128 v[36:39], v3 offset:44288
    s_mov_b64 exec, -1
    v_exp_f32 v46, v46
    v_exp_f32 v47, v47
    v_exp_f32 v48, v48
    v_cvt_pk_bf16_f32 v40, v40, v41
    v_cvt_pk_bf16_f32 v41, v42, v43
    v_cvt_pk_bf16_f32 v42, v44, v45
    v_cvt_pk_bf16_f32 v43, v46, v47
    v_exp_f32 v49, v49
    v_exp_f32 v50, v50
    v_exp_f32 v51, v51
    v_mfma_f32_32x32x16_bf16 v[72:87], v[24:27], v[40:43], v[72:87]
    v_exp_f32 v52, v52
    v_exp_f32 v53, v53
    v_exp_f32 v54, v54
    v_exp_f32 v55, v55
    v_cvt_pk_bf16_f32 v48, v48, v49
    v_cvt_pk_bf16_f32 v49, v50, v51
    v_cvt_pk_bf16_f32 v50, v52, v53
    v_cvt_pk_bf16_f32 v51, v54, v55
    v_exp_f32 v56, v56
    v_exp_f32 v57, v57
    v_mfma_f32_32x32x16_bf16 v[72:87], v[28:31], v[48:51], v[72:87]
    v_exp_f32 v58, v58
    v_exp_f32 v59, v59
    v_exp_f32 v60, v60
    v_exp_f32 v61, v61
    s_waitcnt lgkmcnt(0)
    v_mfma_f32_32x32x16_bf16 v[40:55], v[16:19], v[8:11], 0
    ds_read_b128 v[20:23], v3 offset:47104
    s_mov_b64 exec, s[38:39]
    ds_read_b128 v[24:27], v3 offset:46080
    ds_read_b128 v[28:31], v3 offset:46336
    s_mov_b64 exec, -1
    v_exp_f32 v62, v62
    v_exp_f32 v63, v63
    v_exp_f32 v64, v64
    v_cvt_pk_bf16_f32 v56, v56, v57
    v_cvt_pk_bf16_f32 v57, v58, v59
    v_cvt_pk_bf16_f32 v58, v60, v61
    v_cvt_pk_bf16_f32 v59, v62, v63
    v_exp_f32 v65, v65
    v_exp_f32 v66, v66
    v_exp_f32 v67, v67
    v_mfma_f32_32x32x16_bf16 v[72:87], v[32:35], v[56:59], v[72:87]
    v_exp_f32 v68, v68
    v_exp_f32 v69, v69
    v_exp_f32 v70, v70
    v_exp_f32 v71, v71
    v_cvt_pk_bf16_f32 v64, v64, v65
    v_cvt_pk_bf16_f32 v65, v66, v67
    v_cvt_pk_bf16_f32 v66, v68, v69
    v_cvt_pk_bf16_f32 v67, v70, v71
    v_exp_f32 v40, v40
    v_exp_f32 v41, v41
    v_mfma_f32_32x32x16_bf16 v[72:87], v[36:39], v[64:67], v[72:87]
    v_exp_f32 v42, v42
    v_exp_f32 v43, v43
    v_exp_f32 v44, v44
    v_exp_f32 v45, v45
    s_waitcnt lgkmcnt(0)
    v_mfma_f32_32x32x16_bf16 v[56:71], v[20:23], v[8:11], 0
    ds_read_b128 v[16:19], v3 offset:49152
    s_mov_b64 exec, s[38:39]
    ds_read_b128 v[32:35], v3 offset:48128
    ds_read_b128 v[36:39], v3 offset:48384
    s_mov_b64 exec, -1
    v_exp_f32 v46, v46
    v_exp_f32 v47, v47
    v_exp_f32 v48, v48
    v_cvt_pk_bf16_f32 v40, v40, v41
    v_cvt_pk_bf16_f32 v41, v42, v43
    v_cvt_pk_bf16_f32 v42, v44, v45
    v_cvt_pk_bf16_f32 v43, v46, v47
    v_exp_f32 v49, v49
    v_exp_f32 v50, v50
    v_exp_f32 v51, v51
    v_mfma_f32_32x32x16_bf16 v[72:87], v[24:27], v[40:43], v[72:87]
    v_exp_f32 v52, v52
    v_exp_f32 v53, v53
    v_exp_f32 v54, v54
    v_exp_f32 v55, v55
    v_cvt_pk_bf16_f32 v48, v48, v49
    v_cvt_pk_bf16_f32 v49, v50, v51
    v_cvt_pk_bf16_f32 v50, v52, v53
    v_cvt_pk_bf16_f32 v51, v54, v55
    v_exp_f32 v56, v56
    v_exp_f32 v57, v57
    v_mfma_f32_32x32x16_bf16 v[72:87], v[28:31], v[48:51], v[72:87]
    v_exp_f32 v58, v58
    v_exp_f32 v59, v59
    v_exp_f32 v60, v60
    v_exp_f32 v61, v61
    s_waitcnt lgkmcnt(0)
    v_mfma_f32_32x32x16_bf16 v[40:55], v[16:19], v[8:11], 0
    ds_read_b128 v[20:23], v3 offset:51200
    s_mov_b64 exec, s[38:39]
    ds_read_b128 v[24:27], v3 offset:50176
    ds_read_b128 v[28:31], v3 offset:50432
    s_mov_b64 exec, -1
    v_exp_f32 v62, v62
    v_exp_f32 v63, v63
    v_exp_f32 v64, v64
    v_cvt_pk_bf16_f32 v56, v56, v57
    v_cvt_pk_bf16_f32 v57, v58, v59
    v_cvt_pk_bf16_f32 v58, v60, v61
    v_cvt_pk_bf16_f32 v59, v62, v63
    v_exp_f32 v65, v65
    v_exp_f32 v66, v66
    v_exp_f32 v67, v67
    v_mfma_f32_32x32x16_bf16 v[72:87], v[32:35], v[56:59], v[72:87]
    v_exp_f32 v68, v68
    v_exp_f32 v69, v69
    v_exp_f32 v70, v70
    v_exp_f32 v71, v71
    v_cvt_pk_bf16_f32 v64, v64, v65
    v_cvt_pk_bf16_f32 v65, v66, v67
    v_cvt_pk_bf16_f32 v66, v68, v69
    v_cvt_pk_bf16_f32 v67, v70, v71
    s_setprio 0
    v_exp_f32 v40, v40
    v_exp_f32 v41, v41
    v_mfma_f32_32x32x16_bf16 v[72:87], v[36:39], v[64:67], v[72:87]
    v_exp_f32 v42, v42
    v_exp_f32 v43, v43
    v_exp_f32 v44, v44
    v_exp_f32 v45, v45
    s_waitcnt lgkmcnt(0)
    v_mfma_f32_32x32x16_bf16 v[56:71], v[20:23], v[8:11], 0
    ds_read_b128 v[16:19], v3 offset:53248
    s_mov_b64 exec, s[38:39]
    ds_read_b128 v[32:35], v3 offset:52224
    ds_read_b128 v[36:39], v3 offset:52480
    s_mov_b64 exec, -1
    v_exp_f32 v46, v46
    v_exp_f32 v47, v47
    v_exp_f32 v48, v48
    v_cvt_pk_bf16_f32 v40, v40, v41
    v_cvt_pk_bf16_f32 v41, v42, v43
    v_cvt_pk_bf16_f32 v42, v44, v45
    v_cvt_pk_bf16_f32 v43, v46, v47
    v_exp_f32 v49, v49
    v_exp_f32 v50, v50
    v_exp_f32 v51, v51
    v_mfma_f32_32x32x16_bf16 v[72:87], v[24:27], v[40:43], v[72:87]
    v_exp_f32 v52, v52
    v_exp_f32 v53, v53
    v_exp_f32 v54, v54
    v_exp_f32 v55, v55
    v_cvt_pk_bf16_f32 v48, v48, v49
    v_cvt_pk_bf16_f32 v49, v50, v51
    v_cvt_pk_bf16_f32 v50, v52, v53
    v_cvt_pk_bf16_f32 v51, v54, v55
    v_exp_f32 v56, v56
    v_exp_f32 v57, v57
    v_mfma_f32_32x32x16_bf16 v[72:87], v[28:31], v[48:51], v[72:87]
    v_exp_f32 v58, v58
    v_exp_f32 v59, v59
    v_exp_f32 v60, v60
    v_exp_f32 v61, v61
    s_waitcnt lgkmcnt(0)
    v_mfma_f32_32x32x16_bf16 v[40:55], v[16:19], v[8:11], 0
    ds_read_b128 v[20:23], v3 offset:55296
    s_mov_b64 exec, s[38:39]
    ds_read_b128 v[24:27], v3 offset:54272
    ds_read_b128 v[28:31], v3 offset:54528
    s_mov_b64 exec, -1
    v_exp_f32 v62, v62
    v_exp_f32 v63, v63
    v_exp_f32 v64, v64
    v_cvt_pk_bf16_f32 v56, v56, v57
    v_cvt_pk_bf16_f32 v57, v58, v59
    v_cvt_pk_bf16_f32 v58, v60, v61
    v_cvt_pk_bf16_f32 v59, v62, v63
    v_exp_f32 v65, v65
    v_exp_f32 v66, v66
    v_exp_f32 v67, v67
    v_mfma_f32_32x32x16_bf16 v[72:87], v[32:35], v[56:59], v[72:87]
    v_exp_f32 v68, v68
    v_exp_f32 v69, v69
    v_exp_f32 v70, v70
    v_exp_f32 v71, v71
    v_cvt_pk_bf16_f32 v64, v64, v65
    v_cvt_pk_bf16_f32 v65, v66, v67
    v_cvt_pk_bf16_f32 v66, v68, v69
    v_cvt_pk_bf16_f32 v67, v70, v71
    v_exp_f32 v40, v40
    v_exp_f32 v41, v41
    v_mfma_f32_32x32x16_bf16 v[72:87], v[36:39], v[64:67], v[72:87]
    v_exp_f32 v42, v42
    v_exp_f32 v43, v43
    v_exp_f32 v44, v44
    v_exp_f32 v45, v45
    s_waitcnt lgkmcnt(0)
    v_mfma_f32_32x32x16_bf16 v[56:71], v[20:23], v[8:11], 0
    ds_read_b128 v[16:19], v3 offset:57344
    s_mov_b64 exec, s[38:39]
    ds_read_b128 v[32:35], v3 offset:56320
    ds_read_b128 v[36:39], v3 offset:56576
    s_mov_b64 exec, -1
    v_exp_f32 v46, v46
    v_exp_f32 v47, v47
    v_exp_f32 v48, v48
    v_cvt_pk_bf16_f32 v40, v40, v41
    v_cvt_pk_bf16_f32 v41, v42, v43
    v_cvt_pk_bf16_f32 v42, v44, v45
    v_cvt_pk_bf16_f32 v43, v46, v47
    v_exp_f32 v49, v49
    v_exp_f32 v50, v50
    v_exp_f32 v51, v51
    v_mfma_f32_32x32x16_bf16 v[72:87], v[24:27], v[40:43], v[72:87]
    s_lshl_b32 s26, s22, 5
    s_add_u32 s26, s26, 0x1a88000
    buffer_load_dword v7, v88, s[4:7], s26 offen sc1
    v_exp_f32 v52, v52
    v_exp_f32 v53, v53
    v_exp_f32 v54, v54
    v_exp_f32 v55, v55
    v_cvt_pk_bf16_f32 v48, v48, v49
    v_cvt_pk_bf16_f32 v49, v50, v51
    v_cvt_pk_bf16_f32 v50, v52, v53
    v_cvt_pk_bf16_f32 v51, v54, v55
    v_exp_f32 v56, v56
    v_exp_f32 v57, v57
    v_mfma_f32_32x32x16_bf16 v[72:87], v[28:31], v[48:51], v[72:87]
    v_exp_f32 v58, v58
    v_exp_f32 v59, v59
    v_exp_f32 v60, v60
    v_exp_f32 v61, v61
    s_waitcnt lgkmcnt(0)
    v_mfma_f32_32x32x16_bf16 v[40:55], v[16:19], v[8:11], 0
    ds_read_b128 v[20:23], v3 offset:59392
    s_mov_b64 exec, s[38:39]
    ds_read_b128 v[24:27], v3 offset:58368
    ds_read_b128 v[28:31], v3 offset:58624
    s_mov_b64 exec, -1
    v_exp_f32 v62, v62
    v_exp_f32 v63, v63
    v_exp_f32 v64, v64
    v_cvt_pk_bf16_f32 v56, v56, v57
    v_cvt_pk_bf16_f32 v57, v58, v59
    v_cvt_pk_bf16_f32 v58, v60, v61
    v_cvt_pk_bf16_f32 v59, v62, v63
    v_exp_f32 v65, v65
    v_exp_f32 v66, v66
    v_exp_f32 v67, v67
    v_mfma_f32_32x32x16_bf16 v[72:87], v[32:35], v[56:59], v[72:87]
    v_exp_f32 v68, v68
    v_exp_f32 v69, v69
    v_exp_f32 v70, v70
    v_exp_f32 v71, v71
    v_cvt_pk_bf16_f32 v64, v64, v65
    v_cvt_pk_bf16_f32 v65, v66, v67
    v_cvt_pk_bf16_f32 v66, v68, v69
    v_cvt_pk_bf16_f32 v67, v70, v71
    v_exp_f32 v40, v40
    v_exp_f32 v41, v41
    v_mfma_f32_32x32x16_bf16 v[72:87], v[36:39], v[64:67], v[72:87]
    v_exp_f32 v42, v42
    v_exp_f32 v43, v43
    v_exp_f32 v44, v44
    v_exp_f32 v45, v45
    s_waitcnt lgkmcnt(0)
    v_mfma_f32_32x32x16_bf16 v[56:71], v[20:23], v[8:11], 0
    ds_read_b128 v[16:19], v3 offset:61440
    s_mov_b64 exec, s[38:39]
    ds_read_b128 v[32:35], v3 offset:60416
    ds_read_b128 v[36:39], v3 offset:60672
    s_mov_b64 exec, -1
    v_exp_f32 v46, v46
    v_exp_f32 v47, v47
    v_exp_f32 v48, v48
    v_cvt_pk_bf16_f32 v40, v40, v41
    v_cvt_pk_bf16_f32 v41, v42, v43
    v_cvt_pk_bf16_f32 v42, v44, v45
    v_cvt_pk_bf16_f32 v43, v46, v47
    v_exp_f32 v49, v49
    v_exp_f32 v50, v50
    v_exp_f32 v51, v51
    v_mfma_f32_32x32x16_bf16 v[72:87], v[24:27], v[40:43], v[72:87]
    v_exp_f32 v52, v52
    v_exp_f32 v53, v53
    v_exp_f32 v54, v54
    v_exp_f32 v55, v55
    v_cvt_pk_bf16_f32 v48, v48, v49
    v_cvt_pk_bf16_f32 v49, v50, v51
    v_cvt_pk_bf16_f32 v50, v52, v53
    v_cvt_pk_bf16_f32 v51, v54, v55
    v_exp_f32 v56, v56
    v_exp_f32 v57, v57
    v_mfma_f32_32x32x16_bf16 v[72:87], v[28:31], v[48:51], v[72:87]
    v_exp_f32 v58, v58
    v_exp_f32 v59, v59
    v_exp_f32 v60, v60
    v_exp_f32 v61, v61
    s_waitcnt lgkmcnt(0)
    v_mfma_f32_32x32x16_bf16 v[40:55], v[16:19], v[8:11], 0
    ds_read_b128 v[20:23], v3 offset:63488
    s_mov_b64 exec, s[38:39]
    ds_read_b128 v[24:27], v3 offset:62464
    ds_read_b128 v[28:31], v3 offset:62720
    s_mov_b64 exec, -1
    v_exp_f32 v62, v62
    v_exp_f32 v63, v63
    v_exp_f32 v64, v64
    v_cvt_pk_bf16_f32 v56, v56, v57
    v_cvt_pk_bf16_f32 v57, v58, v59
    v_cvt_pk_bf16_f32 v58, v60, v61
    v_cvt_pk_bf16_f32 v59, v62, v63
    v_exp_f32 v65, v65
    v_exp_f32 v66, v66
    v_exp_f32 v67, v67
    v_mfma_f32_32x32x16_bf16 v[72:87], v[32:35], v[56:59], v[72:87]
    v_exp_f32 v68, v68
    v_exp_f32 v69, v69
    v_exp_f32 v70, v70
    v_exp_f32 v71, v71
    v_cvt_pk_bf16_f32 v64, v64, v65
    v_cvt_pk_bf16_f32 v65, v66, v67
    v_cvt_pk_bf16_f32 v66, v68, v69
    v_cvt_pk_bf16_f32 v67, v70, v71
    v_exp_f32 v40, v40
    v_exp_f32 v41, v41
    v_mfma_f32_32x32x16_bf16 v[72:87], v[36:39], v[64:67], v[72:87]
    v_exp_f32 v42, v42
    v_exp_f32 v43, v43
    v_exp_f32 v44, v44
    v_exp_f32 v45, v45
    s_waitcnt lgkmcnt(0)
    v_mfma_f32_32x32x16_bf16 v[56:71], v[20:23], v[8:11], 0
    s_mov_b64 exec, s[38:39]
    ds_read_b128 v[32:35], v3 offset:64512
    ds_read_b128 v[36:39], v3 offset:64768
    s_mov_b64 exec, -1
    v_exp_f32 v46, v46
    v_exp_f32 v47, v47
    v_exp_f32 v48, v48
    v_cvt_pk_bf16_f32 v40, v40, v41
    v_cvt_pk_bf16_f32 v41, v42, v43
    v_cvt_pk_bf16_f32 v42, v44, v45
    v_cvt_pk_bf16_f32 v43, v46, v47
    v_exp_f32 v49, v49
    v_exp_f32 v50, v50
    v_exp_f32 v51, v51
    v_mfma_f32_32x32x16_bf16 v[72:87], v[24:27], v[40:43], v[72:87]
    v_exp_f32 v52, v52
    v_exp_f32 v53, v53
    v_exp_f32 v54, v54
    v_exp_f32 v55, v55
    v_cvt_pk_bf16_f32 v48, v48, v49
    v_cvt_pk_bf16_f32 v49, v50, v51
    v_cvt_pk_bf16_f32 v50, v52, v53
    v_cvt_pk_bf16_f32 v51, v54, v55
    v_exp_f32 v56, v56
    v_exp_f32 v57, v57
    v_mfma_f32_32x32x16_bf16 v[72:87], v[28:31], v[48:51], v[72:87]
    v_exp_f32 v58, v58
    v_exp_f32 v59, v59
    v_exp_f32 v60, v60
    v_exp_f32 v61, v61
    s_waitcnt lgkmcnt(0)
    v_exp_f32 v62, v62
    v_exp_f32 v63, v63
    v_exp_f32 v64, v64
    v_cvt_pk_bf16_f32 v56, v56, v57
    v_cvt_pk_bf16_f32 v57, v58, v59
    v_cvt_pk_bf16_f32 v58, v60, v61
    v_cvt_pk_bf16_f32 v59, v62, v63
    v_exp_f32 v65, v65
    v_exp_f32 v66, v66
    v_exp_f32 v67, v67
    v_mfma_f32_32x32x16_bf16 v[72:87], v[32:35], v[56:59], v[72:87]
    v_exp_f32 v68, v68
    v_exp_f32 v69, v69
    v_exp_f32 v70, v70
    v_exp_f32 v71, v71
    v_cvt_pk_bf16_f32 v64, v64, v65
    v_cvt_pk_bf16_f32 v65, v66, v67
    v_cvt_pk_bf16_f32 v66, v68, v69
    v_cvt_pk_bf16_f32 v67, v70, v71
    s_nop 1
    v_mfma_f32_32x32x16_bf16 v[72:87], v[36:39], v[64:67], v[72:87]
    s_branch L_adone_15
L_slow_14:
    s_setprio 0
    s_add_u32 s50, s50, 0x1000
    s_and_b32 s50, s50, 0x7fff
    s_add_u32 s51, s51, 0x4000
    s_add_u32 s52, s50, s56
    s_mov_b32 m0, s51
    s_nop 0
    buffer_load_dwordx4 v0, s[4:7], s52 offen offset:0 lds
    buffer_load_dwordx4 v0, s[4:7], s52 offen offset:1024 lds
    s_add_u32 s50, s50, 0x1000
    s_and_b32 s50, s50, 0x7fff
    s_add_u32 s51, s51, 0x4000
    s_add_u32 s52, s50, s56
    s_mov_b32 m0, s51
    s_nop 0
    buffer_load_dwordx4 v0, s[4:7], s52 offen offset:0 lds
    buffer_load_dwordx4 v0, s[4:7], s52 offen offset:1024 lds
    s_add_u32 s50, s50, 0x1000
    s_and_b32 s50, s50, 0x7fff
    s_add_u32 s51, s51, 0x4000
    s_add_u32 s52, s50, s56
    s_mov_b32 m0, s51
    s_nop 0
    buffer_load_dwordx4 v0, s[4:7], s52 offen offset:0 lds
    buffer_load_dwordx4 v0, s[4:7], s52 offen offset:1024 lds
    s_add_u32 s50, s50, 0x1000
    s_and_b32 s50, s50, 0x7fff
    s_add_u32 s51, s51, 0x4000
    s_add_u32 s52, s50, s56
    s_mov_b32 m0, s51
    s_nop 0
    buffer_load_dwordx4 v0, s[4:7], s52 offen offset:0 lds
    buffer_load_dwordx4 v0, s[4:7], s52 offen offset:1024 lds
    s_add_u32 s50, s50, 0x1000
    s_and_b32 s50, s50, 0x7fff
    s_add_u32 s51, s51, 0x4000
    s_add_u32 s52, s50, s56
    s_mov_b32 m0, s51
    s_nop 0
    buffer_load_dwordx4 v0, s[4:7], s52 offen offset:0 lds
    buffer_load_dwordx4 v0, s[4:7], s52 offen offset:1024 lds
    s_add_u32 s50, s50, 0x1000
    s_and_b32 s50, s50, 0x7fff
    s_add_u32 s51, s51, 0x4000
    s_add_u32 s52, s50, s56
    s_mov_b32 m0, s51
    s_nop 0
    buffer_load_dwordx4 v0, s[4:7], s52 offen offset:0 lds
    buffer_load_dwordx4 v0, s[4:7], s52 offen offset:1024 lds
    s_add_u32 s26, s26, 4096
    buffer_load_dwordx4 v[128:131], v0, s[4:7], s26 offen offset:0
    buffer_load_dwordx4 v[132:135], v0, s[4:7], s26 offen offset:1024
    buffer_load_dwordx4 v[136:139], v0, s[4:7], s26 offen offset:2048
    buffer_load_dwordx4 v[140:143], v0, s[4:7], s26 offen offset:3072
    s_add_u32 s26, s26, 4096
    buffer_load_dwordx4 v[144:147], v0, s[4:7], s26 offen offset:0
    buffer_load_dwordx4 v[148:151], v0, s[4:7], s26 offen offset:1024
    buffer_load_dwordx4 v[152:155], v0, s[4:7], s26 offen offset:2048
    buffer_load_dwordx4 v[156:159], v0, s[4:7], s26 offen offset:3072
    s_lshl_b32 s28, s32, 15
    s_add_u32 s28, s28, 0x100000
    buffer_load_dwordx4 v[160:163], v0, s[4:7], s28 offen offset:0
    buffer_load_dwordx4 v[164:167], v0, s[4:7], s28 offen offset:1024
    buffer_load_dwordx4 v[224:227], v0, s[4:7], s28 offen offset:2048
    buffer_load_dwordx4 v[228:231], v0, s[4:7], s28 offen offset:3072
    s_add_u32 s28, s28, 4096
    buffer_load_dwordx4 v[168:171], v0, s[4:7], s28 offen offset:0
    buffer_load_dwordx4 v[172:175], v0, s[4:7], s28 offen offset:1024
    buffer_load_dwordx4 v[232:235], v0, s[4:7], s28 offen offset:2048
    buffer_load_dwordx4 v[236:239], v0, s[4:7], s28 offen offset:3072
    s_add_u32 s28, s28, 4096
    buffer_load_dwordx4 v[176:179], v0, s[4:7], s28 offen offset:0
    buffer_load_dwordx4 v[180:183], v0, s[4:7], s28 offen offset:1024
    buffer_load_dwordx4 v[240:243], v0, s[4:7], s28 offen offset:2048
    buffer_load_dwordx4 v[244:247], v0, s[4:7], s28 offen offset:3072
    s_add_u32 s28, s28, 4096
    buffer_load_dwordx4 v[184:187], v0, s[4:7], s28 offen offset:0
    buffer_load_dwordx4 v[188:191], v0, s[4:7], s28 offen offset:1024
    buffer_load_dwordx4 v[248:251], v0, s[4:7], s28 offen offset:2048
    buffer_load_dwordx4 v[252:255], v0, s[4:7], s28 offen offset:3072
    s_add_u32 s28, s28, 4096
    buffer_load_dwordx4 v[192:195], v0, s[4:7], s28 offen offset:0
    buffer_load_dwordx4 v[196:199], v0, s[4:7], s28 offen offset:1024
    s_add_u32 s28, s28, 4096
    buffer_load_dwordx4 v[200:203], v0, s[4:7], s28 offen offset:0
    buffer_load_dwordx4 v[204:207], v0, s[4:7], s28 offen offset:1024
    s_add_u32 s28, s28, 4096
    buffer_load_dwordx4 v[208:211], v0, s[4:7], s28 offen offset:0
    buffer_load_dwordx4 v[212:215], v0, s[4:7], s28 offen offset:1024
    s_add_u32 s28, s28, 4096
    buffer_load_dwordx4 v[216:219], v0, s[4:7], s28 offen offset:0
    buffer_load_dwordx4 v[220:223], v0, s[4:7], s28 offen offset:1024
    s_mul_i32 s27, s22, 176128
    s_add_u32 s27, s27, 0x1000000
    s_lshl_b32 s26, s32, 11
    s_add_u32 s26, s26, s27
    buffer_load_dword v90, v91, s[4:7], s26 offen
    s_add_u32 s26, s26, 88064
    buffer_load_dword v90, v91, s[4:7], s26 offen
    s_add_u32 s26, s34, 0x400000
    buffer_load_dword v90, v0, s[4:7], s26 offen
    s_and_b32 s57, s22, 7
    s_lshl_b32 s57, s57, 12
    s_add_u32 s57, s57, s54
    s_add_u32 s57, s57, 0xe20000
    buffer_load_dword v90, v91, s[4:7], s57 offen
    s_andn2_b32 s26, s31, 0x3ff
    s_add_u32 s26, s26, 0x1900000
    buffer_load_dword v90, v0, s[4:7], s26 offen
    s_andn2_b32 s26, s31, 0x3ff
    s_add_u32 s26, s26, 0x1980000
    buffer_load_dword v90, v0, s[4:7], s26 offen
    s_lshl_b32 s26, s22, 8
    s_add_u32 s26, s26, 0x1a82000
    buffer_load_dword v90, v89, s[4:7], s26 offen
    s_lshl_b32 s26, s22, 5
    s_add_u32 s26, s26, 0x1a88000
    buffer_load_dword v7, v88, s[4:7], s26 offen sc1
    s_waitcnt vmcnt(0) lgkmcnt(0)
    s_barrier
    s_barrier
    v_mov_b32 v72, 0
    v_mov_b32 v73, 0
    v_mov_b32 v74, 0
    v_mov_b32 v75, 0
    v_mov_b32 v76, 0
    v_mov_b32 v77, 0
    v_mov_b32 v78, 0
    v_mov_b32 v79, 0
    v_mov_b32 v80, 0
    v_mov_b32 v81, 0
    v_mov_b32 v82, 0
    v_mov_b32 v83, 0
    v_mov_b32 v84, 0
    v_mov_b32 v85, 0
    v_mov_b32 v86, 0
    v_mov_b32 v87, 0
    v_mov_b32 v4, 0xff800000
    s_mov_b32 s36, 0
L_sloop_27:
    ds_read_b128 v[16:19], v2 offset:0
    s_mov_b64 exec, s[38:39]
    ds_read_b128 v[24:27], v2 offset:1024
    ds_read_b128 v[28:31], v2 offset:1280
    s_mov_b64 exec, -1
    s_waitcnt lgkmcnt(0)
    v_mfma_f32_32x32x16_bf16 v[40:55], v[16:19], v[8:11], 0
    s_nop 15
    v_max_f32 v5, v40, v41
    v_max_f32 v5, v5, v42
    v_max_f32 v5, v5, v43
    v_max_f32 v5, v5, v44
    v_max_f32 v5, v5, v45
    v_max_f32 v5, v5, v46
    v_max_f32 v5, v5, v47
    v_max_f32 v5, v5, v48
    v_max_f32 v5, v5, v49
    v_max_f32 v5, v5, v50
    v_max_f32 v5, v5, v51
    v_max_f32 v5, v5, v52
    v_max_f32 v5, v5, v53
    v_max_f32 v5, v5, v54
    v_max_f32 v5, v5, v55
    v_mov_b32 v6, v5
    s_nop 1
    v_permlane32_swap_b32 v5, v6
    s_nop 1
    v_max3_f32 v5, v5, v6, v4
    v_sub_f32 v6, v4, v5
    v_exp_f32 v6, v6
    v_mov_b32 v4, v5
    v_sub_f32 v40, v40, v5
    v_sub_f32 v41, v41, v5
    v_sub_f32 v42, v42, v5
    v_sub_f32 v43, v43, v5
    v_sub_f32 v44, v44, v5
    v_sub_f32 v45, v45, v5
    v_sub_f32 v46, v46, v5
    v_sub_f32 v47, v47, v5
    v_sub_f32 v48, v48, v5
    v_sub_f32 v49, v49, v5
    v_sub_f32 v50, v50, v5
    v_sub_f32 v51, v51, v5
    v_sub_f32 v52, v52, v5
    v_sub_f32 v53, v53, v5
    v_sub_f32 v54, v54, v5
    v_sub_f32 v55, v55, v5
    v_mul_f32 v72, v72, v6
    v_mul_f32 v73, v73, v6
    v_mul_f32 v74, v74, v6
    v_mul_f32 v75, v75, v6
    v_mul_f32 v76, v76, v6
    v_mul_f32 v77, v77, v6
    v_mul_f32 v78, v78, v6
    v_mul_f32 v79, v79, v6
    v_mul_f32 v80, v80, v6
    v_mul_f32 v81, v81, v6
    v_mul_f32 v82, v82, v6
    v_mul_f32 v83, v83, v6
    v_mul_f32 v84, v84, v6
    v_mul_f32 v85, v85, v6
    v_mul_f32 v86, v86, v6
    v_mul_f32 v87, v87, v6
    v_exp_f32 v40, v40
    v_exp_f32 v41, v41
    v_exp_f32 v42, v42
    v_exp_f32 v43, v43
    v_exp_f32 v44, v44
    v_exp_f32 v45, v45
    v_exp_f32 v46, v46
    v_exp_f32 v47, v47
    v_exp_f32 v48, v48
    v_exp_f32 v49, v49
    v_exp_f32 v50, v50
    v_exp_f32 v51, v51
    v_exp_f32 v52, v52
    v_exp_f32 v53, v53
    v_exp_f32 v54, v54
    v_exp_f32 v55, v55
    s_nop 0
    v_cvt_pk_bf16_f32 v56, v40, v41
    v_cvt_pk_bf16_f32 v57, v42, v43
    v_cvt_pk_bf16_f32 v58, v44, v45
    v_cvt_pk_bf16_f32 v59, v46, v47
    v_cvt_pk_bf16_f32 v60, v48, v49
    v_cvt_pk_bf16_f32 v61, v50, v51
    v_cvt_pk_bf16_f32 v62, v52, v53
    v_cvt_pk_bf16_f32 v63, v54, v55
    s_nop 1
    v_mfma_f32_32x32x16_bf16 v[72:87], v[24:27], v[56:59], v[72:87]
    v_mfma_f32_32x32x16_bf16 v[72:87], v[28:31], v[60:63], v[72:87]
    s_nop 15
    v_add_u32 v2, 0x800, v2
    s_add_u32 s36, s36, 1
    s_cmp_lg_u32 s36, 64
    s_cbranch_scc1 L_sloop_27
L_adone_15:
    s_waitcnt vmcnt(0)
    v_cmp_eq_u32 vcc, s46, v7
    s_cmp_eq_u64 vcc, exec
    s_cselect_b32 s37, 1, 0
    s_nop 11
    v_rcp_f32 v4, v80
    s_nop 0
    v_mul_f32 v72, v72, v4
    v_mul_f32 v73, v73, v4
    v_mul_f32 v74, v74, v4
    v_mul_f32 v75, v75, v4
    v_mul_f32 v76, v76, v4
    v_mul_f32 v77, v77, v4
    v_mul_f32 v78, v78, v4
    v_mul_f32 v79, v79, v4
    v_cvt_pk_bf16_f32 v16, v72, v73
    v_cvt_pk_bf16_f32 v17, v74, v75
    v_cvt_pk_bf16_f32 v18, v76, v77
    v_cvt_pk_bf16_f32 v19, v78, v79
    s_add_u32 s26, s34, 0x600000
    s_cmp_lg_u32 s37, 0
    s_cbranch_scc1 L_hs_28
    buffer_store_dwordx4 v[16:19], v0, s[4:7], s26 offen sc1
    s_branch L_hsd_29
L_hs_28:
    buffer_store_dwordx4 v[16:19], v0, s[4:7], s26 offen
L_hsd_29:
    s_lshl_b32 s26, s22, 8
    s_lshl_b32 s27, s21, 5
    s_add_u32 s26, s26, s27
    s_lshl_b32 s27, s20, 2
    s_add_u32 s26, s26, s27
    s_add_u32 s26, s26, 0x1a80000
    v_mov_b32 v2, 1
    s_mov_b64 exec, 1
    s_waitcnt vmcnt(0)
    s_cmp_lg_u32 s37, 0
    s_cbranch_scc1 L_hs_30
    buffer_store_dword v2, off, s[4:7], s26 sc1
    s_branch L_hsd_31
L_hs_30:
    buffer_store_dword v2, off, s[4:7], s26
L_hsd_31:
    s_mov_b64 exec, -1
    s_lshl_b32 s44, s32, 15
    s_add_u32 s44, s44, 0x100000
    s_cmp_ge_u32 s20, 0
    s_cbranch_scc1 L_w1l_32
    s_add_u32 s44, s44, 16384
    buffer_load_dwordx4 v[64:67], v0, s[4:7], s44 offen offset:2048
    buffer_load_dwordx4 v[68:71], v0, s[4:7], s44 offen offset:3072
    s_add_u32 s44, s44, 4096
    buffer_load_dwordx4 v[72:75], v0, s[4:7], s44 offen offset:2048
    buffer_load_dwordx4 v[76:79], v0, s[4:7], s44 offen offset:3072
    s_add_u32 s44, s44, 4096
    buffer_load_dwordx4 v[80:83], v0, s[4:7], s44 offen offset:2048
    buffer_load_dwordx4 v[84:87], v0, s[4:7], s44 offen offset:3072
    s_add_u32 s44, s44, 4096
    buffer_load_dwordx4 v[88:91], v0, s[4:7], s44 offen offset:2048
    buffer_load_dwordx4 v[92:95], v0, s[4:7], s44 offen offset:3072
L_w1l_32:
    s_barrier
    s_lshl_b32 s26, s22, 8
    s_lshl_b32 s27, s20, 5
    s_add_u32 s26, s26, s27
    s_add_u32 s26, s26, 0x1a80000
    v_lshrrev_b32 v3, 2, v0
    v_and_b32 v3, 28, v3
    s_mov_b32 s36, 200000
L_poll_33:
    buffer_load_dword v2, v3, s[4:7], s26 offen sc1
    s_waitcnt vmcnt(0)
    v_cmp_eq_u32 vcc, 1, v2
    s_cmp_eq_u64 vcc, exec
    s_cbranch_scc1 L_polld_34
    s_sub_u32 s36, s36, 1
    s_cmp_lg_u32 s36, 0
    s_cbranch_scc1 L_poll_33
L_polld_34:
    s_lshl_b32 s26, s22, 16
    s_lshl_b32 s27, s20, 12
    s_add_u32 s26, s26, s27
    s_add_u32 s26, s26, 0x600000
    s_add_u32 s27, s27, 0x0
    s_add_u32 s28, s26, 0x8000
    s_add_u32 s29, s27, 0x8000
    s_mov_b32 m0, s27
    s_nop 0
    buffer_load_dwordx4 v0, s[4:7], s26 offen offset:0 sc1 lds
    buffer_load_dwordx4 v0, s[4:7], s26 offen offset:1024 sc1 lds
    s_mov_b32 m0, s29
    s_nop 0
    buffer_load_dwordx4 v0, s[4:7], s28 offen offset:0 sc1 lds
    buffer_load_dwordx4 v0, s[4:7], s28 offen offset:1024 sc1 lds
    s_mov_b32 m0, s27
    s_nop 0
    buffer_load_dwordx4 v0, s[4:7], s26 offen offset:2048 sc1 lds
    buffer_load_dwordx4 v0, s[4:7], s26 offen offset:3072 sc1 lds
    s_mov_b32 m0, s29
    s_nop 0
    buffer_load_dwordx4 v0, s[4:7], s28 offen offset:2048 sc1 lds
    buffer_load_dwordx4 v0, s[4:7], s28 offen offset:3072 sc1 lds
    s_waitcnt vmcnt(4) lgkmcnt(0)
    s_barrier
    s_lshl_b32 s26, s23, 15
    s_lshl_b32 s27, s25, 14
    s_add_u32 s26, s26, s27
    s_add_u32 s26, s26, 0x0
    v_add_u32 v2, s26, v0
    ds_read_b128 v[32:35], v2 offset:0
    ds_read_b128 v[36:39], v2 offset:1024
    ds_read_b128 v[40:43], v2 offset:4096
    ds_read_b128 v[44:47], v2 offset:5120
    ds_read_b128 v[48:51], v2 offset:8192
    ds_read_b128 v[52:55], v2 offset:9216
    ds_read_b128 v[56:59], v2 offset:12288
    ds_read_b128 v[60:63], v2 offset:13312
    s_waitcnt lgkmcnt(7)
    v_mfma_f32_32x32x16_bf16 v[16:31], v[96:99], v[32:35], 0
    s_waitcnt lgkmcnt(6)
    v_mfma_f32_32x32x16_bf16 v[16:31], v[100:103], v[36:39], v[16:31]
    s_waitcnt lgkmcnt(5)
    v_mfma_f32_32x32x16_bf16 v[16:31], v[112:115], v[40:43], v[16:31]
    s_waitcnt lgkmcnt(4)
    v_mfma_f32_32x32x16_bf16 v[16:31], v[116:119], v[44:47], v[16:31]
    s_waitcnt lgkmcnt(3)
    v_mfma_f32_32x32x16_bf16 v[16:31], v[128:131], v[48:51], v[16:31]
    s_waitcnt vmcnt(0)
    s_barrier
    ds_read_b128 v[32:35], v2 offset:2048
    ds_read_b128 v[36:39], v2 offset:3072
    ds_read_b128 v[40:43], v2 offset:6144
    ds_read_b128 v[44:47], v2 offset:7168
    ds_read_b128 v[48:51], v2 offset:10240
    s_cmp_lt_u32 s20, 0
    s_cbranch_scc1 L_w1h_35
    s_add_u32 s44, s44, 16384
    buffer_load_dwordx4 v[64:67], v0, s[4:7], s44 offen offset:2048
    buffer_load_dwordx4 v[68:71], v0, s[4:7], s44 offen offset:3072
    s_add_u32 s44, s44, 4096
    buffer_load_dwordx4 v[72:75], v0, s[4:7], s44 offen offset:2048
    buffer_load_dwordx4 v[76:79], v0, s[4:7], s44 offen offset:3072
    s_add_u32 s44, s44, 4096
    buffer_load_dwordx4 v[80:83], v0, s[4:7], s44 offen offset:2048
    buffer_load_dwordx4 v[84:87], v0, s[4:7], s44 offen offset:3072
    s_add_u32 s44, s44, 4096
    buffer_load_dwordx4 v[88:91], v0, s[4:7], s44 offen offset:2048
    buffer_load_dwordx4 v[92:95], v0, s[4:7], s44 offen offset:3072
L_w1h_35:
    s_waitcnt lgkmcnt(7)
    v_mfma_f32_32x32x16_bf16 v[16:31], v[132:135], v[52:55], v[16:31]
    ds_read_b128 v[52:55], v2 offset:11264
    s_waitcnt lgkmcnt(7)
    v_mfma_f32_32x32x16_bf16 v[16:31], v[144:147], v[56:59], v[16:31]
    ds_read_b128 v[56:59], v2 offset:14336
    s_waitcnt lgkmcnt(7)
    v_mfma_f32_32x32x16_bf16 v[16:31], v[148:151], v[60:63], v[16:31]
    ds_read_b128 v[60:63], v2 offset:15360
    s_waitcnt lgkmcnt(7)
    v_mfma_f32_32x32x16_bf16 v[16:31], v[104:107], v[32:35], v[16:31]
    s_waitcnt lgkmcnt(6)
    v_mfma_f32_32x32x16_bf16 v[16:31], v[108:111], v[36:39], v[16:31]
    s_waitcnt lgkmcnt(5)
    v_mfma_f32_32x32x16_bf16 v[16:31], v[120:123], v[40:43], v[16:31]
    s_waitcnt lgkmcnt(4)
    v_mfma_f32_32x32x16_bf16 v[16:31], v[124:127], v[44:47], v[16:31]
    s_waitcnt lgkmcnt(3)
    v_mfma_f32_32x32x16_bf16 v[16:31], v[136:139], v[48:51], v[16:31]
    s_waitcnt lgkmcnt(2)
    v_mfma_f32_32x32x16_bf16 v[16:31], v[140:143], v[52:55], v[16:31]
    s_waitcnt lgkmcnt(1)
    v_mfma_f32_32x32x16_bf16 v[16:31], v[152:155], v[56:59], v[16:31]
    s_waitcnt lgkmcnt(0)
    v_mfma_f32_32x32x16_bf16 v[16:31], v[156:159], v[60:63], v[16:31]
    s_lshl_b32 s26, s20, 11
    s_add_u32 s26, s26, 0x20000
    v_add_u32 v2, s26, v0
    v_xor_b32 v3, 0x2000, v2
    s_nop 7
    s_cmp_eq_u32 s25, 0
    s_cbranch_scc1 L_kh_36
    ds_write_b128 v2, v[16:19]
    ds_write_b128 v2, v[20:23] offset:1024
    s_nop 1
    v_mov_b32 v16, v24
    v_mov_b32 v17, v25
    v_mov_b32 v18, v26
    v_mov_b32 v19, v27
    v_mov_b32 v20, v28
    v_mov_b32 v21, v29
    v_mov_b32 v22, v30
    v_mov_b32 v23, v31
    s_branch L_khd_37
L_kh_36:
    ds_write_b128 v2, v[24:27]
    ds_write_b128 v2, v[28:31] offset:1024
L_khd_37:
    s_waitcnt lgkmcnt(0)
    s_barrier
    ds_read_b128 v[24:27], v3
    ds_read_b128 v[28:31], v3 offset:1024
    s_waitcnt lgkmcnt(0)
    v_pk_add_f32 v[16:17], v[16:17], v[24:25]
    v_pk_add_f32 v[18:19], v[18:19], v[26:27]
    v_pk_add_f32 v[20:21], v[20:21], v[28:29]
    v_pk_add_f32 v[22:23], v[22:23], v[30:31]
    s_lshl_b32 s26, s20, 9
    s_add_u32 s26, s26, 0x27000
    v_add_u32 v6, s26, v1
    ds_read_b128 v[128:131], v6 offset:0
    ds_read_b128 v[132:135], v6 offset:32
    ds_read_b128 v[136:139], v6 offset:64
    ds_read_b128 v[140:143], v6 offset:96
    ds_read_b128 v[144:147], v6 offset:128
    ds_read_b128 v[148:151], v6 offset:160
    ds_read_b128 v[152:155], v6 offset:192
    ds_read_b128 v[156:159], v6 offset:224
    v_lshlrev_b32 v2, 16, v12
    v_and_b32 v3, 0xffff0000, v12
    v_add_f32 v16, v16, v2
    v_add_f32 v17, v17, v3
    v_lshlrev_b32 v2, 16, v13
    v_and_b32 v3, 0xffff0000, v13
    v_add_f32 v18, v18, v2
    v_add_f32 v19, v19, v3
    v_lshlrev_b32 v2, 16, v14
    v_and_b32 v3, 0xffff0000, v14
    v_add_f32 v20, v20, v2
    v_add_f32 v21, v21, v3
    v_lshlrev_b32 v2, 16, v15
    v_and_b32 v3, 0xffff0000, v15
    v_add_f32 v22, v22, v2
    v_add_f32 v23, v23, v3
    v_cvt_pk_bf16_f32 v12, v16, v17
    v_cvt_pk_bf16_f32 v13, v18, v19
    v_cvt_pk_bf16_f32 v14, v20, v21
    v_cvt_pk_bf16_f32 v15, v22, v23
    s_add_u32 s26, s34, 0x400000
    s_cmp_lg_u32 s37, 0
    s_cbranch_scc1 L_hs_38
    buffer_store_dwordx4 v[12:15], v0, s[4:7], s26 offen sc1
    s_branch L_hsd_39
L_hs_38:
    buffer_store_dwordx4 v[12:15], v0, s[4:7], s26 offen
L_hsd_39:
    v_pk_mul_f32 v[4:5], v[16:17], v[16:17]
    v_pk_add_f32 v[2:3], v[16:17], v[18:19]
    v_pk_fma_f32 v[4:5], v[18:19], v[18:19], v[4:5]
    v_pk_fma_f32 v[4:5], v[20:21], v[20:21], v[4:5]
    v_pk_fma_f32 v[4:5], v[22:23], v[22:23], v[4:5]
    v_pk_add_f32 v[2:3], v[2:3], v[20:21]
    v_pk_add_f32 v[2:3], v[2:3], v[22:23]
    v_add_f32 v2, v2, v3
    v_add_f32 v3, v4, v5
    v_mov_b32 v4, v2
    s_nop 1
    v_permlane32_swap_b32 v2, v4
    s_nop 1
    v_add_f32 v2, v2, v4
    v_mov_b32 v4, v3
    s_nop 1
    v_permlane32_swap_b32 v3, v4
    s_nop 1
    v_add_f32 v3, v3, v4
    v_or_b32 v3, 0x80000000, v3
    s_add_u32 s26, s31, 0x1900000
    v_lshlrev_b32 v4, 1, v0
    s_mov_b64 exec, 0xffffffff
    s_waitcnt vmcnt(0)
    s_cmp_lg_u32 s37, 0
    s_cbranch_scc1 L_hs_40
    buffer_store_dwordx2 v[2:3], v4, s[4:7], s26 offen sc1
    s_branch L_hsd_41
L_hs_40:
    buffer_store_dwordx2 v[2:3], v4, s[4:7], s26 offen
L_hsd_41:
    s_mov_b64 exec, -1
    s_lshl_b32 s26, s22, 14
    s_lshl_b32 s27, s20, 11
    s_add_u32 s26, s26, s27
    s_add_u32 s26, s26, 0x1900000
    v_lshlrev_b32 v3, 1, v0
    s_mov_b32 s36, 200000
L_poll_42:
    buffer_load_dwordx4 v[16:19], v3, s[4:7], s26 offen offset:0 sc1
    buffer_load_dwordx4 v[20:23], v3, s[4:7], s26 offen offset:16 sc1
    s_waitcnt vmcnt(0)
    v_and_b32 v2, v17, v19
    v_and_b32 v4, v21, v23
    v_and_b32 v2, v2, v4
    v_cmp_gt_i32 vcc, 0, v2
    s_cmp_eq_u64 vcc, exec
    s_cbranch_scc1 L_polld_43
    s_sub_u32 s36, s36, 1
    s_cmp_lg_u32 s36, 0
    s_cbranch_scc1 L_poll_42
L_polld_43:
    s_lshl_b32 s26, s22, 16
    s_lshl_b32 s27, s20, 12
    s_add_u32 s26, s26, s27
    s_add_u32 s26, s26, 0x400000
    s_add_u32 s27, s27, 0x0
    s_add_u32 s28, s26, 0x8000
    s_add_u32 s29, s27, 0x8000
    s_mov_b32 m0, s27
    s_nop 0
    buffer_load_dwordx4 v0, s[4:7], s26 offen offset:0 sc1 lds
    buffer_load_dwordx4 v0, s[4:7], s26 offen offset:1024 sc1 lds
    s_mov_b32 m0, s29
    s_nop 0
    buffer_load_dwordx4 v0, s[4:7], s28 offen offset:0 sc1 lds
    buffer_load_dwordx4 v0, s[4:7], s28 offen offset:1024 sc1 lds
    s_mov_b32 m0, s27
    s_nop 0
    buffer_load_dwordx4 v0, s[4:7], s26 offen offset:2048 sc1 lds
    buffer_load_dwordx4 v0, s[4:7], s26 offen offset:3072 sc1 lds
    s_mov_b32 m0, s29
    s_nop 0
    buffer_load_dwordx4 v0, s[4:7], s28 offen offset:2048 sc1 lds
    buffer_load_dwordx4 v0, s[4:7], s28 offen offset:3072 sc1 lds
    v_pk_add_f32 v[16:17], v[16:17], v[18:19]
    v_pk_add_f32 v[20:21], v[20:21], v[22:23]
    s_lshl_b32 s28, s20, 9
    s_add_u32 s28, s28, 0x24000
    v_lshrrev_b32 v3, 1, v0
    v_add_u32 v3, s28, v3
    v_pk_add_f32 v[16:17], v[16:17], v[20:21]
    ds_write_b64 v3, v[16:17]
    s_mul_i32 s44, s21, 172
    s_lshl_b32 s45, s33, 1
    s_add_u32 s44, s44, s45
    s_lshl_b32 s44, s44, 10
    s_add_u32 s44, s44, 0x260000
    s_add_u32 s45, s44, 88064
    s_waitcnt vmcnt(4) lgkmcnt(0)
    s_barrier
    s_cmp_ge_u32 s20, 4
    s_cbranch_scc1 L_f1hi_44
    v_add_u32 v2, 0x0, v0
    ds_read_b128 v[48:51], v2 offset:0
    ds_read_b128 v[52:55], v2 offset:32768
    ds_read_b128 v[56:59], v2 offset:1024
    ds_read_b128 v[60:63], v2 offset:33792
    ds_read_b128 v[96:99], v2 offset:4096
    ds_read_b128 v[100:103], v2 offset:36864
    ds_read_b128 v[104:107], v2 offset:5120
    ds_read_b128 v[108:111], v2 offset:37888
    s_waitcnt lgkmcnt(6)
    v_mfma_f32_32x32x16_bf16 v[16:31], v[160:163], v[48:51], 0
    v_mfma_f32_32x32x16_bf16 v[32:47], v[160:163], v[52:55], 0
    ds_read_b128 v[48:51], v2 offset:8192
    ds_read_b128 v[52:55], v2 offset:40960
    buffer_load_dwordx4 v[112:115], v0, s[4:7], s44 offen offset:0
    s_waitcnt lgkmcnt(6)
    v_mfma_f32_32x32x16_bf16 v[16:31], v[164:167], v[56:59], v[16:31]
    v_mfma_f32_32x32x16_bf16 v[32:47], v[164:167], v[60:63], v[32:47]
    ds_read_b128 v[56:59], v2 offset:9216
    ds_read_b128 v[60:63], v2 offset:41984
    buffer_load_dwordx4 v[116:119], v0, s[4:7], s45 offen offset:0
    s_waitcnt lgkmcnt(6)
    v_mfma_f32_32x32x16_bf16 v[16:31], v[168:171], v[96:99], v[16:31]
    v_mfma_f32_32x32x16_bf16 v[32:47], v[168:171], v[100:103], v[32:47]
    ds_read_b128 v[96:99], v2 offset:12288
    ds_read_b128 v[100:103], v2 offset:45056
    buffer_load_dwordx4 v[120:123], v0, s[4:7], s44 offen offset:1024
    s_waitcnt lgkmcnt(6)
    v_mfma_f32_32x32x16_bf16 v[16:31], v[172:175], v[104:107], v[16:31]
    v_mfma_f32_32x32x16_bf16 v[32:47], v[172:175], v[108:111], v[32:47]
    ds_read_b128 v[104:107], v2 offset:13312
    ds_read_b128 v[108:111], v2 offset:46080
    buffer_load_dwordx4 v[124:127], v0, s[4:7], s45 offen offset:1024
    s_waitcnt lgkmcnt(6)
    v_mfma_f32_32x32x16_bf16 v[16:31], v[176:179], v[48:51], v[16:31]
    v_mfma_f32_32x32x16_bf16 v[32:47], v[176:179], v[52:55], v[32:47]
    ds_read_b128 v[48:51], v2 offset:16384
    ds_read_b128 v[52:55], v2 offset:49152
    buffer_load_dwordx4 v[160:163], v0, s[4:7], s44 offen offset:2048
    s_waitcnt lgkmcnt(6)
    v_mfma_f32_32x32x16_bf16 v[16:31], v[180:183], v[56:59], v[16:31]
    v_mfma_f32_32x32x16_bf16 v[32:47], v[180:183], v[60:63], v[32:47]
    ds_read_b128 v[56:59], v2 offset:17408
    ds_read_b128 v[60:63], v2 offset:50176
    buffer_load_dwordx4 v[164:167], v0, s[4:7], s45 offen offset:2048
    s_waitcnt lgkmcnt(6)
    v_mfma_f32_32x32x16_bf16 v[16:31], v[184:187], v[96:99], v[16:31]
    v_mfma_f32_32x32x16_bf16 v[32:47], v[184:187], v[100:103], v[32:47]
    ds_read_b128 v[96:99], v2 offset:20480
    ds_read_b128 v[100:103], v2 offset:53248
    buffer_load_dwordx4 v[168:171], v0, s[4:7], s44 offen offset:3072
    s_waitcnt lgkmcnt(6)
    v_mfma_f32_32x32x16_bf16 v[16:31], v[188:191], v[104:107], v[16:31]
    v_mfma_f32_32x32x16_bf16 v[32:47], v[188:191], v[108:111], v[32:47]
    ds_read_b128 v[104:107], v2 offset:21504
    ds_read_b128 v[108:111], v2 offset:54272
    buffer_load_dwordx4 v[172:175], v0, s[4:7], s45 offen offset:3072
    s_waitcnt lgkmcnt(6)
    v_mfma_f32_32x32x16_bf16 v[16:31], v[192:195], v[48:51], v[16:31]
    v_mfma_f32_32x32x16_bf16 v[32:47], v[192:195], v[52:55], v[32:47]
    ds_read_b128 v[48:51], v2 offset:24576
    ds_read_b128 v[52:55], v2 offset:57344
    s_add_u32 s44, s44, 4096
    s_add_u32 s45, s45, 4096
    buffer_load_dwordx4 v[176:179], v0, s[4:7], s44 offen offset:0
    s_waitcnt lgkmcnt(6)
    v_mfma_f32_32x32x16_bf16 v[16:31], v[196:199], v[56:59], v[16:31]
    v_mfma_f32_32x32x16_bf16 v[32:47], v[196:199], v[60:63], v[32:47]
    s_waitcnt vmcnt(9)
    s_barrier
    ds_read_b128 v[56:59], v2 offset:25600
    ds_read_b128 v[60:63], v2 offset:58368
    buffer_load_dwordx4 v[180:183], v0, s[4:7], s45 offen offset:0
    s_waitcnt lgkmcnt(6)
    v_mfma_f32_32x32x16_bf16 v[16:31], v[200:203], v[96:99], v[16:31]
    v_mfma_f32_32x32x16_bf16 v[32:47], v[200:203], v[100:103], v[32:47]
    ds_read_b128 v[96:99], v2 offset:28672
    ds_read_b128 v[100:103], v2 offset:61440
    buffer_load_dwordx4 v[184:187], v0, s[4:7], s44 offen offset:1024
    s_waitcnt lgkmcnt(6)
    v_mfma_f32_32x32x16_bf16 v[16:31], v[204:207], v[104:107], v[16:31]
    v_mfma_f32_32x32x16_bf16 v[32:47], v[204:207], v[108:111], v[32:47]
    ds_read_b128 v[104:107], v2 offset:29696
    ds_read_b128 v[108:111], v2 offset:62464
    buffer_load_dwordx4 v[188:191], v0, s[4:7], s45 offen offset:1024
    s_waitcnt lgkmcnt(6)
    v_mfma_f32_32x32x16_bf16 v[16:31], v[208:211], v[48:51], v[16:31]
    v_mfma_f32_32x32x16_bf16 v[32:47], v[208:211], v[52:55], v[32:47]
    ds_read_b128 v[48:51], v2 offset:2048
    ds_read_b128 v[52:55], v2 offset:34816
    buffer_load_dwordx4 v[192:195], v0, s[4:7], s44 offen offset:2048
    s_waitcnt lgkmcnt(6)
    v_mfma_f32_32x32x16_bf16 v[16:31], v[212:215], v[56:59], v[16:31]
    v_mfma_f32_32x32x16_bf16 v[32:47], v[212:215], v[60:63], v[32:47]
    ds_read_b128 v[56:59], v2 offset:3072
    ds_read_b128 v[60:63], v2 offset:35840
    buffer_load_dwordx4 v[196:199], v0, s[4:7], s45 offen offset:2048
    s_waitcnt lgkmcnt(6)
    v_mfma_f32_32x32x16_bf16 v[16:31], v[216:219], v[96:99], v[16:31]
    v_mfma_f32_32x32x16_bf16 v[32:47], v[216:219], v[100:103], v[32:47]
    ds_read_b128 v[96:99], v2 offset:6144
    ds_read_b128 v[100:103], v2 offset:38912
    buffer_load_dwordx4 v[200:203], v0, s[4:7], s44 offen offset:3072
    s_waitcnt lgkmcnt(6)
    v_mfma_f32_32x32x16_bf16 v[16:31], v[220:223], v[104:107], v[16:31]
    v_mfma_f32_32x32x16_bf16 v[32:47], v[220:223], v[108:111], v[32:47]
    ds_read_b128 v[104:107], v2 offset:7168
    ds_read_b128 v[108:111], v2 offset:39936
    buffer_load_dwordx4 v[204:207], v0, s[4:7], s45 offen offset:3072
    s_waitcnt lgkmcnt(6)
    v_mfma_f32_32x32x16_bf16 v[16:31], v[224:227], v[48:51], v[16:31]
    v_mfma_f32_32x32x16_bf16 v[32:47], v[224:227], v[52:55], v[32:47]
    ds_read_b128 v[48:51], v2 offset:10240
    ds_read_b128 v[52:55], v2 offset:43008
    s_add_u32 s44, s44, 4096
    s_add_u32 s45, s45, 4096
    buffer_load_dwordx4 v[208:211], v0, s[4:7], s44 offen offset:0
    s_waitcnt lgkmcnt(6)
    v_mfma_f32_32x32x16_bf16 v[16:31], v[228:231], v[56:59], v[16:31]
    v_mfma_f32_32x32x16_bf16 v[32:47], v[228:231], v[60:63], v[32:47]
    ds_read_b128 v[56:59], v2 offset:11264
    ds_read_b128 v[60:63], v2 offset:44032
    buffer_load_dwordx4 v[212:215], v0, s[4:7], s45 offen offset:0
    s_waitcnt lgkmcnt(6)
    v_mfma_f32_32x32x16_bf16 v[16:31], v[232:235], v[96:99], v[16:31]
    v_mfma_f32_32x32x16_bf16 v[32:47], v[232:235], v[100:103], v[32:47]
    ds_read_b128 v[96:99], v2 offset:14336
    ds_read_b128 v[100:103], v2 offset:47104
    buffer_load_dwordx4 v[216:219], v0, s[4:7], s44 offen offset:1024
    s_waitcnt lgkmcnt(6)
    v_mfma_f32_32x32x16_bf16 v[16:31], v[236:239], v[104:107], v[16:31]
    v_mfma_f32_32x32x16_bf16 v[32:47], v[236:239], v[108:111], v[32:47]
    ds_read_b128 v[104:107], v2 offset:15360
    ds_read_b128 v[108:111], v2 offset:48128
    buffer_load_dwordx4 v[220:223], v0, s[4:7], s45 offen offset:1024
    s_waitcnt lgkmcnt(6)
    v_mfma_f32_32x32x16_bf16 v[16:31], v[240:243], v[48:51], v[16:31]
    v_mfma_f32_32x32x16_bf16 v[32:47], v[240:243], v[52:55], v[32:47]
    ds_read_b128 v[48:51], v2 offset:18432
    ds_read_b128 v[52:55], v2 offset:51200
    buffer_load_dwordx4 v[224:227], v0, s[4:7], s44 offen offset:2048
    s_waitcnt lgkmcnt(6)
    v_mfma_f32_32x32x16_bf16 v[16:31], v[244:247], v[56:59], v[16:31]
    v_mfma_f32_32x32x16_bf16 v[32:47], v[244:247], v[60:63], v[32:47]
    ds_read_b128 v[56:59], v2 offset:19456
    ds_read_b128 v[60:63], v2 offset:52224
    buffer_load_dwordx4 v[228:231], v0, s[4:7], s45 offen offset:2048
    s_waitcnt lgkmcnt(6)
    v_mfma_f32_32x32x16_bf16 v[16:31], v[248:251], v[96:99], v[16:31]
    v_mfma_f32_32x32x16_bf16 v[32:47], v[248:251], v[100:103], v[32:47]
    ds_read_b128 v[96:99], v2 offset:22528
    ds_read_b128 v[100:103], v2 offset:55296
    buffer_load_dwordx4 v[232:235], v0, s[4:7], s44 offen offset:3072
    s_waitcnt lgkmcnt(6)
    v_mfma_f32_32x32x16_bf16 v[16:31], v[252:255], v[104:107], v[16:31]
    v_mfma_f32_32x32x16_bf16 v[32:47], v[252:255], v[108:111], v[32:47]
    ds_read_b128 v[104:107], v2 offset:23552
    ds_read_b128 v[108:111], v2 offset:56320
    buffer_load_dwordx4 v[236:239], v0, s[4:7], s45 offen offset:3072
    s_waitcnt lgkmcnt(6)
    v_mfma_f32_32x32x16_bf16 v[16:31], v[64:67], v[48:51], v[16:31]
    v_mfma_f32_32x32x16_bf16 v[32:47], v[64:67], v[52:55], v[32:47]
    ds_read_b128 v[48:51], v2 offset:26624
    ds_read_b128 v[52:55], v2 offset:59392
    s_waitcnt lgkmcnt(6)
    v_mfma_f32_32x32x16_bf16 v[16:31], v[68:71], v[56:59], v[16:31]
    v_mfma_f32_32x32x16_bf16 v[32:47], v[68:71], v[60:63], v[32:47]
    ds_read_b128 v[56:59], v2 offset:27648
    ds_read_b128 v[60:63], v2 offset:60416
    s_waitcnt lgkmcnt(6)
    v_mfma_f32_32x32x16_bf16 v[16:31], v[72:75], v[96:99], v[16:31]
    v_mfma_f32_32x32x16_bf16 v[32:47], v[72:75], v[100:103], v[32:47]
    ds_read_b128 v[96:99], v2 offset:30720
    ds_read_b128 v[100:103], v2 offset:63488
    s_waitcnt lgkmcnt(6)
    v_mfma_f32_32x32x16_bf16 v[16:31], v[76:79], v[104:107], v[16:31]
    v_mfma_f32_32x32x16_bf16 v[32:47], v[76:79], v[108:111], v[32:47]
    ds_read_b128 v[104:107], v2 offset:31744
    ds_read_b128 v[108:111], v2 offset:64512
    s_waitcnt lgkmcnt(6)
    v_mfma_f32_32x32x16_bf16 v[16:31], v[80:83], v[48:51], v[16:31]
    v_mfma_f32_32x32x16_bf16 v[32:47], v[80:83], v[52:55], v[32:47]
    v_and_b32 v3, 0x1f0, v0
    v_lshrrev_b32 v3, 1, v3
    v_add_u32 v3, 0x24000, v3
    ds_read2st64_b64 v[240:243], v3 offset0:0 offset1:1
    ds_read2st64_b64 v[244:247], v3 offset0:2 offset1:3
    ds_read2st64_b64 v[248:251], v3 offset0:4 offset1:5
    ds_read2st64_b64 v[252:255], v3 offset0:6 offset1:7
    v_and_b32 v3, 0x1f0, v0
    v_lshrrev_b32 v3, 1, v3
    v_add_u32 v3, 0x24100, v3
    ds_read2st64_b64 v[64:67], v3 offset0:0 offset1:1
    ds_read2st64_b64 v[68:71], v3 offset0:2 offset1:3
    ds_read2st64_b64 v[72:75], v3 offset0:4 offset1:5
    ds_read2st64_b64 v[76:79], v3 offset0:6 offset1:7
    s_waitcnt lgkmcnt(12)
    v_mfma_f32_32x32x16_bf16 v[16:31], v[84:87], v[56:59], v[16:31]
    v_mfma_f32_32x32x16_bf16 v[32:47], v[84:87], v[60:63], v[32:47]
    s_waitcnt lgkmcnt(10)
    v_mfma_f32_32x32x16_bf16 v[16:31], v[88:91], v[96:99], v[16:31]
    v_mfma_f32_32x32x16_bf16 v[32:47], v[88:91], v[100:103], v[32:47]
    s_waitcnt lgkmcnt(8)
    v_mfma_f32_32x32x16_bf16 v[16:31], v[92:95], v[104:107], v[16:31]
    v_mfma_f32_32x32x16_bf16 v[32:47], v[92:95], v[108:111], v[32:47]
    s_waitcnt lgkmcnt(0)
    v_pk_add_f32 v[240:241], v[240:241], v[248:249]
    v_pk_add_f32 v[242:243], v[242:243], v[250:251]
    v_pk_add_f32 v[244:245], v[244:245], v[252:253]
    v_pk_add_f32 v[246:247], v[246:247], v[254:255]
    v_pk_add_f32 v[240:241], v[240:241], v[244:245]
    v_pk_add_f32 v[242:243], v[242:243], v[246:247]
    v_pk_add_f32 v[4:5], v[240:241], v[242:243]
    v_pk_add_f32 v[64:65], v[64:65], v[72:73]
    v_pk_add_f32 v[66:67], v[66:67], v[74:75]
    v_pk_add_f32 v[68:69], v[68:69], v[76:77]
    v_pk_add_f32 v[70:71], v[70:71], v[78:79]
    v_pk_add_f32 v[64:65], v[64:65], v[68:69]
    v_pk_add_f32 v[66:67], v[66:67], v[70:71]
    v_pk_add_f32 v[6:7], v[64:65], v[66:67]
    v_mul_f32 v4, 0xbb000000, v4
    v_mul_f32 v5, 0xbb000000, v5
    v_fma_f32 v5, -v4, v4, v5
    v_max_f32 v5, 0, v5
    v_add_f32 v5, 0x3727c5ac, v5
    v_rsq_f32 v5, v5
    s_nop 0
    v_mul_f32 v6, 0xbb000000, v6
    v_mul_f32 v7, 0xbb000000, v7
    v_fma_f32 v7, -v6, v6, v7
    v_max_f32 v7, 0, v7
    v_add_f32 v7, 0x3727c5ac, v7
    v_rsq_f32 v7, v7
    s_nop 0
    s_mov_b32 s42, 0xbdd2d3e8
    s_mov_b32 s43, s42
    v_mov_b32 v2, 0xc0135761
    v_mov_b32 v3, v2
    s_mul_i32 s26, s22, 172
    s_lshl_b32 s27, s32, 1
    s_add_u32 s26, s26, s27
    s_lshl_b32 s26, s26, 10
    s_add_u32 s26, s26, 0x1000000
    s_add_u32 s27, s26, 88064
    v_pk_fma_f32 v[16:17], v[4:5], v[128:129], v[16:17] op_sel_hi:[0,1,1]
    v_pk_fma_f32 v[18:19], v[4:5], v[130:131], v[18:19] op_sel_hi:[0,1,1]
    v_pk_fma_f32 v[20:21], v[4:5], v[132:133], v[20:21] op_sel_hi:[0,1,1]
    v_pk_fma_f32 v[22:23], v[4:5], v[134:135], v[22:23] op_sel_hi:[0,1,1]
    v_pk_fma_f32 v[24:25], v[4:5], v[136:137], v[24:25] op_sel_hi:[0,1,1]
    v_pk_fma_f32 v[26:27], v[4:5], v[138:139], v[26:27] op_sel_hi:[0,1,1]
    v_pk_fma_f32 v[28:29], v[4:5], v[140:141], v[28:29] op_sel_hi:[0,1,1]
    v_pk_fma_f32 v[30:31], v[4:5], v[142:143], v[30:31] op_sel_hi:[0,1,1]
    v_pk_fma_f32 v[16:17], v[4:5], v[16:17], v[144:145] op_sel:[1,0,0]
    v_pk_fma_f32 v[18:19], v[4:5], v[18:19], v[146:147] op_sel:[1,0,0]
    v_pk_fma_f32 v[20:21], v[4:5], v[20:21], v[148:149] op_sel:[1,0,0]
    v_pk_fma_f32 v[22:23], v[4:5], v[22:23], v[150:151] op_sel:[1,0,0]
    v_pk_fma_f32 v[24:25], v[4:5], v[24:25], v[152:153] op_sel:[1,0,0]
    v_pk_fma_f32 v[26:27], v[4:5], v[26:27], v[154:155] op_sel:[1,0,0]
    v_pk_fma_f32 v[28:29], v[4:5], v[28:29], v[156:157] op_sel:[1,0,0]
    v_pk_fma_f32 v[30:31], v[4:5], v[30:31], v[158:159] op_sel:[1,0,0]
    v_pk_mul_f32 v[48:49], v[16:17], v[16:17]
    v_pk_mul_f32 v[50:51], v[18:19], v[18:19]
    v_pk_mul_f32 v[52:53], v[20:21], v[20:21]
    v_pk_mul_f32 v[54:55], v[22:23], v[22:23]
    v_pk_mul_f32 v[56:57], v[24:25], v[24:25]
    v_pk_mul_f32 v[58:59], v[26:27], v[26:27]
    v_pk_mul_f32 v[60:61], v[28:29], v[28:29]
    v_pk_mul_f32 v[62:63], v[30:31], v[30:31]
    v_pk_fma_f32 v[48:49], v[48:49], s[42:43], v[2:3]
    v_pk_fma_f32 v[50:51], v[50:51], s[42:43], v[2:3]
    v_pk_fma_f32 v[52:53], v[52:53], s[42:43], v[2:3]
    v_pk_fma_f32 v[54:55], v[54:55], s[42:43], v[2:3]
    v_pk_fma_f32 v[56:57], v[56:57], s[42:43], v[2:3]
    v_pk_fma_f32 v[58:59], v[58:59], s[42:43], v[2:3]
    v_pk_fma_f32 v[60:61], v[60:61], s[42:43], v[2:3]
    v_pk_fma_f32 v[62:63], v[62:63], s[42:43], v[2:3]
    v_pk_mul_f32 v[48:49], v[48:49], v[16:17]
    v_pk_mul_f32 v[50:51], v[50:51], v[18:19]
    v_pk_mul_f32 v[52:53], v[52:53], v[20:21]
    v_pk_mul_f32 v[54:55], v[54:55], v[22:23]
    v_pk_mul_f32 v[56:57], v[56:57], v[24:25]
    v_pk_mul_f32 v[58:59], v[58:59], v[26:27]
    v_pk_mul_f32 v[60:61], v[60:61], v[28:29]
    v_pk_mul_f32 v[62:63], v[62:63], v[30:31]
    v_exp_f32 v48, v48
    v_exp_f32 v49, v49
    v_exp_f32 v50, v50
    v_exp_f32 v51, v51
    v_exp_f32 v52, v52
    v_exp_f32 v53, v53
    v_exp_f32 v54, v54
    v_exp_f32 v55, v55
    v_exp_f32 v56, v56
    v_exp_f32 v57, v57
    v_exp_f32 v58, v58
    v_exp_f32 v59, v59
    v_exp_f32 v60, v60
    v_exp_f32 v61, v61
    v_exp_f32 v62, v62
    v_exp_f32 v63, v63
    v_pk_add_f32 v[48:49], v[48:49], 1.0 op_sel_hi:[1,0]
    v_pk_add_f32 v[50:51], v[50:51], 1.0 op_sel_hi:[1,0]
    v_pk_add_f32 v[52:53], v[52:53], 1.0 op_sel_hi:[1,0]
    v_pk_add_f32 v[54:55], v[54:55], 1.0 op_sel_hi:[1,0]
    v_pk_add_f32 v[56:57], v[56:57], 1.0 op_sel_hi:[1,0]
    v_pk_add_f32 v[58:59], v[58:59], 1.0 op_sel_hi:[1,0]
    v_pk_add_f32 v[60:61], v[60:61], 1.0 op_sel_hi:[1,0]
    v_pk_add_f32 v[62:63], v[62:63], 1.0 op_sel_hi:[1,0]
    v_rcp_f32 v48, v48
    v_rcp_f32 v49, v49
    v_rcp_f32 v50, v50
    v_rcp_f32 v51, v51
    v_rcp_f32 v52, v52
    v_rcp_f32 v53, v53
    v_rcp_f32 v54, v54
    v_rcp_f32 v55, v55
    v_rcp_f32 v56, v56
    v_rcp_f32 v57, v57
    v_rcp_f32 v58, v58
    v_rcp_f32 v59, v59
    v_rcp_f32 v60, v60
    v_rcp_f32 v61, v61
    v_rcp_f32 v62, v62
    v_rcp_f32 v63, v63
    v_pk_mul_f32 v[16:17], v[16:17], v[48:49]
    v_pk_mul_f32 v[18:19], v[18:19], v[50:51]
    v_pk_mul_f32 v[20:21], v[20:21], v[52:53]
    v_pk_mul_f32 v[22:23], v[22:23], v[54:55]
    v_pk_mul_f32 v[24:25], v[24:25], v[56:57]
    v_pk_mul_f32 v[26:27], v[26:27], v[58:59]
    v_pk_mul_f32 v[28:29], v[28:29], v[60:61]
    v_pk_mul_f32 v[30:31], v[30:31], v[62:63]
    v_cvt_pk_bf16_f32 v16, v16, v17
    v_cvt_pk_bf16_f32 v17, v18, v19
    v_cvt_pk_bf16_f32 v18, v20, v21
    v_cvt_pk_bf16_f32 v19, v22, v23
    v_cvt_pk_bf16_f32 v20, v24, v25
    v_cvt_pk_bf16_f32 v21, v26, v27
    v_cvt_pk_bf16_f32 v22, v28, v29
    v_cvt_pk_bf16_f32 v23, v30, v31
    s_cmp_lg_u32 s37, 0
    s_cbranch_scc1 L_hs_46
    buffer_store_dwordx4 v[16:19], v0, s[4:7], s26 offen offset:0 sc1
    buffer_store_dwordx4 v[20:23], v0, s[4:7], s26 offen offset:1024 sc1
    s_branch L_hsd_47
L_hs_46:
    buffer_store_dwordx4 v[16:19], v0, s[4:7], s26 offen offset:0
    buffer_store_dwordx4 v[20:23], v0, s[4:7], s26 offen offset:1024
L_hsd_47:
    v_pk_fma_f32 v[32:33], v[6:7], v[128:129], v[32:33] op_sel_hi:[0,1,1]
    v_pk_fma_f32 v[34:35], v[6:7], v[130:131], v[34:35] op_sel_hi:[0,1,1]
    v_pk_fma_f32 v[36:37], v[6:7], v[132:133], v[36:37] op_sel_hi:[0,1,1]
    v_pk_fma_f32 v[38:39], v[6:7], v[134:135], v[38:39] op_sel_hi:[0,1,1]
    v_pk_fma_f32 v[40:41], v[6:7], v[136:137], v[40:41] op_sel_hi:[0,1,1]
    v_pk_fma_f32 v[42:43], v[6:7], v[138:139], v[42:43] op_sel_hi:[0,1,1]
    v_pk_fma_f32 v[44:45], v[6:7], v[140:141], v[44:45] op_sel_hi:[0,1,1]
    v_pk_fma_f32 v[46:47], v[6:7], v[142:143], v[46:47] op_sel_hi:[0,1,1]
    v_pk_fma_f32 v[32:33], v[6:7], v[32:33], v[144:145] op_sel:[1,0,0]
    v_pk_fma_f32 v[34:35], v[6:7], v[34:35], v[146:147] op_sel:[1,0,0]
    v_pk_fma_f32 v[36:37], v[6:7], v[36:37], v[148:149] op_sel:[1,0,0]
    v_pk_fma_f32 v[38:39], v[6:7], v[38:39], v[150:151] op_sel:[1,0,0]
    v_pk_fma_f32 v[40:41], v[6:7], v[40:41], v[152:153] op_sel:[1,0,0]
    v_pk_fma_f32 v[42:43], v[6:7], v[42:43], v[154:155] op_sel:[1,0,0]
    v_pk_fma_f32 v[44:45], v[6:7], v[44:45], v[156:157] op_sel:[1,0,0]
    v_pk_fma_f32 v[46:47], v[6:7], v[46:47], v[158:159] op_sel:[1,0,0]
    v_pk_mul_f32 v[48:49], v[32:33], v[32:33]
    v_pk_mul_f32 v[50:51], v[34:35], v[34:35]
    v_pk_mul_f32 v[52:53], v[36:37], v[36:37]
    v_pk_mul_f32 v[54:55], v[38:39], v[38:39]
    v_pk_mul_f32 v[56:57], v[40:41], v[40:41]
    v_pk_mul_f32 v[58:59], v[42:43], v[42:43]
    v_pk_mul_f32 v[60:61], v[44:45], v[44:45]
    v_pk_mul_f32 v[62:63], v[46:47], v[46:47]
    v_pk_fma_f32 v[48:49], v[48:49], s[42:43], v[2:3]
    v_pk_fma_f32 v[50:51], v[50:51], s[42:43], v[2:3]
    v_pk_fma_f32 v[52:53], v[52:53], s[42:43], v[2:3]
    v_pk_fma_f32 v[54:55], v[54:55], s[42:43], v[2:3]
    v_pk_fma_f32 v[56:57], v[56:57], s[42:43], v[2:3]
    v_pk_fma_f32 v[58:59], v[58:59], s[42:43], v[2:3]
    v_pk_fma_f32 v[60:61], v[60:61], s[42:43], v[2:3]
    v_pk_fma_f32 v[62:63], v[62:63], s[42:43], v[2:3]
    v_pk_mul_f32 v[48:49], v[48:49], v[32:33]
    v_pk_mul_f32 v[50:51], v[50:51], v[34:35]
    v_pk_mul_f32 v[52:53], v[52:53], v[36:37]
    v_pk_mul_f32 v[54:55], v[54:55], v[38:39]
    v_pk_mul_f32 v[56:57], v[56:57], v[40:41]
    v_pk_mul_f32 v[58:59], v[58:59], v[42:43]
    v_pk_mul_f32 v[60:61], v[60:61], v[44:45]
    v_pk_mul_f32 v[62:63], v[62:63], v[46:47]
    v_exp_f32 v48, v48
    v_exp_f32 v49, v49
    v_exp_f32 v50, v50
    v_exp_f32 v51, v51
    v_exp_f32 v52, v52
    v_exp_f32 v53, v53
    v_exp_f32 v54, v54
    v_exp_f32 v55, v55
    v_exp_f32 v56, v56
    v_exp_f32 v57, v57
    v_exp_f32 v58, v58
    v_exp_f32 v59, v59
    v_exp_f32 v60, v60
    v_exp_f32 v61, v61
    v_exp_f32 v62, v62
    v_exp_f32 v63, v63
    v_pk_add_f32 v[48:49], v[48:49], 1.0 op_sel_hi:[1,0]
    v_pk_add_f32 v[50:51], v[50:51], 1.0 op_sel_hi:[1,0]
    v_pk_add_f32 v[52:53], v[52:53], 1.0 op_sel_hi:[1,0]
    v_pk_add_f32 v[54:55], v[54:55], 1.0 op_sel_hi:[1,0]
    v_pk_add_f32 v[56:57], v[56:57], 1.0 op_sel_hi:[1,0]
    v_pk_add_f32 v[58:59], v[58:59], 1.0 op_sel_hi:[1,0]
    v_pk_add_f32 v[60:61], v[60:61], 1.0 op_sel_hi:[1,0]
    v_pk_add_f32 v[62:63], v[62:63], 1.0 op_sel_hi:[1,0]
    v_rcp_f32 v48, v48
    v_rcp_f32 v49, v49
    v_rcp_f32 v50, v50
    v_rcp_f32 v51, v51
    v_rcp_f32 v52, v52
    v_rcp_f32 v53, v53
    v_rcp_f32 v54, v54
    v_rcp_f32 v55, v55
    v_rcp_f32 v56, v56
    v_rcp_f32 v57, v57
    v_rcp_f32 v58, v58
    v_rcp_f32 v59, v59
    v_rcp_f32 v60, v60
    v_rcp_f32 v61, v61
    v_rcp_f32 v62, v62
    v_rcp_f32 v63, v63
    v_pk_mul_f32 v[32:33], v[32:33], v[48:49]
    v_pk_mul_f32 v[34:35], v[34:35], v[50:51]
    v_pk_mul_f32 v[36:37], v[36:37], v[52:53]
    v_pk_mul_f32 v[38:39], v[38:39], v[54:55]
    v_pk_mul_f32 v[40:41], v[40:41], v[56:57]
    v_pk_mul_f32 v[42:43], v[42:43], v[58:59]
    v_pk_mul_f32 v[44:45], v[44:45], v[60:61]
    v_pk_mul_f32 v[46:47], v[46:47], v[62:63]
    v_cvt_pk_bf16_f32 v32, v32, v33
    v_cvt_pk_bf16_f32 v33, v34, v35
    v_cvt_pk_bf16_f32 v34, v36, v37
    v_cvt_pk_bf16_f32 v35, v38, v39
    v_cvt_pk_bf16_f32 v36, v40, v41
    v_cvt_pk_bf16_f32 v37, v42, v43
    v_cvt_pk_bf16_f32 v38, v44, v45
    v_cvt_pk_bf16_f32 v39, v46, v47
    s_cmp_lg_u32 s37, 0
    s_cbranch_scc1 L_hs_48
    buffer_store_dwordx4 v[32:35], v0, s[4:7], s27 offen offset:0 sc1
    buffer_store_dwordx4 v[36:39], v0, s[4:7], s27 offen offset:1024 sc1
    s_branch L_hsd_49
L_hs_48:
    buffer_store_dwordx4 v[32:35], v0, s[4:7], s27 offen offset:0
    buffer_store_dwordx4 v[36:39], v0, s[4:7], s27 offen offset:1024
L_hsd_49:
    s_branch L_f1j_45
L_f1hi_44:
    s_cmp_ge_u32 s21, 3
    s_cselect_b32 s30, 6, 8
    s_cmp_ge_u32 s20, s30
    s_cbranch_scc1 L_f1sk_50
    s_lshl_b32 s30, s24, 15
    s_add_u32 s30, s30, 0x0
    v_add_u32 v2, s30, v0
    v_and_b32 v3, 0x1f0, v0
    v_lshrrev_b32 v3, 1, v3
    s_lshl_b32 s28, s24, 8
    s_add_u32 s28, s28, 0x24000
    v_add_u32 v3, s28, v3
    ds_read2st64_b64 v[32:35], v3 offset0:0 offset1:1
    ds_read2st64_b64 v[36:39], v3 offset0:2 offset1:3
    ds_read2st64_b64 v[40:43], v3 offset0:4 offset1:5
    ds_read2st64_b64 v[44:47], v3 offset0:6 offset1:7
    ds_read_b128 v[48:51], v2 offset:0
    ds_read_b128 v[52:55], v2 offset:1024
    ds_read_b128 v[56:59], v2 offset:4096
    ds_read_b128 v[60:63], v2 offset:5120
    ds_read_b128 v[96:99], v2 offset:8192
    ds_read_b128 v[100:103], v2 offset:9216
    ds_read_b128 v[104:107], v2 offset:12288
    ds_read_b128 v[108:111], v2 offset:13312
    s_waitcnt lgkmcnt(7)
    v_mfma_f32_32x32x16_bf16 v[16:31], v[160:163], v[48:51], 0
    ds_read_b128 v[48:51], v2 offset:16384
    buffer_load_dwordx4 v[112:115], v0, s[4:7], s44 offen offset:0
    s_waitcnt lgkmcnt(7)
    v_mfma_f32_32x32x16_bf16 v[16:31], v[164:167], v[52:55], v[16:31]
    ds_read_b128 v[52:55], v2 offset:17408
    buffer_load_dwordx4 v[116:119], v0, s[4:7], s45 offen offset:0
    s_waitcnt lgkmcnt(7)
    v_mfma_f32_32x32x16_bf16 v[16:31], v[168:171], v[56:59], v[16:31]
    ds_read_b128 v[56:59], v2 offset:20480
    buffer_load_dwordx4 v[120:123], v0, s[4:7], s44 offen offset:1024
    s_waitcnt lgkmcnt(7)
    v_mfma_f32_32x32x16_bf16 v[16:31], v[172:175], v[60:63], v[16:31]
    ds_read_b128 v[60:63], v2 offset:21504
    buffer_load_dwordx4 v[124:127], v0, s[4:7], s45 offen offset:1024
    s_waitcnt lgkmcnt(7)
    v_mfma_f32_32x32x16_bf16 v[16:31], v[176:179], v[96:99], v[16:31]
    ds_read_b128 v[96:99], v2 offset:24576
    buffer_load_dwordx4 v[160:163], v0, s[4:7], s44 offen offset:2048
    s_waitcnt lgkmcnt(7)
    v_mfma_f32_32x32x16_bf16 v[16:31], v[180:183], v[100:103], v[16:31]
    ds_read_b128 v[100:103], v2 offset:25600
    buffer_load_dwordx4 v[164:167], v0, s[4:7], s45 offen offset:2048
    s_waitcnt lgkmcnt(7)
    v_mfma_f32_32x32x16_bf16 v[16:31], v[184:187], v[104:107], v[16:31]
    ds_read_b128 v[104:107], v2 offset:28672
    buffer_load_dwordx4 v[168:171], v0, s[4:7], s44 offen offset:3072
    s_waitcnt lgkmcnt(7)
    v_mfma_f32_32x32x16_bf16 v[16:31], v[188:191], v[108:111], v[16:31]
    ds_read_b128 v[108:111], v2 offset:29696
    buffer_load_dwordx4 v[172:175], v0, s[4:7], s45 offen offset:3072
    s_waitcnt lgkmcnt(7)
    v_mfma_f32_32x32x16_bf16 v[16:31], v[192:195], v[48:51], v[16:31]
    s_waitcnt vmcnt(8)
    s_barrier
    ds_read_b128 v[48:51], v2 offset:2048
    s_add_u32 s44, s44, 4096
    s_add_u32 s45, s45, 4096
    buffer_load_dwordx4 v[176:179], v0, s[4:7], s44 offen offset:0
    s_waitcnt lgkmcnt(7)
    v_mfma_f32_32x32x16_bf16 v[16:31], v[196:199], v[52:55], v[16:31]
    ds_read_b128 v[52:55], v2 offset:3072
    buffer_load_dwordx4 v[180:183], v0, s[4:7], s45 offen offset:0
    s_waitcnt lgkmcnt(7)
    v_mfma_f32_32x32x16_bf16 v[16:31], v[200:203], v[56:59], v[16:31]
    ds_read_b128 v[56:59], v2 offset:6144
    buffer_load_dwordx4 v[184:187], v0, s[4:7], s44 offen offset:1024
    s_waitcnt lgkmcnt(7)
    v_mfma_f32_32x32x16_bf16 v[16:31], v[204:207], v[60:63], v[16:31]
    ds_read_b128 v[60:63], v2 offset:7168
    buffer_load_dwordx4 v[188:191], v0, s[4:7], s45 offen offset:1024
    s_waitcnt lgkmcnt(7)
    v_mfma_f32_32x32x16_bf16 v[16:31], v[208:211], v[96:99], v[16:31]
    ds_read_b128 v[96:99], v2 offset:10240
    buffer_load_dwordx4 v[192:195], v0, s[4:7], s44 offen offset:2048
    s_waitcnt lgkmcnt(7)
    v_mfma_f32_32x32x16_bf16 v[16:31], v[212:215], v[100:103], v[16:31]
    ds_read_b128 v[100:103], v2 offset:11264
    buffer_load_dwordx4 v[196:199], v0, s[4:7], s45 offen offset:2048
    s_waitcnt lgkmcnt(7)
    v_mfma_f32_32x32x16_bf16 v[16:31], v[216:219], v[104:107], v[16:31]
    ds_read_b128 v[104:107], v2 offset:14336
    buffer_load_dwordx4 v[200:203], v0, s[4:7], s44 offen offset:3072
    s_waitcnt lgkmcnt(7)
    v_mfma_f32_32x32x16_bf16 v[16:31], v[220:223], v[108:111], v[16:31]
    ds_read_b128 v[108:111], v2 offset:15360
    buffer_load_dwordx4 v[204:207], v0, s[4:7], s45 offen offset:3072
    s_waitcnt lgkmcnt(7)
    v_mfma_f32_32x32x16_bf16 v[16:31], v[224:227], v[48:51], v[16:31]
    ds_read_b128 v[48:51], v2 offset:18432
    s_add_u32 s44, s44, 4096
    s_add_u32 s45, s45, 4096
    buffer_load_dwordx4 v[208:211], v0, s[4:7], s44 offen offset:0
    s_waitcnt lgkmcnt(7)
    v_mfma_f32_32x32x16_bf16 v[16:31], v[228:231], v[52:55], v[16:31]
    ds_read_b128 v[52:55], v2 offset:19456
    buffer_load_dwordx4 v[212:215], v0, s[4:7], s45 offen offset:0
    s_waitcnt lgkmcnt(7)
    v_mfma_f32_32x32x16_bf16 v[16:31], v[232:235], v[56:59], v[16:31]
    ds_read_b128 v[56:59], v2 offset:22528
    buffer_load_dwordx4 v[216:219], v0, s[4:7], s44 offen offset:1024
    s_waitcnt lgkmcnt(7)
    v_mfma_f32_32x32x16_bf16 v[16:31], v[236:239], v[60:63], v[16:31]
    ds_read_b128 v[60:63], v2 offset:23552
    buffer_load_dwordx4 v[220:223], v0, s[4:7], s45 offen offset:1024
    s_waitcnt lgkmcnt(7)
    v_mfma_f32_32x32x16_bf16 v[16:31], v[240:243], v[96:99], v[16:31]
    ds_read_b128 v[96:99], v2 offset:26624
    s_waitcnt lgkmcnt(7)
    v_mfma_f32_32x32x16_bf16 v[16:31], v[244:247], v[100:103], v[16:31]
    ds_read_b128 v[100:103], v2 offset:27648
    s_waitcnt lgkmcnt(7)
    v_mfma_f32_32x32x16_bf16 v[16:31], v[248:251], v[104:107], v[16:31]
    ds_read_b128 v[104:107], v2 offset:30720
    s_waitcnt lgkmcnt(7)
    v_mfma_f32_32x32x16_bf16 v[16:31], v[252:255], v[108:111], v[16:31]
    ds_read_b128 v[108:111], v2 offset:31744
    s_waitcnt lgkmcnt(7)
    v_mfma_f32_32x32x16_bf16 v[16:31], v[64:67], v[48:51], v[16:31]
    s_waitcnt lgkmcnt(6)
    v_mfma_f32_32x32x16_bf16 v[16:31], v[68:71], v[52:55], v[16:31]
    s_waitcnt lgkmcnt(5)
    v_mfma_f32_32x32x16_bf16 v[16:31], v[72:75], v[56:59], v[16:31]
    s_waitcnt lgkmcnt(4)
    v_mfma_f32_32x32x16_bf16 v[16:31], v[76:79], v[60:63], v[16:31]
    s_waitcnt lgkmcnt(3)
    v_mfma_f32_32x32x16_bf16 v[16:31], v[80:83], v[96:99], v[16:31]
    s_waitcnt lgkmcnt(2)
    v_mfma_f32_32x32x16_bf16 v[16:31], v[84:87], v[100:103], v[16:31]
    s_waitcnt lgkmcnt(1)
    v_mfma_f32_32x32x16_bf16 v[16:31], v[88:91], v[104:107], v[16:31]
    s_waitcnt lgkmcnt(0)
    v_mfma_f32_32x32x16_bf16 v[16:31], v[92:95], v[108:111], v[16:31]
    v_pk_add_f32 v[32:33], v[32:33], v[40:41]
    v_pk_add_f32 v[34:35], v[34:35], v[42:43]
    v_pk_add_f32 v[36:37], v[36:37], v[44:45]
    v_pk_add_f32 v[38:39], v[38:39], v[46:47]
    v_pk_add_f32 v[32:33], v[32:33], v[36:37]
    v_pk_add_f32 v[34:35], v[34:35], v[38:39]
    v_pk_add_f32 v[4:5], v[32:33], v[34:35]
    v_mul_f32 v4, 0xbb000000, v4
    v_mul_f32 v5, 0xbb000000, v5
    v_fma_f32 v5, -v4, v4, v5
    v_max_f32 v5, 0, v5
    v_add_f32 v5, 0x3727c5ac, v5
    v_rsq_f32 v5, v5
    s_nop 0
    s_mov_b32 s42, 0xbdd2d3e8
    s_mov_b32 s43, s42
    v_mov_b32 v2, 0xc0135761
    v_mov_b32 v3, v2
    s_lshl_b32 s26, s22, 1
    s_add_u32 s26, s26, s24
    s_mul_i32 s26, s26, 86
    s_lshl_b32 s27, s32, 1
    s_add_u32 s26, s26, s27
    s_lshl_b32 s26, s26, 10
    s_add_u32 s26, s26, 0x1000000
    v_pk_fma_f32 v[16:17], v[4:5], v[128:129], v[16:17] op_sel_hi:[0,1,1]
    v_pk_fma_f32 v[18:19], v[4:5], v[130:131], v[18:19] op_sel_hi:[0,1,1]
    v_pk_fma_f32 v[20:21], v[4:5], v[132:133], v[20:21] op_sel_hi:[0,1,1]
    v_pk_fma_f32 v[22:23], v[4:5], v[134:135], v[22:23] op_sel_hi:[0,1,1]
    v_pk_fma_f32 v[24:25], v[4:5], v[136:137], v[24:25] op_sel_hi:[0,1,1]
    v_pk_fma_f32 v[26:27], v[4:5], v[138:139], v[26:27] op_sel_hi:[0,1,1]
    v_pk_fma_f32 v[28:29], v[4:5], v[140:141], v[28:29] op_sel_hi:[0,1,1]
    v_pk_fma_f32 v[30:31], v[4:5], v[142:143], v[30:31] op_sel_hi:[0,1,1]
    v_pk_fma_f32 v[16:17], v[4:5], v[16:17], v[144:145] op_sel:[1,0,0]
    v_pk_fma_f32 v[18:19], v[4:5], v[18:19], v[146:147] op_sel:[1,0,0]
    v_pk_fma_f32 v[20:21], v[4:5], v[20:21], v[148:149] op_sel:[1,0,0]
    v_pk_fma_f32 v[22:23], v[4:5], v[22:23], v[150:151] op_sel:[1,0,0]
    v_pk_fma_f32 v[24:25], v[4:5], v[24:25], v[152:153] op_sel:[1,0,0]
    v_pk_fma_f32 v[26:27], v[4:5], v[26:27], v[154:155] op_sel:[1,0,0]
    v_pk_fma_f32 v[28:29], v[4:5], v[28:29], v[156:157] op_sel:[1,0,0]
    v_pk_fma_f32 v[30:31], v[4:5], v[30:31], v[158:159] op_sel:[1,0,0]
    v_pk_mul_f32 v[48:49], v[16:17], v[16:17]
    v_pk_mul_f32 v[50:51], v[18:19], v[18:19]
    v_pk_mul_f32 v[52:53], v[20:21], v[20:21]
    v_pk_mul_f32 v[54:55], v[22:23], v[22:23]
    v_pk_mul_f32 v[56:57], v[24:25], v[24:25]
    v_pk_mul_f32 v[58:59], v[26:27], v[26:27]
    v_pk_mul_f32 v[60:61], v[28:29], v[28:29]
    v_pk_mul_f32 v[62:63], v[30:31], v[30:31]
    v_pk_fma_f32 v[48:49], v[48:49], s[42:43], v[2:3]
    v_pk_fma_f32 v[50:51], v[50:51], s[42:43], v[2:3]
    v_pk_fma_f32 v[52:53], v[52:53], s[42:43], v[2:3]
    v_pk_fma_f32 v[54:55], v[54:55], s[42:43], v[2:3]
    v_pk_fma_f32 v[56:57], v[56:57], s[42:43], v[2:3]
    v_pk_fma_f32 v[58:59], v[58:59], s[42:43], v[2:3]
    v_pk_fma_f32 v[60:61], v[60:61], s[42:43], v[2:3]
    v_pk_fma_f32 v[62:63], v[62:63], s[42:43], v[2:3]
    v_pk_mul_f32 v[48:49], v[48:49], v[16:17]
    v_pk_mul_f32 v[50:51], v[50:51], v[18:19]
    v_pk_mul_f32 v[52:53], v[52:53], v[20:21]
    v_pk_mul_f32 v[54:55], v[54:55], v[22:23]
    v_pk_mul_f32 v[56:57], v[56:57], v[24:25]
    v_pk_mul_f32 v[58:59], v[58:59], v[26:27]
    v_pk_mul_f32 v[60:61], v[60:61], v[28:29]
    v_pk_mul_f32 v[62:63], v[62:63], v[30:31]
    v_exp_f32 v48, v48
    v_exp_f32 v49, v49
    v_exp_f32 v50, v50
    v_exp_f32 v51, v51
    v_exp_f32 v52, v52
    v_exp_f32 v53, v53
    v_exp_f32 v54, v54
    v_exp_f32 v55, v55
    v_exp_f32 v56, v56
    v_exp_f32 v57, v57
    v_exp_f32 v58, v58
    v_exp_f32 v59, v59
    v_exp_f32 v60, v60
    v_exp_f32 v61, v61
    v_exp_f32 v62, v62
    v_exp_f32 v63, v63
    v_pk_add_f32 v[48:49], v[48:49], 1.0 op_sel_hi:[1,0]
    v_pk_add_f32 v[50:51], v[50:51], 1.0 op_sel_hi:[1,0]
    v_pk_add_f32 v[52:53], v[52:53], 1.0 op_sel_hi:[1,0]
    v_pk_add_f32 v[54:55], v[54:55], 1.0 op_sel_hi:[1,0]
    v_pk_add_f32 v[56:57], v[56:57], 1.0 op_sel_hi:[1,0]
    v_pk_add_f32 v[58:59], v[58:59], 1.0 op_sel_hi:[1,0]
    v_pk_add_f32 v[60:61], v[60:61], 1.0 op_sel_hi:[1,0]
    v_pk_add_f32 v[62:63], v[62:63], 1.0 op_sel_hi:[1,0]
    v_rcp_f32 v48, v48
    v_rcp_f32 v49, v49
    v_rcp_f32 v50, v50
    v_rcp_f32 v51, v51
    v_rcp_f32 v52, v52
    v_rcp_f32 v53, v53
    v_rcp_f32 v54, v54
    v_rcp_f32 v55, v55
    v_rcp_f32 v56, v56
    v_rcp_f32 v57, v57
    v_rcp_f32 v58, v58
    v_rcp_f32 v59, v59
    v_rcp_f32 v60, v60
    v_rcp_f32 v61, v61
    v_rcp_f32 v62, v62
    v_rcp_f32 v63, v63
    v_pk_mul_f32 v[16:17], v[16:17], v[48:49]
    v_pk_mul_f32 v[18:19], v[18:19], v[50:51]
    v_pk_mul_f32 v[20:21], v[20:21], v[52:53]
    v_pk_mul_f32 v[22:23], v[22:23], v[54:55]
    v_pk_mul_f32 v[24:25], v[24:25], v[56:57]
    v_pk_mul_f32 v[26:27], v[26:27], v[58:59]
    v_pk_mul_f32 v[28:29], v[28:29], v[60:61]
    v_pk_mul_f32 v[30:31], v[30:31], v[62:63]
    v_cvt_pk_bf16_f32 v16, v16, v17
    v_cvt_pk_bf16_f32 v17, v18, v19
    v_cvt_pk_bf16_f32 v18, v20, v21
    v_cvt_pk_bf16_f32 v19, v22, v23
    v_cvt_pk_bf16_f32 v20, v24, v25
    v_cvt_pk_bf16_f32 v21, v26, v27
    v_cvt_pk_bf16_f32 v22, v28, v29
    v_cvt_pk_bf16_f32 v23, v30, v31
    s_cmp_lg_u32 s37, 0
    s_cbranch_scc1 L_hs_51
    buffer_store_dwordx4 v[16:19], v0, s[4:7], s26 offen offset:0 sc1
    buffer_store_dwordx4 v[20:23], v0, s[4:7], s26 offen offset:1024 sc1
    s_branch L_hsd_52
L_hs_51:
    buffer_store_dwordx4 v[16:19], v0, s[4:7], s26 offen offset:0
    buffer_store_dwordx4 v[20:23], v0, s[4:7], s26 offen offset:1024
L_hsd_52:
    s_branch L_f1j_45
L_f1sk_50:
    s_waitcnt vmcnt(0)
    s_barrier
    buffer_load_dwordx4 v[112:115], v0, s[4:7], s44 offen offset:0
    buffer_load_dwordx4 v[116:119], v0, s[4:7], s45 offen offset:0
    buffer_load_dwordx4 v[120:123], v0, s[4:7], s44 offen offset:1024
    buffer_load_dwordx4 v[124:127], v0, s[4:7], s45 offen offset:1024
    buffer_load_dwordx4 v[160:163], v0, s[4:7], s44 offen offset:2048
    buffer_load_dwordx4 v[164:167], v0, s[4:7], s45 offen offset:2048
    buffer_load_dwordx4 v[168:171], v0, s[4:7], s44 offen offset:3072
    buffer_load_dwordx4 v[172:175], v0, s[4:7], s45 offen offset:3072
    s_add_u32 s44, s44, 4096
    s_add_u32 s45, s45, 4096
    buffer_load_dwordx4 v[176:179], v0, s[4:7], s44 offen offset:0
    buffer_load_dwordx4 v[180:183], v0, s[4:7], s45 offen offset:0
    buffer_load_dwordx4 v[184:187], v0, s[4:7], s44 offen offset:1024
    buffer_load_dwordx4 v[188:191], v0, s[4:7], s45 offen offset:1024
    buffer_load_dwordx4 v[192:195], v0, s[4:7], s44 offen offset:2048
    buffer_load_dwordx4 v[196:199], v0, s[4:7], s45 offen offset:2048
    buffer_load_dwordx4 v[200:203], v0, s[4:7], s44 offen offset:3072
    buffer_load_dwordx4 v[204:207], v0, s[4:7], s45 offen offset:3072
    s_add_u32 s44, s44, 4096
    s_add_u32 s45, s45, 4096
    buffer_load_dwordx4 v[208:211], v0, s[4:7], s44 offen offset:0
    buffer_load_dwordx4 v[212:215], v0, s[4:7], s45 offen offset:0
    buffer_load_dwordx4 v[216:219], v0, s[4:7], s44 offen offset:1024
    buffer_load_dwordx4 v[220:223], v0, s[4:7], s45 offen offset:1024
L_f1j_45:
    s_lshl_b32 s26, s22, 8
    s_lshl_b32 s27, s21, 5
    s_add_u32 s26, s26, s27
    s_lshl_b32 s27, s20, 2
    s_add_u32 s26, s26, s27
    s_add_u32 s26, s26, 0x1a82000
    v_mov_b32 v2, 1
    s_mov_b64 exec, 1
    s_waitcnt vmcnt(0)
    s_cmp_lg_u32 s37, 0
    s_cbranch_scc1 L_hs_53
    buffer_store_dword v2, off, s[4:7], s26 sc1
    s_branch L_hsd_54
L_hs_53:
    buffer_store_dword v2, off, s[4:7], s26
L_hsd_54:
    s_mov_b64 exec, -1
    s_barrier
    s_lshl_b32 s26, s22, 8
    s_lshl_b32 s27, s20, 5
    s_add_u32 s26, s26, s27
    s_add_u32 s26, s26, 0x1a82000
    v_lshrrev_b32 v3, 2, v0
    v_and_b32 v3, 28, v3
    s_mov_b32 s36, 200000
L_poll_55:
    buffer_load_dword v2, v3, s[4:7], s26 offen sc1
    s_waitcnt vmcnt(0)
    v_cmp_eq_u32 vcc, 1, v2
    s_cmp_eq_u64 vcc, exec
    s_cbranch_scc1 L_polld_56
    s_sub_u32 s36, s36, 1
    s_cmp_lg_u32 s36, 0
    s_cbranch_scc1 L_poll_55
L_polld_56:
    s_mul_i32 s26, s22, 172
    s_lshl_b32 s27, s33, 1
    s_add_u32 s26, s26, s27
    s_lshl_b32 s26, s26, 10
    s_add_u32 s26, s26, 0x1000000
    s_add_u32 s27, s26, 88064
    buffer_load_dwordx4 v[128:131], v0, s[4:7], s26 offen offset:0 sc1
    buffer_load_dwordx4 v[132:135], v0, s[4:7], s27 offen offset:0 sc1
    buffer_load_dwordx4 v[136:139], v0, s[4:7], s26 offen offset:1024 sc1
    buffer_load_dwordx4 v[140:143], v0, s[4:7], s27 offen offset:1024 sc1
    buffer_load_dwordx4 v[144:147], v0, s[4:7], s26 offen offset:2048 sc1
    buffer_load_dwordx4 v[148:151], v0, s[4:7], s27 offen offset:2048 sc1
    buffer_load_dwordx4 v[152:155], v0, s[4:7], s26 offen offset:3072 sc1
    buffer_load_dwordx4 v[156:159], v0, s[4:7], s27 offen offset:3072 sc1
    s_add_u32 s26, s26, 4096
    s_add_u32 s27, s27, 4096
    buffer_load_dwordx4 v[240:243], v0, s[4:7], s26 offen offset:0 sc1
    buffer_load_dwordx4 v[244:247], v0, s[4:7], s27 offen offset:0 sc1
    buffer_load_dwordx4 v[248:251], v0, s[4:7], s26 offen offset:1024 sc1
    buffer_load_dwordx4 v[252:255], v0, s[4:7], s27 offen offset:1024 sc1
    buffer_load_dwordx4 v[80:83], v0, s[4:7], s26 offen offset:2048 sc1
    buffer_load_dwordx4 v[84:87], v0, s[4:7], s27 offen offset:2048 sc1
    buffer_load_dwordx4 v[88:91], v0, s[4:7], s26 offen offset:3072 sc1
    buffer_load_dwordx4 v[92:95], v0, s[4:7], s27 offen offset:3072 sc1
    s_add_u32 s26, s26, 4096
    s_add_u32 s27, s27, 4096
    buffer_load_dwordx4 v[96:99], v0, s[4:7], s26 offen offset:0 sc1
    buffer_load_dwordx4 v[100:103], v0, s[4:7], s27 offen offset:0 sc1
    buffer_load_dwordx4 v[104:107], v0, s[4:7], s26 offen offset:1024 sc1
    buffer_load_dwordx4 v[108:111], v0, s[4:7], s27 offen offset:1024 sc1
    s_cmp_ge_u32 s20, 3
    s_cbranch_scc1 L_f2s_57
    s_waitcnt vmcnt(18)
    v_mfma_f32_32x32x16_bf16 v[16:31], v[112:115], v[128:131], 0
    v_mfma_f32_32x32x16_bf16 v[48:63], v[116:119], v[128:131], 0
    v_mfma_f32_32x32x16_bf16 v[32:47], v[112:115], v[132:135], 0
    v_mfma_f32_32x32x16_bf16 v[64:79], v[116:119], v[132:135], 0
    buffer_load_dwordx4 v[128:131], v0, s[4:7], s26 offen offset:2048 sc1
    buffer_load_dwordx4 v[132:135], v0, s[4:7], s27 offen offset:2048 sc1
    s_waitcnt vmcnt(18)
    v_mfma_f32_32x32x16_bf16 v[16:31], v[120:123], v[136:139], v[16:31]
    v_mfma_f32_32x32x16_bf16 v[48:63], v[124:127], v[136:139], v[48:63]
    v_mfma_f32_32x32x16_bf16 v[32:47], v[120:123], v[140:143], v[32:47]
    v_mfma_f32_32x32x16_bf16 v[64:79], v[124:127], v[140:143], v[64:79]
    buffer_load_dwordx4 v[136:139], v0, s[4:7], s26 offen offset:3072 sc1
    buffer_load_dwordx4 v[140:143], v0, s[4:7], s27 offen offset:3072 sc1
    s_waitcnt vmcnt(18)
    v_mfma_f32_32x32x16_bf16 v[16:31], v[160:163], v[144:147], v[16:31]
    v_mfma_f32_32x32x16_bf16 v[48:63], v[164:167], v[144:147], v[48:63]
    v_mfma_f32_32x32x16_bf16 v[32:47], v[160:163], v[148:151], v[32:47]
    v_mfma_f32_32x32x16_bf16 v[64:79], v[164:167], v[148:151], v[64:79]
    s_lshr_b32 s28, s34, 5
    s_and_b32 s28, s28, 0x3ff
    v_lshrrev_b32 v3, 1, v1
    buffer_load_dwordx2 v[8:9], v3, s[16:19], s28 offen
    buffer_load_dwordx2 v[10:11], v3, s[16:19], s28 offen offset:16
    s_waitcnt vmcnt(18)
    v_mfma_f32_32x32x16_bf16 v[16:31], v[168:171], v[152:155], v[16:31]
    v_mfma_f32_32x32x16_bf16 v[48:63], v[172:175], v[152:155], v[48:63]
    v_mfma_f32_32x32x16_bf16 v[32:47], v[168:171], v[156:159], v[32:47]
    v_mfma_f32_32x32x16_bf16 v[64:79], v[172:175], v[156:159], v[64:79]
    s_waitcnt vmcnt(16)
    v_mfma_f32_32x32x16_bf16 v[16:31], v[176:179], v[240:243], v[16:31]
    v_mfma_f32_32x32x16_bf16 v[48:63], v[180:183], v[240:243], v[48:63]
    v_mfma_f32_32x32x16_bf16 v[32:47], v[176:179], v[244:247], v[32:47]
    v_mfma_f32_32x32x16_bf16 v[64:79], v[180:183], v[244:247], v[64:79]
    s_waitcnt vmcnt(14)
    v_mfma_f32_32x32x16_bf16 v[16:31], v[184:187], v[248:251], v[16:31]
    v_mfma_f32_32x32x16_bf16 v[48:63], v[188:191], v[248:251], v[48:63]
    v_mfma_f32_32x32x16_bf16 v[32:47], v[184:187], v[252:255], v[32:47]
    v_mfma_f32_32x32x16_bf16 v[64:79], v[188:191], v[252:255], v[64:79]
    s_waitcnt vmcnt(12)
    v_mfma_f32_32x32x16_bf16 v[16:31], v[192:195], v[80:83], v[16:31]
    v_mfma_f32_32x32x16_bf16 v[48:63], v[196:199], v[80:83], v[48:63]
    v_mfma_f32_32x32x16_bf16 v[32:47], v[192:195], v[84:87], v[32:47]
    v_mfma_f32_32x32x16_bf16 v[64:79], v[196:199], v[84:87], v[64:79]
    s_waitcnt vmcnt(10)
    v_mfma_f32_32x32x16_bf16 v[16:31], v[200:203], v[88:91], v[16:31]
    v_mfma_f32_32x32x16_bf16 v[48:63], v[204:207], v[88:91], v[48:63]
    v_mfma_f32_32x32x16_bf16 v[32:47], v[200:203], v[92:95], v[32:47]
    v_mfma_f32_32x32x16_bf16 v[64:79], v[204:207], v[92:95], v[64:79]
    s_waitcnt vmcnt(8)
    v_mfma_f32_32x32x16_bf16 v[16:31], v[208:211], v[96:99], v[16:31]
    v_mfma_f32_32x32x16_bf16 v[48:63], v[212:215], v[96:99], v[48:63]
    v_mfma_f32_32x32x16_bf16 v[32:47], v[208:211], v[100:103], v[32:47]
    v_mfma_f32_32x32x16_bf16 v[64:79], v[212:215], v[100:103], v[64:79]
    s_waitcnt vmcnt(6)
    v_mfma_f32_32x32x16_bf16 v[16:31], v[216:219], v[104:107], v[16:31]
    v_mfma_f32_32x32x16_bf16 v[48:63], v[220:223], v[104:107], v[48:63]
    v_mfma_f32_32x32x16_bf16 v[32:47], v[216:219], v[108:111], v[32:47]
    v_mfma_f32_32x32x16_bf16 v[64:79], v[220:223], v[108:111], v[64:79]
    s_waitcnt vmcnt(4)
    v_mfma_f32_32x32x16_bf16 v[16:31], v[224:227], v[128:131], v[16:31]
    v_mfma_f32_32x32x16_bf16 v[48:63], v[228:231], v[128:131], v[48:63]
    v_mfma_f32_32x32x16_bf16 v[32:47], v[224:227], v[132:135], v[32:47]
    v_mfma_f32_32x32x16_bf16 v[64:79], v[228:231], v[132:135], v[64:79]
    s_waitcnt vmcnt(2)
    v_mfma_f32_32x32x16_bf16 v[16:31], v[232:235], v[136:139], v[16:31]
    v_mfma_f32_32x32x16_bf16 v[48:63], v[236:239], v[136:139], v[48:63]
    v_mfma_f32_32x32x16_bf16 v[32:47], v[232:235], v[140:143], v[32:47]
    v_mfma_f32_32x32x16_bf16 v[64:79], v[236:239], v[140:143], v[64:79]
    s_branch L_f2f_58
L_f2s_57:
    s_lshr_b32 s28, s34, 5
    s_and_b32 s28, s28, 0x3ff
    v_lshrrev_b32 v3, 1, v1
    buffer_load_dwordx2 v[8:9], v3, s[16:19], s28 offen
    buffer_load_dwordx2 v[10:11], v3, s[16:19], s28 offen offset:16
    s_waitcnt vmcnt(20)
    v_mfma_f32_32x32x16_bf16 v[16:31], v[112:115], v[128:131], 0
    v_mfma_f32_32x32x16_bf16 v[48:63], v[116:119], v[128:131], 0
    v_mfma_f32_32x32x16_bf16 v[32:47], v[112:115], v[132:135], 0
    v_mfma_f32_32x32x16_bf16 v[64:79], v[116:119], v[132:135], 0
    s_waitcnt vmcnt(18)
    v_mfma_f32_32x32x16_bf16 v[16:31], v[120:123], v[136:139], v[16:31]
    v_mfma_f32_32x32x16_bf16 v[48:63], v[124:127], v[136:139], v[48:63]
    v_mfma_f32_32x32x16_bf16 v[32:47], v[120:123], v[140:143], v[32:47]
    v_mfma_f32_32x32x16_bf16 v[64:79], v[124:127], v[140:143], v[64:79]
    s_waitcnt vmcnt(16)
    v_mfma_f32_32x32x16_bf16 v[16:31], v[160:163], v[144:147], v[16:31]
    v_mfma_f32_32x32x16_bf16 v[48:63], v[164:167], v[144:147], v[48:63]
    v_mfma_f32_32x32x16_bf16 v[32:47], v[160:163], v[148:151], v[32:47]
    v_mfma_f32_32x32x16_bf16 v[64:79], v[164:167], v[148:151], v[64:79]
    s_waitcnt vmcnt(14)
    v_mfma_f32_32x32x16_bf16 v[16:31], v[168:171], v[152:155], v[16:31]
    v_mfma_f32_32x32x16_bf16 v[48:63], v[172:175], v[152:155], v[48:63]
    v_mfma_f32_32x32x16_bf16 v[32:47], v[168:171], v[156:159], v[32:47]
    v_mfma_f32_32x32x16_bf16 v[64:79], v[172:175], v[156:159], v[64:79]
    s_waitcnt vmcnt(12)
    v_mfma_f32_32x32x16_bf16 v[16:31], v[176:179], v[240:243], v[16:31]
    v_mfma_f32_32x32x16_bf16 v[48:63], v[180:183], v[240:243], v[48:63]
    v_mfma_f32_32x32x16_bf16 v[32:47], v[176:179], v[244:247], v[32:47]
    v_mfma_f32_32x32x16_bf16 v[64:79], v[180:183], v[244:247], v[64:79]
    s_waitcnt vmcnt(10)
    v_mfma_f32_32x32x16_bf16 v[16:31], v[184:187], v[248:251], v[16:31]
    v_mfma_f32_32x32x16_bf16 v[48:63], v[188:191], v[248:251], v[48:63]
    v_mfma_f32_32x32x16_bf16 v[32:47], v[184:187], v[252:255], v[32:47]
    v_mfma_f32_32x32x16_bf16 v[64:79], v[188:191], v[252:255], v[64:79]
    s_waitcnt vmcnt(8)
    v_mfma_f32_32x32x16_bf16 v[16:31], v[192:195], v[80:83], v[16:31]
    v_mfma_f32_32x32x16_bf16 v[48:63], v[196:199], v[80:83], v[48:63]
    v_mfma_f32_32x32x16_bf16 v[32:47], v[192:195], v[84:87], v[32:47]
    v_mfma_f32_32x32x16_bf16 v[64:79], v[196:199], v[84:87], v[64:79]
    s_waitcnt vmcnt(6)
    v_mfma_f32_32x32x16_bf16 v[16:31], v[200:203], v[88:91], v[16:31]
    v_mfma_f32_32x32x16_bf16 v[48:63], v[204:207], v[88:91], v[48:63]
    v_mfma_f32_32x32x16_bf16 v[32:47], v[200:203], v[92:95], v[32:47]
    v_mfma_f32_32x32x16_bf16 v[64:79], v[204:207], v[92:95], v[64:79]
    s_waitcnt vmcnt(4)
    v_mfma_f32_32x32x16_bf16 v[16:31], v[208:211], v[96:99], v[16:31]
    v_mfma_f32_32x32x16_bf16 v[48:63], v[212:215], v[96:99], v[48:63]
    v_mfma_f32_32x32x16_bf16 v[32:47], v[208:211], v[100:103], v[32:47]
    v_mfma_f32_32x32x16_bf16 v[64:79], v[212:215], v[100:103], v[64:79]
    s_waitcnt vmcnt(2)
    v_mfma_f32_32x32x16_bf16 v[16:31], v[216:219], v[104:107], v[16:31]
    v_mfma_f32_32x32x16_bf16 v[48:63], v[220:223], v[104:107], v[48:63]
    v_mfma_f32_32x32x16_bf16 v[32:47], v[216:219], v[108:111], v[32:47]
    v_mfma_f32_32x32x16_bf16 v[64:79], v[220:223], v[108:111], v[64:79]
L_f2f_58:
    s_cmp_gt_u32 s21, 1
    s_cbranch_scc1 L_kvp_59
    s_lshl_b32 s44, s20, 12
    s_add_u32 s44, s44, 0x3c0000
    buffer_load_dwordx4 v[168:171], v0, s[4:7], s44 offen offset:0
    buffer_load_dwordx4 v[172:175], v0, s[4:7], s44 offen offset:1024
    buffer_load_dwordx4 v[176:179], v0, s[4:7], s44 offen offset:2048
    buffer_load_dwordx4 v[180:183], v0, s[4:7], s44 offen offset:3072
    s_lshl_b32 s44, s24, 6
    s_add_u32 s44, s44, 0x3d0800
    buffer_load_dwordx4 v[184:187], v1, s[4:7], s44 offen
    buffer_load_dwordx4 v[188:191], v1, s[4:7], s44 offen offset:32
L_kvp_59:
    s_lshl_b32 s26, s20, 11
    v_add_u32 v2, s26, v0
    v_add_u32 v3, 0x10000, v2
    s_nop 11
    ds_write_b128 v2, v[16:19] offset:0
    s_lshl_b32 s44, s21, 1
    s_add_u32 s44, s44, s24
    s_lshl_b32 s44, s44, 15
    s_lshr_b32 s45, s20, 1
    s_lshl_b32 s45, s45, 13
    s_add_u32 s44, s44, s45
    s_add_u32 s44, s44, 0x0
    buffer_load_dwordx4 v[96:99], v0, s[4:7], s44 offen offset:0
    ds_write_b128 v2, v[20:23] offset:1024
    buffer_load_dwordx4 v[100:103], v0, s[4:7], s44 offen offset:1024
    ds_write_b128 v2, v[48:51] offset:16384
    buffer_load_dwordx4 v[104:107], v0, s[4:7], s44 offen offset:2048
    ds_write_b128 v2, v[52:55] offset:17408
    ds_write_b128 v2, v[32:35] offset:32768
    buffer_load_dwordx4 v[108:111], v0, s[4:7], s44 offen offset:3072
    ds_write_b128 v2, v[36:39] offset:33792
    s_add_u32 s44, s44, 4096
    buffer_load_dwordx4 v[112:115], v0, s[4:7], s44 offen offset:0
    ds_write_b128 v2, v[64:67] offset:49152
    buffer_load_dwordx4 v[116:119], v0, s[4:7], s44 offen offset:1024
    ds_write_b128 v2, v[68:71] offset:50176
    ds_write_b128 v3, v[24:27] offset:0
    buffer_load_dwordx4 v[120:123], v0, s[4:7], s44 offen offset:2048
    ds_write_b128 v3, v[28:31] offset:1024
    buffer_load_dwordx4 v[124:127], v0, s[4:7], s44 offen offset:3072
    ds_write_b128 v3, v[56:59] offset:16384
    ds_write_b128 v3, v[60:63] offset:17408
    ds_write_b128 v3, v[40:43] offset:32768
    ds_write_b128 v3, v[44:47] offset:33792
    ds_write_b128 v3, v[72:75] offset:49152
    ds_write_b128 v3, v[76:79] offset:50176
    s_lshl_b32 s26, s20, 14
    v_add_u32 v2, s26, v0
    s_waitcnt lgkmcnt(0)
    s_barrier
    ds_read_b128 v[16:19], v2 offset:0
    ds_read_b128 v[20:23], v2 offset:1024
    ds_read_b128 v[24:27], v2 offset:2048
    ds_read_b128 v[28:31], v2 offset:3072
    ds_read_b128 v[32:35], v2 offset:4096
    ds_read_b128 v[36:39], v2 offset:5120
    ds_read_b128 v[40:43], v2 offset:6144
    ds_read_b128 v[44:47], v2 offset:7168
    s_waitcnt vmcnt(8) lgkmcnt(4)
    ds_read_b128 v[48:51], v2 offset:8192
    ds_read_b128 v[52:55], v2 offset:9216
    ds_read_b128 v[56:59], v2 offset:10240
    ds_read_b128 v[60:63], v2 offset:11264
    ds_read_b128 v[64:67], v2 offset:12288
    ds_read_b128 v[68:71], v2 offset:13312
    ds_read_b128 v[72:75], v2 offset:14336
    ds_read_b128 v[76:79], v2 offset:15360
    v_lshlrev_b32 v4, 16, v12
    v_and_b32 v5, 0xffff0000, v12
    v_add_f32 v16, v16, v4
    v_add_f32 v17, v17, v5
    v_lshlrev_b32 v4, 16, v13
    v_and_b32 v5, 0xffff0000, v13
    v_add_f32 v18, v18, v4
    v_add_f32 v19, v19, v5
    v_lshlrev_b32 v4, 16, v14
    v_and_b32 v5, 0xffff0000, v14
    v_add_f32 v20, v20, v4
    v_add_f32 v21, v21, v5
    v_lshlrev_b32 v4, 16, v15
    v_and_b32 v5, 0xffff0000, v15
    v_add_f32 v22, v22, v4
    v_add_f32 v23, v23, v5
    v_lshlrev_b32 v4, 16, v8
    v_and_b32 v5, 0xffff0000, v8
    v_add_f32 v24, v24, v4
    v_add_f32 v25, v25, v5
    v_lshlrev_b32 v4, 16, v9
    v_and_b32 v5, 0xffff0000, v9
    v_add_f32 v26, v26, v4
    v_add_f32 v27, v27, v5
    v_lshlrev_b32 v4, 16, v10
    v_and_b32 v5, 0xffff0000, v10
    v_add_f32 v28, v28, v4
    v_add_f32 v29, v29, v5
    v_lshlrev_b32 v4, 16, v11
    v_and_b32 v5, 0xffff0000, v11
    v_add_f32 v30, v30, v4
    v_add_f32 v31, v31, v5
    v_pk_add_f32 v[16:17], v[16:17], v[24:25]
    v_pk_add_f32 v[18:19], v[18:19], v[26:27]
    v_pk_add_f32 v[20:21], v[20:21], v[28:29]
    v_pk_add_f32 v[22:23], v[22:23], v[30:31]
    s_waitcnt lgkmcnt(10)
    v_pk_add_f32 v[16:17], v[16:17], v[32:33]
    v_pk_add_f32 v[18:19], v[18:19], v[34:35]
    v_pk_add_f32 v[20:21], v[20:21], v[36:37]
    v_pk_add_f32 v[22:23], v[22:23], v[38:39]
    s_waitcnt lgkmcnt(8)
    v_pk_add_f32 v[16:17], v[16:17], v[40:41]
    v_pk_add_f32 v[18:19], v[18:19], v[42:43]
    v_pk_add_f32 v[20:21], v[20:21], v[44:45]
    v_pk_add_f32 v[22:23], v[22:23], v[46:47]
    s_waitcnt lgkmcnt(6)
    v_pk_add_f32 v[16:17], v[16:17], v[48:49]
    v_pk_add_f32 v[18:19], v[18:19], v[50:51]
    v_pk_add_f32 v[20:21], v[20:21], v[52:53]
    v_pk_add_f32 v[22:23], v[22:23], v[54:55]
    s_waitcnt lgkmcnt(4)
    v_pk_add_f32 v[16:17], v[16:17], v[56:57]
    v_pk_add_f32 v[18:19], v[18:19], v[58:59]
    v_pk_add_f32 v[20:21], v[20:21], v[60:61]
    v_pk_add_f32 v[22:23], v[22:23], v[62:63]
    s_waitcnt lgkmcnt(2)
    v_pk_add_f32 v[16:17], v[16:17], v[64:65]
    v_pk_add_f32 v[18:19], v[18:19], v[66:67]
    v_pk_add_f32 v[20:21], v[20:21], v[68:69]
    v_pk_add_f32 v[22:23], v[22:23], v[70:71]
    s_waitcnt lgkmcnt(0)
    v_pk_add_f32 v[16:17], v[16:17], v[72:73]
    v_pk_add_f32 v[18:19], v[18:19], v[74:75]
    v_pk_add_f32 v[20:21], v[20:21], v[76:77]
    v_pk_add_f32 v[22:23], v[22:23], v[78:79]
    v_cvt_pk_bf16_f32 v12, v16, v17
    v_cvt_pk_bf16_f32 v13, v18, v19
    v_cvt_pk_bf16_f32 v14, v20, v21
    v_cvt_pk_bf16_f32 v15, v22, v23
    s_add_u32 s26, s34, 0x600000
    s_cmp_lg_u32 s37, 0
    s_cbranch_scc1 L_hs_60
    buffer_store_dwordx4 v[12:15], v0, s[4:7], s26 offen sc1
    s_branch L_hsd_61
L_hs_60:
    buffer_store_dwordx4 v[12:15], v0, s[4:7], s26 offen
L_hsd_61:
    v_pk_mul_f32 v[4:5], v[16:17], v[16:17]
    v_pk_add_f32 v[2:3], v[16:17], v[18:19]
    v_pk_fma_f32 v[4:5], v[18:19], v[18:19], v[4:5]
    v_pk_fma_f32 v[4:5], v[20:21], v[20:21], v[4:5]
    v_pk_fma_f32 v[4:5], v[22:23], v[22:23], v[4:5]
    v_pk_add_f32 v[2:3], v[2:3], v[20:21]
    v_pk_add_f32 v[2:3], v[2:3], v[22:23]
    v_add_f32 v2, v2, v3
    v_add_f32 v3, v4, v5
    v_mov_b32 v4, v2
    s_nop 1
    v_permlane32_swap_b32 v2, v4
    s_nop 1
    v_add_f32 v2, v2, v4
    v_mov_b32 v4, v3
    s_nop 1
    v_permlane32_swap_b32 v3, v4
    s_nop 1
    v_add_f32 v3, v3, v4
    v_or_b32 v3, 0x80000000, v3
    s_add_u32 s26, s31, 0x1980000
    v_lshlrev_b32 v4, 1, v0
    s_mov_b64 exec, 0xffffffff
    s_waitcnt vmcnt(0)
    s_cmp_lg_u32 s37, 0
    s_cbranch_scc1 L_hs_62
    buffer_store_dwordx2 v[2:3], v4, s[4:7], s26 offen sc1
    s_branch L_hsd_63
L_hs_62:
    buffer_store_dwordx2 v[2:3], v4, s[4:7], s26 offen
L_hsd_63:
    s_mov_b64 exec, -1
    s_barrier
    s_lshl_b32 s26, s22, 14
    s_lshl_b32 s27, s20, 11
    s_add_u32 s26, s26, s27
    s_add_u32 s26, s26, 0x1980000
    v_lshlrev_b32 v3, 1, v0
    s_mov_b32 s36, 200000
L_poll_64:
    buffer_load_dwordx4 v[16:19], v3, s[4:7], s26 offen offset:0 sc1
    buffer_load_dwordx4 v[20:23], v3, s[4:7], s26 offen offset:16 sc1
    s_waitcnt vmcnt(0)
    v_and_b32 v2, v17, v19
    v_and_b32 v4, v21, v23
    v_and_b32 v2, v2, v4
    v_cmp_gt_i32 vcc, 0, v2
    s_cmp_eq_u64 vcc, exec
    s_cbranch_scc1 L_polld_65
    s_sub_u32 s36, s36, 1
    s_cmp_lg_u32 s36, 0
    s_cbranch_scc1 L_poll_64
L_polld_65:
    s_lshl_b32 s26, s22, 16
    s_lshl_b32 s27, s20, 12
    s_add_u32 s26, s26, s27
    s_add_u32 s26, s26, 0x600000
    s_add_u32 s27, s27, 0x0
    s_mov_b32 m0, s27
    s_nop 0
    buffer_load_dwordx4 v0, s[4:7], s26 offen offset:0 sc1 lds
    buffer_load_dwordx4 v0, s[4:7], s26 offen offset:1024 sc1 lds
    buffer_load_dwordx4 v0, s[4:7], s26 offen offset:2048 sc1 lds
    buffer_load_dwordx4 v0, s[4:7], s26 offen offset:3072 sc1 lds
    s_lshl_b32 s26, s22, 16
    s_lshl_b32 s27, s20, 12
    s_add_u32 s26, s26, s27
    s_add_u32 s26, s26, 0x608000
    s_add_u32 s27, s27, 0x8000
    s_mov_b32 m0, s27
    s_nop 0
    buffer_load_dwordx4 v0, s[4:7], s26 offen offset:0 sc1 lds
    buffer_load_dwordx4 v0, s[4:7], s26 offen offset:1024 sc1 lds
    buffer_load_dwordx4 v0, s[4:7], s26 offen offset:2048 sc1 lds
    buffer_load_dwordx4 v0, s[4:7], s26 offen offset:3072 sc1 lds
    v_pk_add_f32 v[16:17], v[16:17], v[18:19]
    v_pk_add_f32 v[20:21], v[20:21], v[22:23]
    s_lshl_b32 s28, s20, 9
    s_add_u32 s28, s28, 0x24000
    v_lshrrev_b32 v3, 1, v0
    v_add_u32 v3, s28, v3
    v_pk_add_f32 v[16:17], v[16:17], v[20:21]
    ds_write_b64 v3, v[16:17]
    s_waitcnt vmcnt(0) lgkmcnt(0)
    s_barrier
    v_and_b32 v3, 0x1f0, v0
    v_lshrrev_b32 v3, 1, v3
    s_lshl_b32 s28, s23, 8
    s_add_u32 s28, s28, 0x24000
    v_add_u32 v3, s28, v3
    ds_read2st64_b64 v[80:83], v3 offset0:0 offset1:1
    ds_read2st64_b64 v[84:87], v3 offset0:2 offset1:3
    ds_read2st64_b64 v[88:91], v3 offset0:4 offset1:5
    ds_read2st64_b64 v[92:95], v3 offset0:6 offset1:7
    s_mov_b32 s47, 0
    s_mov_b32 s49, 0
    s_cmp_gt_u32 s21, 1
    s_cbranch_scc1 L_kvd_66
    s_lshl_b32 s26, s21, 15
    s_lshl_b32 s27, s20, 12
    s_add_u32 s26, s26, s27
    v_add_u32 v2, s26, v0
    ds_read_b128 v[32:35], v2 offset:0
    ds_read_b128 v[36:39], v2 offset:1024
    ds_read_b128 v[40:43], v2 offset:2048
    ds_read_b128 v[44:47], v2 offset:3072
    s_add_u32 s27, s27, 0x10000
    v_add_u32 v3, s27, v0
    s_waitcnt vmcnt(0)
    s_waitcnt lgkmcnt(3)
    v_mfma_f32_32x32x16_bf16 v[64:79], v[168:171], v[32:35], 0
    s_waitcnt lgkmcnt(2)
    v_mfma_f32_32x32x16_bf16 v[64:79], v[172:175], v[36:39], v[64:79]
    s_waitcnt lgkmcnt(1)
    v_mfma_f32_32x32x16_bf16 v[64:79], v[176:179], v[40:43], v[64:79]
    s_waitcnt lgkmcnt(0)
    v_mfma_f32_32x32x16_bf16 v[64:79], v[180:183], v[44:47], v[64:79]
    s_nop 15
    ds_write_b128 v3, v[64:67] offset:0
    ds_write_b128 v3, v[68:71] offset:1024
    ds_write_b128 v3, v[72:75] offset:2048
    ds_write_b128 v3, v[76:79] offset:3072
    s_waitcnt lgkmcnt(0)
    s_barrier
    s_cmp_lg_u32 s23, s21
    s_cbranch_scc1 L_kvd_66
    s_cmp_lg_u32 s25, 0
    s_cbranch_scc1 L_kvd_66
    s_lshl_b32 s26, s24, 11
    s_add_u32 s26, s26, 0x10000
    v_add_u32 v2, s26, v0
    ds_read_b128 v[16:19], v2 offset:0
    ds_read_b128 v[20:23], v2 offset:1024
    ds_read_b128 v[24:27], v2 offset:4096
    ds_read_b128 v[28:31], v2 offset:5120
    ds_read_b128 v[32:35], v2 offset:8192
    ds_read_b128 v[36:39], v2 offset:9216
    ds_read_b128 v[40:43], v2 offset:12288
    ds_read_b128 v[44:47], v2 offset:13312
    s_waitcnt lgkmcnt(4)
    ds_read_b128 v[48:51], v2 offset:16384
    ds_read_b128 v[52:55], v2 offset:17408
    ds_read_b128 v[56:59], v2 offset:20480
    ds_read_b128 v[60:63], v2 offset:21504
    ds_read_b128 v[64:67], v2 offset:24576
    ds_read_b128 v[68:71], v2 offset:25600
    ds_read_b128 v[72:75], v2 offset:28672
    ds_read_b128 v[76:79], v2 offset:29696
    v_mov_b32 v192, v80
    v_mov_b32 v193, v81
    v_mov_b32 v194, v82
    v_mov_b32 v195, v83
    v_mov_b32 v196, v84
    v_mov_b32 v197, v85
    v_mov_b32 v198, v86
    v_mov_b32 v199, v87
    v_pk_add_f32 v[192:193], v[192:193], v[88:89]
    v_pk_add_f32 v[194:195], v[194:195], v[90:91]
    v_pk_add_f32 v[196:197], v[196:197], v[92:93]
    v_pk_add_f32 v[198:199], v[198:199], v[94:95]
    v_pk_add_f32 v[192:193], v[192:193], v[196:197]
    v_pk_add_f32 v[194:195], v[194:195], v[198:199]
    v_pk_add_f32 v[8:9], v[192:193], v[194:195]
    v_mul_f32 v8, 0xbb000000, v8
    v_mul_f32 v9, 0xbb000000, v9
    v_fma_f32 v9, -v8, v8, v9
    v_max_f32 v9, 0, v9
    v_add_f32 v9, 0x3727c5ac, v9
    v_rsq_f32 v9, v9
    s_nop 0
    v_pk_add_f32 v[16:17], v[16:17], v[24:25]
    v_pk_add_f32 v[18:19], v[18:19], v[26:27]
    v_pk_add_f32 v[20:21], v[20:21], v[28:29]
    v_pk_add_f32 v[22:23], v[22:23], v[30:31]
    s_waitcnt lgkmcnt(10)
    v_pk_add_f32 v[16:17], v[16:17], v[32:33]
    v_pk_add_f32 v[18:19], v[18:19], v[34:35]
    v_pk_add_f32 v[20:21], v[20:21], v[36:37]
    v_pk_add_f32 v[22:23], v[22:23], v[38:39]
    s_waitcnt lgkmcnt(8)
    v_pk_add_f32 v[16:17], v[16:17], v[40:41]
    v_pk_add_f32 v[18:19], v[18:19], v[42:43]
    v_pk_add_f32 v[20:21], v[20:21], v[44:45]
    v_pk_add_f32 v[22:23], v[22:23], v[46:47]
    s_waitcnt lgkmcnt(6)
    v_pk_add_f32 v[16:17], v[16:17], v[48:49]
    v_pk_add_f32 v[18:19], v[18:19], v[50:51]
    v_pk_add_f32 v[20:21], v[20:21], v[52:53]
    v_pk_add_f32 v[22:23], v[22:23], v[54:55]
    s_waitcnt lgkmcnt(4)
    v_pk_add_f32 v[16:17], v[16:17], v[56:57]
    v_pk_add_f32 v[18:19], v[18:19], v[58:59]
    v_pk_add_f32 v[20:21], v[20:21], v[60:61]
    v_pk_add_f32 v[22:23], v[22:23], v[62:63]
    s_waitcnt lgkmcnt(2)
    v_pk_add_f32 v[16:17], v[16:17], v[64:65]
    v_pk_add_f32 v[18:19], v[18:19], v[66:67]
    v_pk_add_f32 v[20:21], v[20:21], v[68:69]
    v_pk_add_f32 v[22:23], v[22:23], v[70:71]
    s_waitcnt lgkmcnt(0)
    v_pk_add_f32 v[16:17], v[16:17], v[72:73]
    v_pk_add_f32 v[18:19], v[18:19], v[74:75]
    v_pk_add_f32 v[20:21], v[20:21], v[76:77]
    v_pk_add_f32 v[22:23], v[22:23], v[78:79]
    v_fma_f32 v16, v8, v184, v16
    v_fma_f32 v17, v8, v185, v17
    v_fma_f32 v18, v8, v186, v18
    v_fma_f32 v19, v8, v187, v19
    v_fma_f32 v20, v8, v188, v20
    v_fma_f32 v21, v8, v189, v21
    v_fma_f32 v22, v8, v190, v22
    v_fma_f32 v23, v8, v191, v23
    v_mul_f32 v16, v9, v16
    v_mul_f32 v17, v9, v17
    v_mul_f32 v18, v9, v18
    v_mul_f32 v19, v9, v19
    v_mul_f32 v20, v9, v20
    v_mul_f32 v21, v9, v21
    v_mul_f32 v22, v9, v22
    v_mul_f32 v23, v9, v23
    v_cvt_pk_bf16_f32 v24, v16, v17
    v_cvt_pk_bf16_f32 v25, v18, v19
    v_cvt_pk_bf16_f32 v26, v20, v21
    v_cvt_pk_bf16_f32 v27, v22, v23
    s_lshl_b32 s26, s22, 1
    s_add_u32 s26, s26, s23
    s_lshl_b32 s27, s26, 11
    s_add_u32 s29, s27, 0xe00000
    s_add_u32 s30, s27, 0xe00000
    s_add_u32 s27, s27, 0x15a0000
    s_lshl_b32 s48, s26, 2
    s_add_u32 s48, s48, 0x1a9a000
    s_cmp_lg_u32 s24, 0
    s_cbranch_scc1 L_kvv_67
    s_add_u32 s57, s29, 0x20000
    buffer_store_dwordx4 v[24:27], v0, s[4:7], s57 offen offset:0
    buffer_store_dwordx4 v[24:27], v0, s[4:7], s29 offen offset:0 sc1
    buffer_store_dwordx4 v[24:27], v0, s[4:7], s27 offen offset:0 sc1
    v_mov_b32 v4, 0
    v_dot2_f32_bf16 v4, v24, v24, v4
    v_dot2_f32_bf16 v4, v25, v25, v4
    v_dot2_f32_bf16 v4, v26, v26, v4
    v_dot2_f32_bf16 v4, v27, v27, v4
    s_nop 2
    v_mov_b32 v6, v4
    s_nop 1
    v_permlane32_swap_b32 v4, v6
    s_nop 1
    v_add_f32 v4, v4, v6
    v_cmp_ge_f32 vcc, 0x43800000, v4
    s_cmp_eq_u64 vcc, exec
    s_cselect_b32 s47, 1, 2
    s_branch L_kvd_66
L_kvv_67:
    v_lshrrev_b32 v2, 4, v0
    v_bfe_u32 v3, v2, 2, 1
    v_lshlrev_b32 v3, 9, v3
    v_bfe_u32 v4, v2, 4, 1
    v_lshl_add_u32 v3, v4, 8, v3
    v_and_b32 v4, 3, v2
    v_lshl_add_u32 v3, v4, 1, v3
    v_bfe_u32 v4, v2, 3, 1
    v_lshl_add_u32 v3, v4, 3, v3
    v_lshl_add_u32 v3, v1, 2, v3
    v_add_u32 v3, 0x26000, v3
    ds_write_b16 v3, v24 offset:0
    ds_write_b16_d16_hi v3, v24 offset:16
    ds_write_b16 v3, v25 offset:32
    ds_write_b16_d16_hi v3, v25 offset:48
    ds_write_b16 v3, v26 offset:128
    ds_write_b16_d16_hi v3, v26 offset:144
    ds_write_b16 v3, v27 offset:160
    ds_write_b16_d16_hi v3, v27 offset:176
    v_add_u32 v2, 0x26000, v0
    s_waitcnt lgkmcnt(0)
    ds_read_b128 v[24:27], v2
    s_waitcnt lgkmcnt(0)
    s_add_u32 s57, s29, 0x20000
    buffer_store_dwordx4 v[24:27], v0, s[4:7], s57 offen offset:1024
    buffer_store_dwordx4 v[24:27], v0, s[4:7], s29 offen offset:1024 sc1
    buffer_store_dwordx4 v[24:27], v0, s[4:7], s27 offen offset:1024 sc1
L_kvd_66:
    s_lshr_b32 s27, s20, 1
    s_lshl_b32 s26, s27, 13
    s_add_u32 s26, s26, 0x0
    v_add_u32 v2, s26, v0
    ds_read_b128 v[48:51], v2 offset:0
    ds_read_b128 v[52:55], v2 offset:32768
    ds_read_b128 v[56:59], v2 offset:1024
    ds_read_b128 v[60:63], v2 offset:33792
    ds_read_b128 v[64:67], v2 offset:4096
    ds_read_b128 v[68:71], v2 offset:36864
    ds_read_b128 v[72:75], v2 offset:5120
    ds_read_b128 v[76:79], v2 offset:37888
    s_waitcnt lgkmcnt(8)
    v_pk_add_f32 v[80:81], v[80:81], v[88:89]
    v_pk_add_f32 v[82:83], v[82:83], v[90:91]
    v_pk_add_f32 v[84:85], v[84:85], v[92:93]
    v_pk_add_f32 v[86:87], v[86:87], v[94:95]
    v_pk_add_f32 v[80:81], v[80:81], v[84:85]
    v_pk_add_f32 v[82:83], v[82:83], v[86:87]
    v_pk_add_f32 v[4:5], v[80:81], v[82:83]
    v_mul_f32 v4, 0xbb000000, v4
    v_mul_f32 v5, 0xbb000000, v5
    v_fma_f32 v5, -v4, v4, v5
    v_max_f32 v5, 0, v5
    v_add_f32 v5, 0x3727c5ac, v5
    v_rsq_f32 v5, v5
    s_nop 0
    v_mul_f32 v5, 0x3eb8aa3b, v5
    s_waitcnt lgkmcnt(7)
    v_mfma_f32_32x32x16_bf16 v[16:31], v[96:99], v[48:51], 0
    ds_read_b128 v[48:51], v2 offset:2048
    s_waitcnt lgkmcnt(7)
    v_mfma_f32_32x32x16_bf16 v[32:47], v[96:99], v[52:55], 0
    ds_read_b128 v[52:55], v2 offset:34816
    s_waitcnt lgkmcnt(7)
    v_mfma_f32_32x32x16_bf16 v[16:31], v[100:103], v[56:59], v[16:31]
    ds_read_b128 v[56:59], v2 offset:3072
    s_waitcnt lgkmcnt(7)
    v_mfma_f32_32x32x16_bf16 v[32:47], v[100:103], v[60:63], v[32:47]
    ds_read_b128 v[60:63], v2 offset:35840
    s_waitcnt lgkmcnt(7)
    v_mfma_f32_32x32x16_bf16 v[16:31], v[112:115], v[64:67], v[16:31]
    ds_read_b128 v[64:67], v2 offset:6144
    s_waitcnt lgkmcnt(7)
    v_mfma_f32_32x32x16_bf16 v[32:47], v[112:115], v[68:71], v[32:47]
    ds_read_b128 v[68:71], v2 offset:38912
    s_waitcnt lgkmcnt(7)
    v_mfma_f32_32x32x16_bf16 v[16:31], v[116:119], v[72:75], v[16:31]
    ds_read_b128 v[72:75], v2 offset:7168
    s_waitcnt lgkmcnt(7)
    v_mfma_f32_32x32x16_bf16 v[32:47], v[116:119], v[76:79], v[32:47]
    ds_read_b128 v[76:79], v2 offset:39936
    s_waitcnt lgkmcnt(7)
    v_mfma_f32_32x32x16_bf16 v[16:31], v[104:107], v[48:51], v[16:31]
    s_waitcnt lgkmcnt(6)
    v_mfma_f32_32x32x16_bf16 v[32:47], v[104:107], v[52:55], v[32:47]
    s_waitcnt lgkmcnt(5)
    v_mfma_f32_32x32x16_bf16 v[16:31], v[108:111], v[56:59], v[16:31]
    s_waitcnt lgkmcnt(4)
    v_mfma_f32_32x32x16_bf16 v[32:47], v[108:111], v[60:63], v[32:47]
    s_waitcnt lgkmcnt(3)
    v_mfma_f32_32x32x16_bf16 v[16:31], v[120:123], v[64:67], v[16:31]
    s_waitcnt lgkmcnt(2)
    v_mfma_f32_32x32x16_bf16 v[32:47], v[120:123], v[68:71], v[32:47]
    s_waitcnt lgkmcnt(1)
    v_mfma_f32_32x32x16_bf16 v[16:31], v[124:127], v[72:75], v[16:31]
    s_waitcnt lgkmcnt(0)
    v_mfma_f32_32x32x16_bf16 v[32:47], v[124:127], v[76:79], v[32:47]
    s_mul_i32 s26, s24, 6144
    s_add_u32 s26, s26, 0x18000
    v_add_u32 v2, s26, v0
    s_mul_i32 s26, s20, 6144
    s_add_u32 s26, s26, 0x18000
    v_add_u32 v3, s26, v0
    s_lshr_b32 s27, s20, 1
    s_nop 7
L_kq_69:
    s_cmp_lg_u32 s27, 0
    s_cbranch_scc1 L_kq_70
    ds_write_b128 v2, v[24:27] offset:26624
    ds_write_b128 v2, v[28:31] offset:27648
    ds_write_b128 v2, v[32:35] offset:12288
    ds_write_b128 v2, v[36:39] offset:13312
    ds_write_b128 v2, v[40:43] offset:40960
    ds_write_b128 v2, v[44:47] offset:41984
    s_branch L_kq_73
L_kq_70:
    s_cmp_lg_u32 s27, 1
    s_cbranch_scc1 L_kq_71
    ds_write_b128 v2, v[24:27] offset:24576
    ds_write_b128 v2, v[28:31] offset:25600
    ds_write_b128 v2, v[16:19] offset:4096
    ds_write_b128 v2, v[20:23] offset:5120
    ds_write_b128 v2, v[40:43] offset:38912
    ds_write_b128 v2, v[44:47] offset:39936
    s_nop 1
    v_mov_b32 v16, v32
    v_mov_b32 v17, v33
    v_mov_b32 v18, v34
    v_mov_b32 v19, v35
    v_mov_b32 v20, v36
    v_mov_b32 v21, v37
    v_mov_b32 v22, v38
    v_mov_b32 v23, v39
    s_branch L_kq_73
L_kq_71:
    s_cmp_lg_u32 s27, 2
    s_cbranch_scc1 L_kq_72
    ds_write_b128 v2, v[16:19] offset:2048
    ds_write_b128 v2, v[20:23] offset:3072
    ds_write_b128 v2, v[40:43] offset:36864
    ds_write_b128 v2, v[44:47] offset:37888
    ds_write_b128 v2, v[32:35] offset:16384
    ds_write_b128 v2, v[36:39] offset:17408
    s_nop 1
    v_mov_b32 v16, v24
    v_mov_b32 v17, v25
    v_mov_b32 v18, v26
    v_mov_b32 v19, v27
    v_mov_b32 v20, v28
    v_mov_b32 v21, v29
    v_mov_b32 v22, v30
    v_mov_b32 v23, v31
    s_branch L_kq_73
L_kq_72:
    ds_write_b128 v2, v[16:19] offset:0
    ds_write_b128 v2, v[20:23] offset:1024
    ds_write_b128 v2, v[24:27] offset:28672
    ds_write_b128 v2, v[28:31] offset:29696
    ds_write_b128 v2, v[32:35] offset:14336
    ds_write_b128 v2, v[36:39] offset:15360
    s_nop 1
    v_mov_b32 v16, v40
    v_mov_b32 v17, v41
    v_mov_b32 v18, v42
    v_mov_b32 v19, v43
    v_mov_b32 v20, v44
    v_mov_b32 v21, v45
    v_mov_b32 v22, v46
    v_mov_b32 v23, v47
L_kq_73:
    s_lshl_b32 s26, s20, 9
    s_add_u32 s26, s26, 0x27100
    v_add_u32 v6, s26, v1
    ds_read_b128 v[160:163], v6 offset:0
    ds_read_b128 v[164:167], v6 offset:32
    s_waitcnt lgkmcnt(0)
    s_barrier
    ds_read_b128 v[24:27], v3 offset:0
    ds_read_b128 v[28:31], v3 offset:1024
    ds_read_b128 v[32:35], v3 offset:2048
    ds_read_b128 v[36:39], v3 offset:3072
    ds_read_b128 v[40:43], v3 offset:4096
    ds_read_b128 v[44:47], v3 offset:5120
    s_waitcnt lgkmcnt(4)
    v_pk_add_f32 v[16:17], v[16:17], v[24:25]
    v_pk_add_f32 v[18:19], v[18:19], v[26:27]
    v_pk_add_f32 v[20:21], v[20:21], v[28:29]
    v_pk_add_f32 v[22:23], v[22:23], v[30:31]
    s_waitcnt lgkmcnt(2)
    v_pk_add_f32 v[16:17], v[16:17], v[32:33]
    v_pk_add_f32 v[18:19], v[18:19], v[34:35]
    v_pk_add_f32 v[20:21], v[20:21], v[36:37]
    v_pk_add_f32 v[22:23], v[22:23], v[38:39]
    s_waitcnt lgkmcnt(0)
    v_pk_add_f32 v[16:17], v[16:17], v[40:41]
    v_pk_add_f32 v[18:19], v[18:19], v[42:43]
    v_pk_add_f32 v[20:21], v[20:21], v[44:45]
    v_pk_add_f32 v[22:23], v[22:23], v[46:47]
    v_fma_f32 v16, v4, v160, v16
    v_fma_f32 v17, v4, v161, v17
    v_fma_f32 v18, v4, v162, v18
    v_fma_f32 v19, v4, v163, v19
    v_fma_f32 v20, v4, v164, v20
    v_fma_f32 v21, v4, v165, v21
    v_fma_f32 v22, v4, v166, v22
    v_fma_f32 v23, v4, v167, v23
    v_mul_f32 v16, v5, v16
    v_mul_f32 v17, v5, v17
    v_mul_f32 v18, v5, v18
    v_mul_f32 v19, v5, v19
    v_mul_f32 v20, v5, v20
    v_mul_f32 v21, v5, v21
    v_mul_f32 v22, v5, v22
    v_mul_f32 v23, v5, v23
    v_cvt_pk_bf16_f32 v8, v16, v17
    v_cvt_pk_bf16_f32 v9, v18, v19
    v_cvt_pk_bf16_f32 v10, v20, v21
    v_cvt_pk_bf16_f32 v11, v22, v23
    v_lshrrev_b32 v89, 2, v0
    v_and_b32 v88, 28, v89
    v_lshlrev_b32 v91, 1, v0
    s_lshl_b32 s51, s20, 11
    s_and_b32 s50, s22, 7
    s_lshl_b32 s50, s50, 12
    s_add_u32 s55, s54, 0xe00000
    s_add_u32 s56, s54, 0x15a0000
    s_add_u32 s26, s50, s55
    s_add_u32 s27, s26, 0x20000
    s_add_u32 s50, s50, 0x1000
    s_and_b32 s50, s50, 0x7fff
    s_add_u32 s55, s50, s55
    v_add_u32 v92, s51, v0
    s_add_u32 s51, s51, 0x4000
    s_mov_b32 s36, 400003
L_kp_74:
    s_and_b32 s28, s36, 3
    s_cselect_b32 s28, s27, s26
    buffer_load_dwordx4 v[40:43], v0, s[4:7], s28 offen offset:0 sc1
    buffer_load_dwordx4 v[44:47], v0, s[4:7], s28 offen offset:1024 sc1
    s_waitcnt vmcnt(0)
    v_max3_u32 v2, v40, v41, v42
    v_max3_u32 v2, v2, v43, v44
    v_max3_u32 v2, v2, v45, v46
    v_max_u32 v2, v2, v47
    v_cmp_ne_u32 vcc, -1, v2
    s_cmp_eq_u64 vcc, exec
    s_cbranch_scc1 L_kpd_75
    s_sleep 1
    s_sub_u32 s36, s36, 1
    s_cmp_lg_u32 s36, 0
    s_cbranch_scc1 L_kp_74
L_kpd_75:
    ds_write_b128 v92, v[40:43] offset:0
    ds_write_b128 v92, v[44:47] offset:1024
    s_lshr_b32 s53, s2, 4
    s_mul_i32 s53, s53, 4352
    s_add_u32 s53, s53, 0x1a9a000
    v_mov_b32 v4, 0
    v_dot2_f32_bf16 v4, v8, v8, v4
    v_dot2_f32_bf16 v4, v9, v9, v4
    v_dot2_f32_bf16 v4, v10, v10, v4
    v_dot2_f32_bf16 v4, v11, v11, v4
    v_mov_b32 v24, s35
    v_mov_b32 v25, s35
    v_mov_b32 v26, s35
    v_mov_b32 v27, s35
    v_mov_b32 v28, s35
    v_mov_b32 v29, s35
    v_mov_b32 v30, s35
    v_mov_b32 v31, s35
    v_mov_b32 v32, s35
    v_mov_b32 v33, s35
    v_mov_b32 v34, s35
    v_mov_b32 v35, s35
    v_mov_b32 v36, s35
    v_mov_b32 v37, s35
    v_mov_b32 v38, s35
    v_mov_b32 v39, s35
    v_mov_b32 v72, 0
    v_mov_b32 v73, 0
    v_mov_b32 v74, 0
    v_mov_b32 v75, 0
    v_mov_b32 v76, 0
    v_mov_b32 v77, 0
    v_mov_b32 v78, 0
    v_mov_b32 v79, 0
    v_mov_b32 v80, 0
    v_mov_b32 v81, 0
    v_mov_b32 v82, 0
    v_mov_b32 v83, 0
    v_mov_b32 v84, 0
    v_mov_b32 v85, 0
    v_mov_b32 v86, 0
    v_mov_b32 v87, 0
    v_mov_b32 v6, v4
    s_nop 1
    v_permlane32_swap_b32 v4, v6
    s_nop 1
    v_add_f32 v4, v4, v6
    v_cmp_ge_f32 vcc, 0x41800000, v4
    s_mov_b32 s38, 0x0000ffff
    s_mov_b32 s39, 0x0000ffff
    s_mov_b64 s[40:41], vcc
    v_mov_b32 v2, v0
    v_add_u32 v3, 0x10000, v2
    s_waitcnt lgkmcnt(0)
    s_barrier
    ds_read_b128 v[16:19], v2 offset:0
    ds_read_b128 v[20:23], v2 offset:2048
    s_mov_b64 exec, s[38:39]
    ds_read_b128 v[24:27], v2 offset:1024
    ds_read_b128 v[28:31], v2 offset:1280
    s_mov_b64 exec, -1
    s_cmp_eq_u32 s47, 0
    s_cbranch_scc1 L_kvf_78
    v_mov_b32 v93, s47
    v_mul_u32_u24 v94, 272, v0
    s_mov_b64 exec, 0xffff
    buffer_store_dword v93, v94, s[4:7], s48 offen sc1
    s_mov_b64 exec, -1
L_kvf_78:
    s_waitcnt lgkmcnt(3)
    v_mfma_f32_32x32x16_bf16 v[40:55], v[16:19], v[8:11], 0
    s_nop 13
    s_cmp_lt_u32 s20, 4
    s_cbranch_scc1 L_pr_79
    s_setprio 1
L_pr_79:
    v_exp_f32 v40, v40
    v_exp_f32 v41, v41
    v_exp_f32 v42, v42
    v_exp_f32 v43, v43
    v_exp_f32 v44, v44
    v_exp_f32 v45, v45
    s_waitcnt lgkmcnt(0)
    v_mfma_f32_32x32x16_bf16 v[56:71], v[20:23], v[8:11], 0
    ds_read_b128 v[16:19], v2 offset:4096
    s_mov_b64 exec, s[38:39]
    ds_read_b128 v[32:35], v2 offset:3072
    ds_read_b128 v[36:39], v2 offset:3328
    s_mov_b64 exec, -1
    v_exp_f32 v46, v46
    v_exp_f32 v47, v47
    v_exp_f32 v48, v48
    v_cvt_pk_bf16_f32 v40, v40, v41
    v_cvt_pk_bf16_f32 v41, v42, v43
    v_cvt_pk_bf16_f32 v42, v44, v45
    v_cvt_pk_bf16_f32 v43, v46, v47
    v_exp_f32 v49, v49
    v_exp_f32 v50, v50
    v_exp_f32 v51, v51
    v_mfma_f32_32x32x16_bf16 v[72:87], v[24:27], v[40:43], v[72:87]
    s_add_u32 s26, s34, 0x400000
    buffer_load_dword v90, v0, s[4:7], s26 offen
    v_exp_f32 v52, v52
    v_exp_f32 v53, v53
    v_exp_f32 v54, v54
    v_exp_f32 v55, v55
    v_cvt_pk_bf16_f32 v48, v48, v49
    v_cvt_pk_bf16_f32 v49, v50, v51
    v_cvt_pk_bf16_f32 v50, v52, v53
    v_cvt_pk_bf16_f32 v51, v54, v55
    v_exp_f32 v56, v56
    v_exp_f32 v57, v57
    v_mfma_f32_32x32x16_bf16 v[72:87], v[28:31], v[48:51], v[72:87]
    v_exp_f32 v58, v58
    v_exp_f32 v59, v59
    v_exp_f32 v60, v60
    v_exp_f32 v61, v61
    s_waitcnt lgkmcnt(0)
    v_mfma_f32_32x32x16_bf16 v[40:55], v[16:19], v[8:11], 0
    ds_read_b128 v[20:23], v2 offset:6144
    s_mov_b64 exec, s[38:39]
    ds_read_b128 v[24:27], v2 offset:5120
    ds_read_b128 v[28:31], v2 offset:5376
    s_mov_b64 exec, -1
    v_exp_f32 v62, v62
    v_exp_f32 v63, v63
    v_exp_f32 v64, v64
    v_cvt_pk_bf16_f32 v56, v56, v57
    v_cvt_pk_bf16_f32 v57, v58, v59
    v_cvt_pk_bf16_f32 v58, v60, v61
    v_cvt_pk_bf16_f32 v59, v62, v63
    v_exp_f32 v65, v65
    v_exp_f32 v66, v66
    v_exp_f32 v67, v67
    v_mfma_f32_32x32x16_bf16 v[72:87], v[32:35], v[56:59], v[72:87]
    s_lshl_b32 s26, s22, 8
    s_add_u32 s26, s26, 0x1a84000
    buffer_load_dword v90, v89, s[4:7], s26 offen
    v_exp_f32 v68, v68
    v_exp_f32 v69, v69
    v_exp_f32 v70, v70
    v_exp_f32 v71, v71
    v_cvt_pk_bf16_f32 v64, v64, v65
    v_cvt_pk_bf16_f32 v65, v66, v67
    v_cvt_pk_bf16_f32 v66, v68, v69
    v_cvt_pk_bf16_f32 v67, v70, v71
    v_exp_f32 v40, v40
    v_exp_f32 v41, v41
    v_mfma_f32_32x32x16_bf16 v[72:87], v[36:39], v[64:67], v[72:87]
    v_exp_f32 v42, v42
    v_exp_f32 v43, v43
    v_exp_f32 v44, v44
    v_exp_f32 v45, v45
    s_waitcnt lgkmcnt(0)
    v_mfma_f32_32x32x16_bf16 v[56:71], v[20:23], v[8:11], 0
    ds_read_b128 v[16:19], v2 offset:8192
    s_mov_b64 exec, s[38:39]
    ds_read_b128 v[32:35], v2 offset:7168
    ds_read_b128 v[36:39], v2 offset:7424
    s_mov_b64 exec, -1
    v_exp_f32 v46, v46
    v_exp_f32 v47, v47
    v_exp_f32 v48, v48
    v_cvt_pk_bf16_f32 v40, v40, v41
    v_cvt_pk_bf16_f32 v41, v42, v43
    v_cvt_pk_bf16_f32 v42, v44, v45
    v_cvt_pk_bf16_f32 v43, v46, v47
    v_exp_f32 v49, v49
    v_exp_f32 v50, v50
    v_exp_f32 v51, v51
    v_mfma_f32_32x32x16_bf16 v[72:87], v[24:27], v[40:43], v[72:87]
    s_lshl_b32 s26, s21, 1
    s_add_u32 s26, s26, s24
    s_lshl_b32 s26, s26, 15
    s_lshl_b32 s27, s25, 14
    s_add_u32 s26, s26, s27
    s_add_u32 s26, s26, 0x80000
    buffer_load_dwordx4 v[96:99], v0, s[4:7], s26 offen offset:0
    v_exp_f32 v52, v52
    v_exp_f32 v53, v53
    v_exp_f32 v54, v54
    v_exp_f32 v55, v55
    v_cvt_pk_bf16_f32 v48, v48, v49
    v_cvt_pk_bf16_f32 v49, v50, v51
    v_cvt_pk_bf16_f32 v50, v52, v53
    v_cvt_pk_bf16_f32 v51, v54, v55
    v_exp_f32 v56, v56
    v_exp_f32 v57, v57
    v_mfma_f32_32x32x16_bf16 v[72:87], v[28:31], v[48:51], v[72:87]
    v_exp_f32 v58, v58
    v_exp_f32 v59, v59
    v_exp_f32 v60, v60
    v_exp_f32 v61, v61
    s_waitcnt lgkmcnt(0)
    v_mfma_f32_32x32x16_bf16 v[40:55], v[16:19], v[8:11], 0
    ds_read_b128 v[20:23], v2 offset:10240
    s_mov_b64 exec, s[38:39]
    ds_read_b128 v[24:27], v2 offset:9216
    ds_read_b128 v[28:31], v2 offset:9472
    s_mov_b64 exec, -1
    v_exp_f32 v62, v62
    v_exp_f32 v63, v63
    v_exp_f32 v64, v64
    v_cvt_pk_bf16_f32 v56, v56, v57
    v_cvt_pk_bf16_f32 v57, v58, v59
    v_cvt_pk_bf16_f32 v58, v60, v61
    v_cvt_pk_bf16_f32 v59, v62, v63
    v_exp_f32 v65, v65
    v_exp_f32 v66, v66
    v_exp_f32 v67, v67
    v_mfma_f32_32x32x16_bf16 v[72:87], v[32:35], v[56:59], v[72:87]
    buffer_load_dwordx4 v[100:103], v0, s[4:7], s26 offen offset:1024
    v_exp_f32 v68, v68
    v_exp_f32 v69, v69
    v_exp_f32 v70, v70
    v_exp_f32 v71, v71
    v_cvt_pk_bf16_f32 v64, v64, v65
    v_cvt_pk_bf16_f32 v65, v66, v67
    v_cvt_pk_bf16_f32 v66, v68, v69
    v_cvt_pk_bf16_f32 v67, v70, v71
    s_setprio 0
    v_exp_f32 v40, v40
    v_exp_f32 v41, v41
    v_mfma_f32_32x32x16_bf16 v[72:87], v[36:39], v[64:67], v[72:87]
    v_exp_f32 v42, v42
    v_exp_f32 v43, v43
    v_exp_f32 v44, v44
    v_exp_f32 v45, v45
    s_waitcnt lgkmcnt(0)
    v_mfma_f32_32x32x16_bf16 v[56:71], v[20:23], v[8:11], 0
    ds_read_b128 v[16:19], v2 offset:12288
    s_mov_b64 exec, s[38:39]
    ds_read_b128 v[32:35], v2 offset:11264
    ds_read_b128 v[36:39], v2 offset:11520
    s_mov_b64 exec, -1
    v_exp_f32 v46, v46
    v_exp_f32 v47, v47
    v_exp_f32 v48, v48
    v_cvt_pk_bf16_f32 v40, v40, v41
    v_cvt_pk_bf16_f32 v41, v42, v43
    v_cvt_pk_bf16_f32 v42, v44, v45
    v_cvt_pk_bf16_f32 v43, v46, v47
    v_exp_f32 v49, v49
    v_exp_f32 v50, v50
    v_exp_f32 v51, v51
    v_mfma_f32_32x32x16_bf16 v[72:87], v[24:27], v[40:43], v[72:87]
    buffer_load_dwordx4 v[104:107], v0, s[4:7], s26 offen offset:2048
    buffer_load_dwordx4 v[152:155], v0, s[4:7], s55 offen offset:0 sc1
    buffer_load_dwordx4 v[156:159], v0, s[4:7], s55 offen offset:1024 sc1
    v_exp_f32 v52, v52
    v_exp_f32 v53, v53
    v_exp_f32 v54, v54
    v_exp_f32 v55, v55
    v_cvt_pk_bf16_f32 v48, v48, v49
    v_cvt_pk_bf16_f32 v49, v50, v51
    v_cvt_pk_bf16_f32 v50, v52, v53
    v_cvt_pk_bf16_f32 v51, v54, v55
    v_exp_f32 v56, v56
    v_exp_f32 v57, v57
    v_mfma_f32_32x32x16_bf16 v[72:87], v[28:31], v[48:51], v[72:87]
    v_exp_f32 v58, v58
    v_exp_f32 v59, v59
    v_exp_f32 v60, v60
    v_exp_f32 v61, v61
    s_waitcnt lgkmcnt(0)
    v_mfma_f32_32x32x16_bf16 v[40:55], v[16:19], v[8:11], 0
    ds_read_b128 v[20:23], v2 offset:14336
    s_mov_b64 exec, s[38:39]
    ds_read_b128 v[24:27], v2 offset:13312
    ds_read_b128 v[28:31], v2 offset:13568
    s_mov_b64 exec, -1
    v_exp_f32 v62, v62
    v_exp_f32 v63, v63
    v_exp_f32 v64, v64
    v_cvt_pk_bf16_f32 v56, v56, v57
    v_cvt_pk_bf16_f32 v57, v58, v59
    v_cvt_pk_bf16_f32 v58, v60, v61
    v_cvt_pk_bf16_f32 v59, v62, v63
    v_exp_f32 v65, v65
    v_exp_f32 v66, v66
    v_exp_f32 v67, v67
    v_mfma_f32_32x32x16_bf16 v[72:87], v[32:35], v[56:59], v[72:87]
    buffer_load_dwordx4 v[108:111], v0, s[4:7], s26 offen offset:3072
    s_waitcnt vmcnt(1)
    v_max3_u32 v93, v152, v153, v154
    v_max3_u32 v93, v93, v155, v156
    v_max3_u32 v93, v93, v157, v158
    v_max_u32 v93, v93, v159
    v_cmp_ne_u32 vcc, -1, v93
    s_cmp_eq_u64 vcc, exec
    s_cbranch_scc1 L_tok_80
    s_mov_b32 s36, 200000
L_poll_81:
    buffer_load_dwordx4 v[152:155], v0, s[4:7], s55 offen offset:0 sc1
    buffer_load_dwordx4 v[156:159], v0, s[4:7], s55 offen offset:1024 sc1
    s_waitcnt vmcnt(0)
    v_max3_u32 v93, v152, v153, v154
    v_max3_u32 v93, v93, v155, v156
    v_max3_u32 v93, v93, v157, v158
    v_max_u32 v93, v93, v159
    v_cmp_ne_u32 vcc, -1, v93
    s_cmp_eq_u64 vcc, exec
    s_cbranch_scc1 L_polld_82
    s_sleep 1
    s_sub_u32 s36, s36, 1
    s_cmp_lg_u32 s36, 0
    s_cbranch_scc1 L_poll_81
L_polld_82:
L_tok_80:
    ds_write_b128 v92, v[152:155] offset:16384
    ds_write_b128 v92, v[156:159] offset:17408
    v_exp_f32 v68, v68
    v_exp_f32 v69, v69
    v_exp_f32 v70, v70
    v_exp_f32 v71, v71
    v_cvt_pk_bf16_f32 v64, v64, v65
    v_cvt_pk_bf16_f32 v65, v66, v67
    v_cvt_pk_bf16_f32 v66, v68, v69
    v_cvt_pk_bf16_f32 v67, v70, v71
    v_exp_f32 v40, v40
    v_exp_f32 v41, v41
    v_mfma_f32_32x32x16_bf16 v[72:87], v[36:39], v[64:67], v[72:87]
    v_exp_f32 v42, v42
    v_exp_f32 v43, v43
    v_exp_f32 v44, v44
    v_exp_f32 v45, v45
    s_waitcnt lgkmcnt(0)
    s_barrier
    s_waitcnt lgkmcnt(0)
    v_mfma_f32_32x32x16_bf16 v[56:71], v[20:23], v[8:11], 0
    ds_read_b128 v[16:19], v2 offset:16384
    s_mov_b64 exec, s[38:39]
    ds_read_b128 v[32:35], v2 offset:15360
    ds_read_b128 v[36:39], v2 offset:15616
    s_mov_b64 exec, -1
    v_exp_f32 v46, v46
    v_exp_f32 v47, v47
    v_exp_f32 v48, v48
    v_cvt_pk_bf16_f32 v40, v40, v41
    v_cvt_pk_bf16_f32 v41, v42, v43
    v_cvt_pk_bf16_f32 v42, v44, v45
    v_cvt_pk_bf16_f32 v43, v46, v47
    v_exp_f32 v49, v49
    v_exp_f32 v50, v50
    v_exp_f32 v51, v51
    v_mfma_f32_32x32x16_bf16 v[72:87], v[24:27], v[40:43], v[72:87]
    s_add_u32 s26, s26, 4096
    buffer_load_dwordx4 v[112:115], v0, s[4:7], s26 offen offset:0
    v_exp_f32 v52, v52
    v_exp_f32 v53, v53
    v_exp_f32 v54, v54
    v_exp_f32 v55, v55
    v_cvt_pk_bf16_f32 v48, v48, v49
    v_cvt_pk_bf16_f32 v49, v50, v51
    v_cvt_pk_bf16_f32 v50, v52, v53
    v_cvt_pk_bf16_f32 v51, v54, v55
    s_cmp_lt_u32 s20, 4
    s_cbranch_scc1 L_pr_83
    s_setprio 1
L_pr_83:
    v_exp_f32 v56, v56
    v_exp_f32 v57, v57
    v_mfma_f32_32x32x16_bf16 v[72:87], v[28:31], v[48:51], v[72:87]
    v_exp_f32 v58, v58
    v_exp_f32 v59, v59
    v_exp_f32 v60, v60
    v_exp_f32 v61, v61
    s_waitcnt lgkmcnt(0)
    v_mfma_f32_32x32x16_bf16 v[40:55], v[16:19], v[8:11], 0
    ds_read_b128 v[20:23], v2 offset:18432
    s_mov_b64 exec, s[38:39]
    ds_read_b128 v[24:27], v2 offset:17408
    ds_read_b128 v[28:31], v2 offset:17664
    s_mov_b64 exec, -1
    v_exp_f32 v62, v62
    v_exp_f32 v63, v63
    v_exp_f32 v64, v64
    v_cvt_pk_bf16_f32 v56, v56, v57
    v_cvt_pk_bf16_f32 v57, v58, v59
    v_cvt_pk_bf16_f32 v58, v60, v61
    v_cvt_pk_bf16_f32 v59, v62, v63
    v_exp_f32 v65, v65
    v_exp_f32 v66, v66
    v_exp_f32 v67, v67
    v_mfma_f32_32x32x16_bf16 v[72:87], v[32:35], v[56:59], v[72:87]
    buffer_load_dword v5, v89, s[4:7], s53 offen sc1
    v_exp_f32 v68, v68
    v_exp_f32 v69, v69
    v_exp_f32 v70, v70
    v_exp_f32 v71, v71
    v_cvt_pk_bf16_f32 v64, v64, v65
    v_cvt_pk_bf16_f32 v65, v66, v67
    v_cvt_pk_bf16_f32 v66, v68, v69
    v_cvt_pk_bf16_f32 v67, v70, v71
    v_exp_f32 v40, v40
    v_exp_f32 v41, v41
    v_mfma_f32_32x32x16_bf16 v[72:87], v[36:39], v[64:67], v[72:87]
    v_exp_f32 v42, v42
    v_exp_f32 v43, v43
    v_exp_f32 v44, v44
    v_exp_f32 v45, v45
    s_waitcnt lgkmcnt(0)
    v_mfma_f32_32x32x16_bf16 v[56:71], v[20:23], v[8:11], 0
    ds_read_b128 v[16:19], v2 offset:20480
    s_mov_b64 exec, s[38:39]
    ds_read_b128 v[32:35], v2 offset:19456
    ds_read_b128 v[36:39], v2 offset:19712
    s_mov_b64 exec, -1
    v_exp_f32 v46, v46
    v_exp_f32 v47, v47
    v_exp_f32 v48, v48
    v_cvt_pk_bf16_f32 v40, v40, v41
    v_cvt_pk_bf16_f32 v41, v42, v43
    v_cvt_pk_bf16_f32 v42, v44, v45
    v_cvt_pk_bf16_f32 v43, v46, v47
    v_exp_f32 v49, v49
    v_exp_f32 v50, v50
    v_exp_f32 v51, v51
    v_mfma_f32_32x32x16_bf16 v[72:87], v[24:27], v[40:43], v[72:87]
    buffer_load_dwordx4 v[116:119], v0, s[4:7], s26 offen offset:1024
    v_exp_f32 v52, v52
    v_exp_f32 v53, v53
    v_exp_f32 v54, v54
    v_exp_f32 v55, v55
    v_cvt_pk_bf16_f32 v48, v48, v49
    v_cvt_pk_bf16_f32 v49, v50, v51
    v_cvt_pk_bf16_f32 v50, v52, v53
    v_cvt_pk_bf16_f32 v51, v54, v55
    v_exp_f32 v56, v56
    v_exp_f32 v57, v57
    v_mfma_f32_32x32x16_bf16 v[72:87], v[28:31], v[48:51], v[72:87]
    v_exp_f32 v58, v58
    v_exp_f32 v59, v59
    v_exp_f32 v60, v60
    v_exp_f32 v61, v61
    s_waitcnt lgkmcnt(0)
    v_mfma_f32_32x32x16_bf16 v[40:55], v[16:19], v[8:11], 0
    ds_read_b128 v[20:23], v2 offset:22528
    s_mov_b64 exec, s[38:39]
    ds_read_b128 v[24:27], v2 offset:21504
    ds_read_b128 v[28:31], v2 offset:21760
    s_mov_b64 exec, -1
    v_exp_f32 v62, v62
    v_exp_f32 v63, v63
    v_exp_f32 v64, v64
    v_cvt_pk_bf16_f32 v56, v56, v57
    v_cvt_pk_bf16_f32 v57, v58, v59
    v_cvt_pk_bf16_f32 v58, v60, v61
    v_cvt_pk_bf16_f32 v59, v62, v63
    v_exp_f32 v65, v65
    v_exp_f32 v66, v66
    v_exp_f32 v67, v67
    v_mfma_f32_32x32x16_bf16 v[72:87], v[32:35], v[56:59], v[72:87]
    buffer_load_dwordx4 v[120:123], v0, s[4:7], s26 offen offset:2048
    v_exp_f32 v68, v68
    v_exp_f32 v69, v69
    v_exp_f32 v70, v70
    v_exp_f32 v71, v71
    v_cvt_pk_bf16_f32 v64, v64, v65
    v_cvt_pk_bf16_f32 v65, v66, v67
    v_cvt_pk_bf16_f32 v66, v68, v69
    v_cvt_pk_bf16_f32 v67, v70, v71
    v_exp_f32 v40, v40
    v_exp_f32 v41, v41
    v_mfma_f32_32x32x16_bf16 v[72:87], v[36:39], v[64:67], v[72:87]
    v_exp_f32 v42, v42
    v_exp_f32 v43, v43
    v_exp_f32 v44, v44
    v_exp_f32 v45, v45
    s_waitcnt lgkmcnt(0)
    v_mfma_f32_32x32x16_bf16 v[56:71], v[20:23], v[8:11], 0
    ds_read_b128 v[16:19], v2 offset:24576
    s_mov_b64 exec, s[38:39]
    ds_read_b128 v[32:35], v2 offset:23552
    ds_read_b128 v[36:39], v2 offset:23808
    s_mov_b64 exec, -1
    v_exp_f32 v46, v46
    v_exp_f32 v47, v47
    v_exp_f32 v48, v48
    v_cvt_pk_bf16_f32 v40, v40, v41
    v_cvt_pk_bf16_f32 v41, v42, v43
    v_cvt_pk_bf16_f32 v42, v44, v45
    v_cvt_pk_bf16_f32 v43, v46, v47
    v_exp_f32 v49, v49
    v_exp_f32 v50, v50
    v_exp_f32 v51, v51
    v_mfma_f32_32x32x16_bf16 v[72:87], v[24:27], v[40:43], v[72:87]
    buffer_load_dwordx4 v[124:127], v0, s[4:7], s26 offen offset:3072
    v_exp_f32 v52, v52
    v_exp_f32 v53, v53
    v_exp_f32 v54, v54
    v_exp_f32 v55, v55
    v_cvt_pk_bf16_f32 v48, v48, v49
    v_cvt_pk_bf16_f32 v49, v50, v51
    v_cvt_pk_bf16_f32 v50, v52, v53
    v_cvt_pk_bf16_f32 v51, v54, v55
    v_exp_f32 v56, v56
    v_exp_f32 v57, v57
    v_mfma_f32_32x32x16_bf16 v[72:87], v[28:31], v[48:51], v[72:87]
    v_exp_f32 v58, v58
    v_exp_f32 v59, v59
    v_exp_f32 v60, v60
    v_exp_f32 v61, v61
    s_waitcnt lgkmcnt(0)
    v_mfma_f32_32x32x16_bf16 v[40:55], v[16:19], v[8:11], 0
    ds_read_b128 v[20:23], v2 offset:26624
    s_mov_b64 exec, s[38:39]
    ds_read_b128 v[24:27], v2 offset:25600
    ds_read_b128 v[28:31], v2 offset:25856
    s_mov_b64 exec, -1
    v_exp_f32 v62, v62
    v_exp_f32 v63, v63
    v_exp_f32 v64, v64
    v_cvt_pk_bf16_f32 v56, v56, v57
    v_cvt_pk_bf16_f32 v57, v58, v59
    v_cvt_pk_bf16_f32 v58, v60, v61
    v_cvt_pk_bf16_f32 v59, v62, v63
    v_exp_f32 v65, v65
    v_exp_f32 v66, v66
    v_exp_f32 v67, v67
    v_mfma_f32_32x32x16_bf16 v[72:87], v[32:35], v[56:59], v[72:87]
    s_waitcnt vmcnt(3)
    v_cmp_ne_u32 vcc, 0, v5
    s_cmp_eq_u64 vcc, exec
    s_cbranch_scc1 L_kok_84
    s_mov_b32 s36, 200000
L_poll_85:
    buffer_load_dword v5, v89, s[4:7], s53 offen sc1
    s_waitcnt vmcnt(0)
    v_cmp_ne_u32 vcc, 0, v5
    s_cmp_eq_u64 vcc, exec
    s_cbranch_scc1 L_polld_86
    s_sleep 2
    s_sub_u32 s36, s36, 1
    s_cmp_lg_u32 s36, 0
    s_cbranch_scc1 L_poll_85
L_polld_86:
L_kok_84:
    v_cmp_eq_u32 vcc, 1, v5
    s_and_b64 vcc, vcc, s[40:41]
    s_cmp_eq_u64 vcc, exec
    s_cbranch_scc0 L_slow_76
    s_add_u32 s50, s50, 0x1000
    s_and_b32 s50, s50, 0x7fff
    s_add_u32 s51, s51, 0x4000
    s_add_u32 s52, s50, s56
    s_mov_b32 m0, s51
    s_nop 0
    buffer_load_dwordx4 v0, s[4:7], s52 offen offset:0 lds
    buffer_load_dwordx4 v0, s[4:7], s52 offen offset:1024 lds
    v_exp_f32 v68, v68
    v_exp_f32 v69, v69
    v_exp_f32 v70, v70
    v_exp_f32 v71, v71
    v_cvt_pk_bf16_f32 v64, v64, v65
    v_cvt_pk_bf16_f32 v65, v66, v67
    v_cvt_pk_bf16_f32 v66, v68, v69
    v_cvt_pk_bf16_f32 v67, v70, v71
    s_setprio 0
    v_exp_f32 v40, v40
    v_exp_f32 v41, v41
    v_mfma_f32_32x32x16_bf16 v[72:87], v[36:39], v[64:67], v[72:87]
    v_exp_f32 v42, v42
    v_exp_f32 v43, v43
    v_exp_f32 v44, v44
    v_exp_f32 v45, v45
    s_waitcnt lgkmcnt(0)
    v_mfma_f32_32x32x16_bf16 v[56:71], v[20:23], v[8:11], 0
    ds_read_b128 v[16:19], v2 offset:28672
    s_mov_b64 exec, s[38:39]
    ds_read_b128 v[32:35], v2 offset:27648
    ds_read_b128 v[36:39], v2 offset:27904
    s_mov_b64 exec, -1
    v_exp_f32 v46, v46
    v_exp_f32 v47, v47
    v_exp_f32 v48, v48
    v_cvt_pk_bf16_f32 v40, v40, v41
    v_cvt_pk_bf16_f32 v41, v42, v43
    v_cvt_pk_bf16_f32 v42, v44, v45
    v_cvt_pk_bf16_f32 v43, v46, v47
    v_exp_f32 v49, v49
    v_exp_f32 v50, v50
    v_exp_f32 v51, v51
    v_mfma_f32_32x32x16_bf16 v[72:87], v[24:27], v[40:43], v[72:87]
    s_add_u32 s50, s50, 0x1000
    s_and_b32 s50, s50, 0x7fff
    s_add_u32 s51, s51, 0x4000
    s_add_u32 s52, s50, s56
    s_mov_b32 m0, s51
    s_nop 0
    buffer_load_dwordx4 v0, s[4:7], s52 offen offset:0 lds
    buffer_load_dwordx4 v0, s[4:7], s52 offen offset:1024 lds
    v_exp_f32 v52, v52
    v_exp_f32 v53, v53
    v_exp_f32 v54, v54
    v_exp_f32 v55, v55
    v_cvt_pk_bf16_f32 v48, v48, v49
    v_cvt_pk_bf16_f32 v49, v50, v51
    v_cvt_pk_bf16_f32 v50, v52, v53
    v_cvt_pk_bf16_f32 v51, v54, v55
    v_exp_f32 v56, v56
    v_exp_f32 v57, v57
    v_mfma_f32_32x32x16_bf16 v[72:87], v[28:31], v[48:51], v[72:87]
    v_exp_f32 v58, v58
    v_exp_f32 v59, v59
    v_exp_f32 v60, v60
    v_exp_f32 v61, v61
    s_waitcnt lgkmcnt(0)
    v_mfma_f32_32x32x16_bf16 v[40:55], v[16:19], v[8:11], 0
    ds_read_b128 v[20:23], v2 offset:30720
    s_mov_b64 exec, s[38:39]
    ds_read_b128 v[24:27], v2 offset:29696
    ds_read_b128 v[28:31], v2 offset:29952
    s_mov_b64 exec, -1
    v_exp_f32 v62, v62
    v_exp_f32 v63, v63
    v_exp_f32 v64, v64
    v_cvt_pk_bf16_f32 v56, v56, v57
    v_cvt_pk_bf16_f32 v57, v58, v59
    v_cvt_pk_bf16_f32 v58, v60, v61
    v_cvt_pk_bf16_f32 v59, v62, v63
    v_exp_f32 v65, v65
    v_exp_f32 v66, v66
    v_exp_f32 v67, v67
    v_mfma_f32_32x32x16_bf16 v[72:87], v[32:35], v[56:59], v[72:87]
    s_add_u32 s50, s50, 0x1000
    s_and_b32 s50, s50, 0x7fff
    s_add_u32 s51, s51, 0x4000
    s_add_u32 s52, s50, s56
    s_mov_b32 m0, s51
    s_nop 0
    buffer_load_dwordx4 v0, s[4:7], s52 offen offset:0 lds
    buffer_load_dwordx4 v0, s[4:7], s52 offen offset:1024 lds
    v_exp_f32 v68, v68
    v_exp_f32 v69, v69
    v_exp_f32 v70, v70
    v_exp_f32 v71, v71
    v_cvt_pk_bf16_f32 v64, v64, v65
    v_cvt_pk_bf16_f32 v65, v66, v67
    v_cvt_pk_bf16_f32 v66, v68, v69
    v_cvt_pk_bf16_f32 v67, v70, v71
    v_exp_f32 v40, v40
    v_exp_f32 v41, v41
    v_mfma_f32_32x32x16_bf16 v[72:87], v[36:39], v[64:67], v[72:87]
    v_exp_f32 v42, v42
    v_exp_f32 v43, v43
    v_exp_f32 v44, v44
    v_exp_f32 v45, v45
    s_waitcnt vmcnt(4)
    s_barrier
    s_waitcnt lgkmcnt(0)
    v_mfma_f32_32x32x16_bf16 v[56:71], v[20:23], v[8:11], 0
    ds_read_b128 v[16:19], v2 offset:32768
    s_mov_b64 exec, s[38:39]
    ds_read_b128 v[32:35], v2 offset:31744
    ds_read_b128 v[36:39], v2 offset:32000
    s_mov_b64 exec, -1
    v_exp_f32 v46, v46
    v_exp_f32 v47, v47
    v_exp_f32 v48, v48
    v_cvt_pk_bf16_f32 v40, v40, v41
    v_cvt_pk_bf16_f32 v41, v42, v43
    v_cvt_pk_bf16_f32 v42, v44, v45
    v_cvt_pk_bf16_f32 v43, v46, v47
    v_exp_f32 v49, v49
    v_exp_f32 v50, v50
    v_exp_f32 v51, v51
    v_mfma_f32_32x32x16_bf16 v[72:87], v[24:27], v[40:43], v[72:87]
    s_add_u32 s50, s50, 0x1000
    s_and_b32 s50, s50, 0x7fff
    s_add_u32 s51, s51, 0x4000
    s_add_u32 s52, s50, s56
    s_mov_b32 m0, s51
    s_nop 0
    buffer_load_dwordx4 v0, s[4:7], s52 offen offset:0 lds
    buffer_load_dwordx4 v0, s[4:7], s52 offen offset:1024 lds
    v_exp_f32 v52, v52
    v_exp_f32 v53, v53
    v_exp_f32 v54, v54
    v_exp_f32 v55, v55
    v_cvt_pk_bf16_f32 v48, v48, v49
    v_cvt_pk_bf16_f32 v49, v50, v51
    v_cvt_pk_bf16_f32 v50, v52, v53
    v_cvt_pk_bf16_f32 v51, v54, v55
    s_cmp_lt_u32 s20, 4
    s_cbranch_scc1 L_pr_87
    s_setprio 1
L_pr_87:
    v_exp_f32 v56, v56
    v_exp_f32 v57, v57
    v_mfma_f32_32x32x16_bf16 v[72:87], v[28:31], v[48:51], v[72:87]
    v_exp_f32 v58, v58
    v_exp_f32 v59, v59
    v_exp_f32 v60, v60
    v_exp_f32 v61, v61
    s_waitcnt lgkmcnt(0)
    v_mfma_f32_32x32x16_bf16 v[40:55], v[16:19], v[8:11], 0
    ds_read_b128 v[20:23], v2 offset:34816
    s_mov_b64 exec, s[38:39]
    ds_read_b128 v[24:27], v2 offset:33792
    ds_read_b128 v[28:31], v2 offset:34048
    s_mov_b64 exec, -1
    v_exp_f32 v62, v62
    v_exp_f32 v63, v63
    v_exp_f32 v64, v64
    v_cvt_pk_bf16_f32 v56, v56, v57
    v_cvt_pk_bf16_f32 v57, v58, v59
    v_cvt_pk_bf16_f32 v58, v60, v61
    v_cvt_pk_bf16_f32 v59, v62, v63
    v_exp_f32 v65, v65
    v_exp_f32 v66, v66
    v_exp_f32 v67, v67
    v_mfma_f32_32x32x16_bf16 v[72:87], v[32:35], v[56:59], v[72:87]
    s_add_u32 s50, s50, 0x1000
    s_and_b32 s50, s50, 0x7fff
    s_add_u32 s51, s51, 0x4000
    s_add_u32 s52, s50, s56
    s_mov_b32 m0, s51
    s_nop 0
    buffer_load_dwordx4 v0, s[4:7], s52 offen offset:0 lds
    buffer_load_dwordx4 v0, s[4:7], s52 offen offset:1024 lds
    v_exp_f32 v68, v68
    v_exp_f32 v69, v69
    v_exp_f32 v70, v70
    v_exp_f32 v71, v71
    v_cvt_pk_bf16_f32 v64, v64, v65
    v_cvt_pk_bf16_f32 v65, v66, v67
    v_cvt_pk_bf16_f32 v66, v68, v69
    v_cvt_pk_bf16_f32 v67, v70, v71
    v_exp_f32 v40, v40
    v_exp_f32 v41, v41
    v_mfma_f32_32x32x16_bf16 v[72:87], v[36:39], v[64:67], v[72:87]
    v_exp_f32 v42, v42
    v_exp_f32 v43, v43
    v_exp_f32 v44, v44
    v_exp_f32 v45, v45
    s_waitcnt lgkmcnt(0)
    v_mfma_f32_32x32x16_bf16 v[56:71], v[20:23], v[8:11], 0
    ds_read_b128 v[16:19], v2 offset:36864
    s_mov_b64 exec, s[38:39]
    ds_read_b128 v[32:35], v2 offset:35840
    ds_read_b128 v[36:39], v2 offset:36096
    s_mov_b64 exec, -1
    v_exp_f32 v46, v46
    v_exp_f32 v47, v47
    v_exp_f32 v48, v48
    v_cvt_pk_bf16_f32 v40, v40, v41
    v_cvt_pk_bf16_f32 v41, v42, v43
    v_cvt_pk_bf16_f32 v42, v44, v45
    v_cvt_pk_bf16_f32 v43, v46, v47
    v_exp_f32 v49, v49
    v_exp_f32 v50, v50
    v_exp_f32 v51, v51
    v_mfma_f32_32x32x16_bf16 v[72:87], v[24:27], v[40:43], v[72:87]
    s_add_u32 s50, s50, 0x1000
    s_and_b32 s50, s50, 0x7fff
    s_add_u32 s51, s51, 0x4000
    s_add_u32 s52, s50, s56
    s_mov_b32 m0, s51
    s_nop 0
    buffer_load_dwordx4 v0, s[4:7], s52 offen offset:0 lds
    buffer_load_dwordx4 v0, s[4:7], s52 offen offset:1024 lds
    v_exp_f32 v52, v52
    v_exp_f32 v53, v53
    v_exp_f32 v54, v54
    v_exp_f32 v55, v55
    v_cvt_pk_bf16_f32 v48, v48, v49
    v_cvt_pk_bf16_f32 v49, v50, v51
    v_cvt_pk_bf16_f32 v50, v52, v53
    v_cvt_pk_bf16_f32 v51, v54, v55
    v_exp_f32 v56, v56
    v_exp_f32 v57, v57
    v_mfma_f32_32x32x16_bf16 v[72:87], v[28:31], v[48:51], v[72:87]
    v_exp_f32 v58, v58
    v_exp_f32 v59, v59
    v_exp_f32 v60, v60
    v_exp_f32 v61, v61
    s_waitcnt lgkmcnt(0)
    v_mfma_f32_32x32x16_bf16 v[40:55], v[16:19], v[8:11], 0
    ds_read_b128 v[20:23], v2 offset:38912
    s_mov_b64 exec, s[38:39]
    ds_read_b128 v[24:27], v2 offset:37888
    ds_read_b128 v[28:31], v2 offset:38144
    s_mov_b64 exec, -1
    v_exp_f32 v62, v62
    v_exp_f32 v63, v63
    v_exp_f32 v64, v64
    v_cvt_pk_bf16_f32 v56, v56, v57
    v_cvt_pk_bf16_f32 v57, v58, v59
    v_cvt_pk_bf16_f32 v58, v60, v61
    v_cvt_pk_bf16_f32 v59, v62, v63
    v_exp_f32 v65, v65
    v_exp_f32 v66, v66
    v_exp_f32 v67, v67
    v_mfma_f32_32x32x16_bf16 v[72:87], v[32:35], v[56:59], v[72:87]
    s_add_u32 s26, s26, 4096
    buffer_load_dwordx4 v[128:131], v0, s[4:7], s26 offen offset:0
    buffer_load_dwordx4 v[132:135], v0, s[4:7], s26 offen offset:1024
    v_exp_f32 v68, v68
    v_exp_f32 v69, v69
    v_exp_f32 v70, v70
    v_exp_f32 v71, v71
    v_cvt_pk_bf16_f32 v64, v64, v65
    v_cvt_pk_bf16_f32 v65, v66, v67
    v_cvt_pk_bf16_f32 v66, v68, v69
    v_cvt_pk_bf16_f32 v67, v70, v71
    v_exp_f32 v40, v40
    v_exp_f32 v41, v41
    v_mfma_f32_32x32x16_bf16 v[72:87], v[36:39], v[64:67], v[72:87]
    v_exp_f32 v42, v42
    v_exp_f32 v43, v43
    v_exp_f32 v44, v44
    v_exp_f32 v45, v45
    s_waitcnt lgkmcnt(0)
    v_mfma_f32_32x32x16_bf16 v[56:71], v[20:23], v[8:11], 0
    ds_read_b128 v[16:19], v2 offset:40960
    s_mov_b64 exec, s[38:39]
    ds_read_b128 v[32:35], v2 offset:39936
    ds_read_b128 v[36:39], v2 offset:40192
    s_mov_b64 exec, -1
    v_exp_f32 v46, v46
    v_exp_f32 v47, v47
    v_exp_f32 v48, v48
    v_cvt_pk_bf16_f32 v40, v40, v41
    v_cvt_pk_bf16_f32 v41, v42, v43
    v_cvt_pk_bf16_f32 v42, v44, v45
    v_cvt_pk_bf16_f32 v43, v46, v47
    v_exp_f32 v49, v49
    v_exp_f32 v50, v50
    v_exp_f32 v51, v51
    v_mfma_f32_32x32x16_bf16 v[72:87], v[24:27], v[40:43], v[72:87]
    buffer_load_dwordx4 v[136:139], v0, s[4:7], s26 offen offset:2048
    buffer_load_dwordx4 v[140:143], v0, s[4:7], s26 offen offset:3072
    v_exp_f32 v52, v52
    v_exp_f32 v53, v53
    v_exp_f32 v54, v54
    v_exp_f32 v55, v55
    v_cvt_pk_bf16_f32 v48, v48, v49
    v_cvt_pk_bf16_f32 v49, v50, v51
    v_cvt_pk_bf16_f32 v50, v52, v53
    v_cvt_pk_bf16_f32 v51, v54, v55
    v_exp_f32 v56, v56
    v_exp_f32 v57, v57
    v_mfma_f32_32x32x16_bf16 v[72:87], v[28:31], v[48:51], v[72:87]
    v_exp_f32 v58, v58
    v_exp_f32 v59, v59
    v_exp_f32 v60, v60
    v_exp_f32 v61, v61
    s_waitcnt lgkmcnt(0)
    v_mfma_f32_32x32x16_bf16 v[40:55], v[16:19], v[8:11], 0
    ds_read_b128 v[20:23], v2 offset:43008
    s_mov_b64 exec, s[38:39]
    ds_read_b128 v[24:27], v2 offset:41984
    ds_read_b128 v[28:31], v2 offset:42240
    s_mov_b64 exec, -1
    v_exp_f32 v62, v62
    v_exp_f32 v63, v63
    v_exp_f32 v64, v64
    v_cvt_pk_bf16_f32 v56, v56, v57
    v_cvt_pk_bf16_f32 v57, v58, v59
    v_cvt_pk_bf16_f32 v58, v60, v61
    v_cvt_pk_bf16_f32 v59, v62, v63
    v_exp_f32 v65, v65
    v_exp_f32 v66, v66
    v_exp_f32 v67, v67
    v_mfma_f32_32x32x16_bf16 v[72:87], v[32:35], v[56:59], v[72:87]
    s_add_u32 s26, s26, 4096
    buffer_load_dwordx4 v[144:147], v0, s[4:7], s26 offen offset:0
    buffer_load_dwordx4 v[148:151], v0, s[4:7], s26 offen offset:1024
    v_exp_f32 v68, v68
    v_exp_f32 v69, v69
    v_exp_f32 v70, v70
    v_exp_f32 v71, v71
    v_cvt_pk_bf16_f32 v64, v64, v65
    v_cvt_pk_bf16_f32 v65, v66, v67
    v_cvt_pk_bf16_f32 v66, v68, v69
    v_cvt_pk_bf16_f32 v67, v70, v71
    s_setprio 0
    v_exp_f32 v40, v40
    v_exp_f32 v41, v41
    v_mfma_f32_32x32x16_bf16 v[72:87], v[36:39], v[64:67], v[72:87]
    v_exp_f32 v42, v42
    v_exp_f32 v43, v43
    v_exp_f32 v44, v44
    v_exp_f32 v45, v45
    s_waitcnt lgkmcnt(0)
    v_mfma_f32_32x32x16_bf16 v[56:71], v[20:23], v[8:11], 0
    ds_read_b128 v[16:19], v2 offset:45056
    s_mov_b64 exec, s[38:39]
    ds_read_b128 v[32:35], v2 offset:44032
    ds_read_b128 v[36:39], v2 offset:44288
    s_mov_b64 exec, -1
    v_exp_f32 v46, v46
    v_exp_f32 v47, v47
    v_exp_f32 v48, v48
    v_cvt_pk_bf16_f32 v40, v40, v41
    v_cvt_pk_bf16_f32 v41, v42, v43
    v_cvt_pk_bf16_f32 v42, v44, v45
    v_cvt_pk_bf16_f32 v43, v46, v47
    v_exp_f32 v49, v49
    v_exp_f32 v50, v50
    v_exp_f32 v51, v51
    v_mfma_f32_32x32x16_bf16 v[72:87], v[24:27], v[40:43], v[72:87]
    buffer_load_dwordx4 v[152:155], v0, s[4:7], s26 offen offset:2048
    buffer_load_dwordx4 v[156:159], v0, s[4:7], s26 offen offset:3072
    v_exp_f32 v52, v52
    v_exp_f32 v53, v53
    v_exp_f32 v54, v54
    v_exp_f32 v55, v55
    v_cvt_pk_bf16_f32 v48, v48, v49
    v_cvt_pk_bf16_f32 v49, v50, v51
    v_cvt_pk_bf16_f32 v50, v52, v53
    v_cvt_pk_bf16_f32 v51, v54, v55
    v_exp_f32 v56, v56
    v_exp_f32 v57, v57
    v_mfma_f32_32x32x16_bf16 v[72:87], v[28:31], v[48:51], v[72:87]
    v_exp_f32 v58, v58
    v_exp_f32 v59, v59
    v_exp_f32 v60, v60
    v_exp_f32 v61, v61
    s_waitcnt lgkmcnt(0)
    v_mfma_f32_32x32x16_bf16 v[40:55], v[16:19], v[8:11], 0
    ds_read_b128 v[20:23], v2 offset:47104
    s_mov_b64 exec, s[38:39]
    ds_read_b128 v[24:27], v2 offset:46080
    ds_read_b128 v[28:31], v2 offset:46336
    s_mov_b64 exec, -1
    v_exp_f32 v62, v62
    v_exp_f32 v63, v63
    v_exp_f32 v64, v64
    v_cvt_pk_bf16_f32 v56, v56, v57
    v_cvt_pk_bf16_f32 v57, v58, v59
    v_cvt_pk_bf16_f32 v58, v60, v61
    v_cvt_pk_bf16_f32 v59, v62, v63
    v_exp_f32 v65, v65
    v_exp_f32 v66, v66
    v_exp_f32 v67, v67
    v_mfma_f32_32x32x16_bf16 v[72:87], v[32:35], v[56:59], v[72:87]
    s_lshl_b32 s28, s32, 15
    s_add_u32 s28, s28, 0x100000
    buffer_load_dwordx4 v[160:163], v0, s[4:7], s28 offen offset:0
    buffer_load_dwordx4 v[164:167], v0, s[4:7], s28 offen offset:1024
    v_exp_f32 v68, v68
    v_exp_f32 v69, v69
    v_exp_f32 v70, v70
    v_exp_f32 v71, v71
    v_cvt_pk_bf16_f32 v64, v64, v65
    v_cvt_pk_bf16_f32 v65, v66, v67
    v_cvt_pk_bf16_f32 v66, v68, v69
    v_cvt_pk_bf16_f32 v67, v70, v71
    v_exp_f32 v40, v40
    v_exp_f32 v41, v41
    v_mfma_f32_32x32x16_bf16 v[72:87], v[36:39], v[64:67], v[72:87]
    v_exp_f32 v42, v42
    v_exp_f32 v43, v43
    v_exp_f32 v44, v44
    v_exp_f32 v45, v45
    s_waitcnt vmcnt(10)
    s_barrier
    s_waitcnt lgkmcnt(0)
    v_mfma_f32_32x32x16_bf16 v[56:71], v[20:23], v[8:11], 0
    ds_read_b128 v[16:19], v2 offset:49152
    s_mov_b64 exec, s[38:39]
    ds_read_b128 v[32:35], v2 offset:48128
    ds_read_b128 v[36:39], v2 offset:48384
    s_mov_b64 exec, -1
    v_exp_f32 v46, v46
    v_exp_f32 v47, v47
    v_exp_f32 v48, v48
    v_cvt_pk_bf16_f32 v40, v40, v41
    v_cvt_pk_bf16_f32 v41, v42, v43
    v_cvt_pk_bf16_f32 v42, v44, v45
    v_cvt_pk_bf16_f32 v43, v46, v47
    v_exp_f32 v49, v49
    v_exp_f32 v50, v50
    v_exp_f32 v51, v51
    v_mfma_f32_32x32x16_bf16 v[72:87], v[24:27], v[40:43], v[72:87]
    buffer_load_dwordx4 v[224:227], v0, s[4:7], s28 offen offset:2048
    buffer_load_dwordx4 v[228:231], v0, s[4:7], s28 offen offset:3072
    v_exp_f32 v52, v52
    v_exp_f32 v53, v53
    v_exp_f32 v54, v54
    v_exp_f32 v55, v55
    v_cvt_pk_bf16_f32 v48, v48, v49
    v_cvt_pk_bf16_f32 v49, v50, v51
    v_cvt_pk_bf16_f32 v50, v52, v53
    v_cvt_pk_bf16_f32 v51, v54, v55
    s_cmp_lt_u32 s20, 4
    s_cbranch_scc1 L_pr_88
    s_setprio 1
L_pr_88:
    v_exp_f32 v56, v56
    v_exp_f32 v57, v57
    v_mfma_f32_32x32x16_bf16 v[72:87], v[28:31], v[48:51], v[72:87]
    v_exp_f32 v58, v58
    v_exp_f32 v59, v59
    v_exp_f32 v60, v60
    v_exp_f32 v61, v61
    s_waitcnt lgkmcnt(0)
    v_mfma_f32_32x32x16_bf16 v[40:55], v[16:19], v[8:11], 0
    ds_read_b128 v[20:23], v2 offset:51200
    s_mov_b64 exec, s[38:39]
    ds_read_b128 v[24:27], v2 offset:50176
    ds_read_b128 v[28:31], v2 offset:50432
    s_mov_b64 exec, -1
    v_exp_f32 v62, v62
    v_exp_f32 v63, v63
    v_exp_f32 v64, v64
    v_cvt_pk_bf16_f32 v56, v56, v57
    v_cvt_pk_bf16_f32 v57, v58, v59
    v_cvt_pk_bf16_f32 v58, v60, v61
    v_cvt_pk_bf16_f32 v59, v62, v63
    v_exp_f32 v65, v65
    v_exp_f32 v66, v66
    v_exp_f32 v67, v67
    v_mfma_f32_32x32x16_bf16 v[72:87], v[32:35], v[56:59], v[72:87]
    s_add_u32 s28, s28, 4096
    buffer_load_dwordx4 v[168:171], v0, s[4:7], s28 offen offset:0
    buffer_load_dwordx4 v[172:175], v0, s[4:7], s28 offen offset:1024
    v_exp_f32 v68, v68
    v_exp_f32 v69, v69
    v_exp_f32 v70, v70
    v_exp_f32 v71, v71
    v_cvt_pk_bf16_f32 v64, v64, v65
    v_cvt_pk_bf16_f32 v65, v66, v67
    v_cvt_pk_bf16_f32 v66, v68, v69
    v_cvt_pk_bf16_f32 v67, v70, v71
    v_exp_f32 v40, v40
    v_exp_f32 v41, v41
    v_mfma_f32_32x32x16_bf16 v[72:87], v[36:39], v[64:67], v[72:87]
    v_exp_f32 v42, v42
    v_exp_f32 v43, v43
    v_exp_f32 v44, v44
    v_exp_f32 v45, v45
    s_waitcnt lgkmcnt(0)
    v_mfma_f32_32x32x16_bf16 v[56:71], v[20:23], v[8:11], 0
    ds_read_b128 v[16:19], v2 offset:53248
    s_mov_b64 exec, s[38:39]
    ds_read_b128 v[32:35], v2 offset:52224
    ds_read_b128 v[36:39], v2 offset:52480
    s_mov_b64 exec, -1
    v_exp_f32 v46, v46
    v_exp_f32 v47, v47
    v_exp_f32 v48, v48
    v_cvt_pk_bf16_f32 v40, v40, v41
    v_cvt_pk_bf16_f32 v41, v42, v43
    v_cvt_pk_bf16_f32 v42, v44, v45
    v_cvt_pk_bf16_f32 v43, v46, v47
    v_exp_f32 v49, v49
    v_exp_f32 v50, v50
    v_exp_f32 v51, v51
    v_mfma_f32_32x32x16_bf16 v[72:87], v[24:27], v[40:43], v[72:87]
    buffer_load_dwordx4 v[232:235], v0, s[4:7], s28 offen offset:2048
    buffer_load_dwordx4 v[236:239], v0, s[4:7], s28 offen offset:3072
    v_exp_f32 v52, v52
    v_exp_f32 v53, v53
    v_exp_f32 v54, v54
    v_exp_f32 v55, v55
    v_cvt_pk_bf16_f32 v48, v48, v49
    v_cvt_pk_bf16_f32 v49, v50, v51
    v_cvt_pk_bf16_f32 v50, v52, v53
    v_cvt_pk_bf16_f32 v51, v54, v55
    v_exp_f32 v56, v56
    v_exp_f32 v57, v57
    v_mfma_f32_32x32x16_bf16 v[72:87], v[28:31], v[48:51], v[72:87]
    v_exp_f32 v58, v58
    v_exp_f32 v59, v59
    v_exp_f32 v60, v60
    v_exp_f32 v61, v61
    s_waitcnt lgkmcnt(0)
    v_mfma_f32_32x32x16_bf16 v[40:55], v[16:19], v[8:11], 0
    ds_read_b128 v[20:23], v2 offset:55296
    s_mov_b64 exec, s[38:39]
    ds_read_b128 v[24:27], v2 offset:54272
    ds_read_b128 v[28:31], v2 offset:54528
    s_mov_b64 exec, -1
    v_exp_f32 v62, v62
    v_exp_f32 v63, v63
    v_exp_f32 v64, v64
    v_cvt_pk_bf16_f32 v56, v56, v57
    v_cvt_pk_bf16_f32 v57, v58, v59
    v_cvt_pk_bf16_f32 v58, v60, v61
    v_cvt_pk_bf16_f32 v59, v62, v63
    v_exp_f32 v65, v65
    v_exp_f32 v66, v66
    v_exp_f32 v67, v67
    v_mfma_f32_32x32x16_bf16 v[72:87], v[32:35], v[56:59], v[72:87]
    s_add_u32 s28, s28, 4096
    buffer_load_dwordx4 v[176:179], v0, s[4:7], s28 offen offset:0
    buffer_load_dwordx4 v[180:183], v0, s[4:7], s28 offen offset:1024
    v_exp_f32 v68, v68
    v_exp_f32 v69, v69
    v_exp_f32 v70, v70
    v_exp_f32 v71, v71
    v_cvt_pk_bf16_f32 v64, v64, v65
    v_cvt_pk_bf16_f32 v65, v66, v67
    v_cvt_pk_bf16_f32 v66, v68, v69
    v_cvt_pk_bf16_f32 v67, v70, v71
    v_exp_f32 v40, v40
    v_exp_f32 v41, v41
    v_mfma_f32_32x32x16_bf16 v[72:87], v[36:39], v[64:67], v[72:87]
    v_exp_f32 v42, v42
    v_exp_f32 v43, v43
    v_exp_f32 v44, v44
    v_exp_f32 v45, v45
    s_waitcnt lgkmcnt(0)
    v_mfma_f32_32x32x16_bf16 v[56:71], v[20:23], v[8:11], 0
    ds_read_b128 v[16:19], v2 offset:57344
    s_mov_b64 exec, s[38:39]
    ds_read_b128 v[32:35], v2 offset:56320
    ds_read_b128 v[36:39], v2 offset:56576
    s_mov_b64 exec, -1
    v_exp_f32 v46, v46
    v_exp_f32 v47, v47
    v_exp_f32 v48, v48
    v_cvt_pk_bf16_f32 v40, v40, v41
    v_cvt_pk_bf16_f32 v41, v42, v43
    v_cvt_pk_bf16_f32 v42, v44, v45
    v_cvt_pk_bf16_f32 v43, v46, v47
    v_exp_f32 v49, v49
    v_exp_f32 v50, v50
    v_exp_f32 v51, v51
    v_mfma_f32_32x32x16_bf16 v[72:87], v[24:27], v[40:43], v[72:87]
    buffer_load_dwordx4 v[240:243], v0, s[4:7], s28 offen offset:2048
    buffer_load_dwordx4 v[244:247], v0, s[4:7], s28 offen offset:3072
    v_exp_f32 v52, v52
    v_exp_f32 v53, v53
    v_exp_f32 v54, v54
    v_exp_f32 v55, v55
    v_cvt_pk_bf16_f32 v48, v48, v49
    v_cvt_pk_bf16_f32 v49, v50, v51
    v_cvt_pk_bf16_f32 v50, v52, v53
    v_cvt_pk_bf16_f32 v51, v54, v55
    v_exp_f32 v56, v56
    v_exp_f32 v57, v57
    v_mfma_f32_32x32x16_bf16 v[72:87], v[28:31], v[48:51], v[72:87]
    v_exp_f32 v58, v58
    v_exp_f32 v59, v59
    v_exp_f32 v60, v60
    v_exp_f32 v61, v61
    s_waitcnt lgkmcnt(0)
    v_mfma_f32_32x32x16_bf16 v[40:55], v[16:19], v[8:11], 0
    ds_read_b128 v[20:23], v2 offset:59392
    s_mov_b64 exec, s[38:39]
    ds_read_b128 v[24:27], v2 offset:58368
    ds_read_b128 v[28:31], v2 offset:58624
    s_mov_b64 exec, -1
    v_exp_f32 v62, v62
    v_exp_f32 v63, v63
    v_exp_f32 v64, v64
    v_cvt_pk_bf16_f32 v56, v56, v57
    v_cvt_pk_bf16_f32 v57, v58, v59
    v_cvt_pk_bf16_f32 v58, v60, v61
    v_cvt_pk_bf16_f32 v59, v62, v63
    v_exp_f32 v65, v65
    v_exp_f32 v66, v66
    v_exp_f32 v67, v67
    v_mfma_f32_32x32x16_bf16 v[72:87], v[32:35], v[56:59], v[72:87]
    s_add_u32 s28, s28, 4096
    buffer_load_dwordx4 v[184:187], v0, s[4:7], s28 offen offset:0
    buffer_load_dwordx4 v[188:191], v0, s[4:7], s28 offen offset:1024
    v_exp_f32 v68, v68
    v_exp_f32 v69, v69
    v_exp_f32 v70, v70
    v_exp_f32 v71, v71
    v_cvt_pk_bf16_f32 v64, v64, v65
    v_cvt_pk_bf16_f32 v65, v66, v67
    v_cvt_pk_bf16_f32 v66, v68, v69
    v_cvt_pk_bf16_f32 v67, v70, v71
    v_exp_f32 v40, v40
    v_exp_f32 v41, v41
    v_mfma_f32_32x32x16_bf16 v[72:87], v[36:39], v[64:67], v[72:87]
    v_exp_f32 v42, v42
    v_exp_f32 v43, v43
    v_exp_f32 v44, v44
    v_exp_f32 v45, v45
    s_waitcnt lgkmcnt(0)
    v_mfma_f32_32x32x16_bf16 v[56:71], v[20:23], v[8:11], 0
    ds_read_b128 v[16:19], v2 offset:61440
    s_mov_b64 exec, s[38:39]
    ds_read_b128 v[32:35], v2 offset:60416
    ds_read_b128 v[36:39], v2 offset:60672
    s_mov_b64 exec, -1
    v_exp_f32 v46, v46
    v_exp_f32 v47, v47
    v_exp_f32 v48, v48
    v_cvt_pk_bf16_f32 v40, v40, v41
    v_cvt_pk_bf16_f32 v41, v42, v43
    v_cvt_pk_bf16_f32 v42, v44, v45
    v_cvt_pk_bf16_f32 v43, v46, v47
    v_exp_f32 v49, v49
    v_exp_f32 v50, v50
    v_exp_f32 v51, v51
    v_mfma_f32_32x32x16_bf16 v[72:87], v[24:27], v[40:43], v[72:87]
    buffer_load_dwordx4 v[248:251], v0, s[4:7], s28 offen offset:2048
    buffer_load_dwordx4 v[252:255], v0, s[4:7], s28 offen offset:3072
    v_exp_f32 v52, v52
    v_exp_f32 v53, v53
    v_exp_f32 v54, v54
    v_exp_f32 v55, v55
    v_cvt_pk_bf16_f32 v48, v48, v49
    v_cvt_pk_bf16_f32 v49, v50, v51
    v_cvt_pk_bf16_f32 v50, v52, v53
    v_cvt_pk_bf16_f32 v51, v54, v55
    v_exp_f32 v56, v56
    v_exp_f32 v57, v57
    v_mfma_f32_32x32x16_bf16 v[72:87], v[28:31], v[48:51], v[72:87]
    v_exp_f32 v58, v58
    v_exp_f32 v59, v59
    v_exp_f32 v60, v60
    v_exp_f32 v61, v61
    s_waitcnt lgkmcnt(0)
    v_mfma_f32_32x32x16_bf16 v[40:55], v[16:19], v[8:11], 0
    ds_read_b128 v[20:23], v2 offset:63488
    s_mov_b64 exec, s[38:39]
    ds_read_b128 v[24:27], v2 offset:62464
    ds_read_b128 v[28:31], v2 offset:62720
    s_mov_b64 exec, -1
    v_exp_f32 v62, v62
    v_exp_f32 v63, v63
    v_exp_f32 v64, v64
    v_cvt_pk_bf16_f32 v56, v56, v57
    v_cvt_pk_bf16_f32 v57, v58, v59
    v_cvt_pk_bf16_f32 v58, v60, v61
    v_cvt_pk_bf16_f32 v59, v62, v63
    v_exp_f32 v65, v65
    v_exp_f32 v66, v66
    v_exp_f32 v67, v67
    v_mfma_f32_32x32x16_bf16 v[72:87], v[32:35], v[56:59], v[72:87]
    s_add_u32 s28, s28, 4096
    buffer_load_dwordx4 v[192:195], v0, s[4:7], s28 offen offset:0
    buffer_load_dwordx4 v[196:199], v0, s[4:7], s28 offen offset:1024
    v_exp_f32 v68, v68
    v_exp_f32 v69, v69
    v_exp_f32 v70, v70
    v_exp_f32 v71, v71
    v_cvt_pk_bf16_f32 v64, v64, v65
    v_cvt_pk_bf16_f32 v65, v66, v67
    v_cvt_pk_bf16_f32 v66, v68, v69
    v_cvt_pk_bf16_f32 v67, v70, v71
    v_exp_f32 v40, v40
    v_exp_f32 v41, v41
    v_mfma_f32_32x32x16_bf16 v[72:87], v[36:39], v[64:67], v[72:87]
    v_exp_f32 v42, v42
    v_exp_f32 v43, v43
    v_exp_f32 v44, v44
    v_exp_f32 v45, v45
    s_waitcnt lgkmcnt(0)
    v_mfma_f32_32x32x16_bf16 v[56:71], v[20:23], v[8:11], 0
    ds_read_b128 v[16:19], v3 offset:0
    s_mov_b64 exec, s[38:39]
    ds_read_b128 v[32:35], v2 offset:64512
    ds_read_b128 v[36:39], v2 offset:64768
    s_mov_b64 exec, -1
    v_exp_f32 v46, v46
    v_exp_f32 v47, v47
    v_exp_f32 v48, v48
    v_cvt_pk_bf16_f32 v40, v40, v41
    v_cvt_pk_bf16_f32 v41, v42, v43
    v_cvt_pk_bf16_f32 v42, v44, v45
    v_cvt_pk_bf16_f32 v43, v46, v47
    v_exp_f32 v49, v49
    v_exp_f32 v50, v50
    v_exp_f32 v51, v51
    v_mfma_f32_32x32x16_bf16 v[72:87], v[24:27], v[40:43], v[72:87]
    s_add_u32 s28, s28, 4096
    buffer_load_dwordx4 v[200:203], v0, s[4:7], s28 offen offset:0
    buffer_load_dwordx4 v[204:207], v0, s[4:7], s28 offen offset:1024
    v_exp_f32 v52, v52
    v_exp_f32 v53, v53
    v_exp_f32 v54, v54
    v_exp_f32 v55, v55
    v_cvt_pk_bf16_f32 v48, v48, v49
    v_cvt_pk_bf16_f32 v49, v50, v51
    v_cvt_pk_bf16_f32 v50, v52, v53
    v_cvt_pk_bf16_f32 v51, v54, v55
    v_exp_f32 v56, v56
    v_exp_f32 v57, v57
    v_mfma_f32_32x32x16_bf16 v[72:87], v[28:31], v[48:51], v[72:87]
    v_exp_f32 v58, v58
    v_exp_f32 v59, v59
    v_exp_f32 v60, v60
    v_exp_f32 v61, v61
    s_waitcnt lgkmcnt(0)
    v_mfma_f32_32x32x16_bf16 v[40:55], v[16:19], v[8:11], 0
    ds_read_b128 v[20:23], v3 offset:2048
    s_mov_b64 exec, s[38:39]
    ds_read_b128 v[24:27], v3 offset:1024
    ds_read_b128 v[28:31], v3 offset:1280
    s_mov_b64 exec, -1
    v_exp_f32 v62, v62
    v_exp_f32 v63, v63
    v_exp_f32 v64, v64
    v_cvt_pk_bf16_f32 v56, v56, v57
    v_cvt_pk_bf16_f32 v57, v58, v59
    v_cvt_pk_bf16_f32 v58, v60, v61
    v_cvt_pk_bf16_f32 v59, v62, v63
    v_exp_f32 v65, v65
    v_exp_f32 v66, v66
    v_exp_f32 v67, v67
    v_mfma_f32_32x32x16_bf16 v[72:87], v[32:35], v[56:59], v[72:87]
    s_add_u32 s28, s28, 4096
    buffer_load_dwordx4 v[208:211], v0, s[4:7], s28 offen offset:0
    buffer_load_dwordx4 v[212:215], v0, s[4:7], s28 offen offset:1024
    v_exp_f32 v68, v68
    v_exp_f32 v69, v69
    v_exp_f32 v70, v70
    v_exp_f32 v71, v71
    v_cvt_pk_bf16_f32 v64, v64, v65
    v_cvt_pk_bf16_f32 v65, v66, v67
    v_cvt_pk_bf16_f32 v66, v68, v69
    v_cvt_pk_bf16_f32 v67, v70, v71
    v_exp_f32 v40, v40
    v_exp_f32 v41, v41
    v_mfma_f32_32x32x16_bf16 v[72:87], v[36:39], v[64:67], v[72:87]
    v_exp_f32 v42, v42
    v_exp_f32 v43, v43
    v_exp_f32 v44, v44
    v_exp_f32 v45, v45
    s_waitcnt lgkmcnt(0)
    v_mfma_f32_32x32x16_bf16 v[56:71], v[20:23], v[8:11], 0
    ds_read_b128 v[16:19], v3 offset:4096
    s_mov_b64 exec, s[38:39]
    ds_read_b128 v[32:35], v3 offset:3072
    ds_read_b128 v[36:39], v3 offset:3328
    s_mov_b64 exec, -1
    v_exp_f32 v46, v46
    v_exp_f32 v47, v47
    v_exp_f32 v48, v48
    v_cvt_pk_bf16_f32 v40, v40, v41
    v_cvt_pk_bf16_f32 v41, v42, v43
    v_cvt_pk_bf16_f32 v42, v44, v45
    v_cvt_pk_bf16_f32 v43, v46, v47
    v_exp_f32 v49, v49
    v_exp_f32 v50, v50
    v_exp_f32 v51, v51
    v_mfma_f32_32x32x16_bf16 v[72:87], v[24:27], v[40:43], v[72:87]
    s_add_u32 s28, s28, 4096
    buffer_load_dwordx4 v[216:219], v0, s[4:7], s28 offen offset:0
    buffer_load_dwordx4 v[220:223], v0, s[4:7], s28 offen offset:1024
    v_exp_f32 v52, v52
    v_exp_f32 v53, v53
    v_exp_f32 v54, v54
    v_exp_f32 v55, v55
    v_cvt_pk_bf16_f32 v48, v48, v49
    v_cvt_pk_bf16_f32 v49, v50, v51
    v_cvt_pk_bf16_f32 v50, v52, v53
    v_cvt_pk_bf16_f32 v51, v54, v55
    v_exp_f32 v56, v56
    v_exp_f32 v57, v57
    v_mfma_f32_32x32x16_bf16 v[72:87], v[28:31], v[48:51], v[72:87]
    v_exp_f32 v58, v58
    v_exp_f32 v59, v59
    v_exp_f32 v60, v60
    v_exp_f32 v61, v61
    s_waitcnt lgkmcnt(0)
    v_mfma_f32_32x32x16_bf16 v[40:55], v[16:19], v[8:11], 0
    ds_read_b128 v[20:23], v3 offset:6144
    s_mov_b64 exec, s[38:39]
    ds_read_b128 v[24:27], v3 offset:5120
    ds_read_b128 v[28:31], v3 offset:5376
    s_mov_b64 exec, -1
    v_exp_f32 v62, v62
    v_exp_f32 v63, v63
    v_exp_f32 v64, v64
    v_cvt_pk_bf16_f32 v56, v56, v57
    v_cvt_pk_bf16_f32 v57, v58, v59
    v_cvt_pk_bf16_f32 v58, v60, v61
    v_cvt_pk_bf16_f32 v59, v62, v63
    v_exp_f32 v65, v65
    v_exp_f32 v66, v66
    v_exp_f32 v67, v67
    v_mfma_f32_32x32x16_bf16 v[72:87], v[32:35], v[56:59], v[72:87]
    s_mul_i32 s27, s22, 176128
    s_add_u32 s27, s27, 0x1000000
    s_lshl_b32 s26, s32, 11
    s_add_u32 s26, s26, s27
    buffer_load_dword v90, v91, s[4:7], s26 offen
    s_add_u32 s26, s26, 88064
    buffer_load_dword v90, v91, s[4:7], s26 offen
    v_exp_f32 v68, v68
    v_exp_f32 v69, v69
    v_exp_f32 v70, v70
    v_exp_f32 v71, v71
    v_cvt_pk_bf16_f32 v64, v64, v65
    v_cvt_pk_bf16_f32 v65, v66, v67
    v_cvt_pk_bf16_f32 v66, v68, v69
    v_cvt_pk_bf16_f32 v67, v70, v71
    v_exp_f32 v40, v40
    v_exp_f32 v41, v41
    v_mfma_f32_32x32x16_bf16 v[72:87], v[36:39], v[64:67], v[72:87]
    v_exp_f32 v42, v42
    v_exp_f32 v43, v43
    v_exp_f32 v44, v44
    v_exp_f32 v45, v45
    s_waitcnt lgkmcnt(0)
    v_mfma_f32_32x32x16_bf16 v[56:71], v[20:23], v[8:11], 0
    ds_read_b128 v[16:19], v3 offset:8192
    s_mov_b64 exec, s[38:39]
    ds_read_b128 v[32:35], v3 offset:7168
    ds_read_b128 v[36:39], v3 offset:7424
    s_mov_b64 exec, -1
    v_exp_f32 v46, v46
    v_exp_f32 v47, v47
    v_exp_f32 v48, v48
    v_cvt_pk_bf16_f32 v40, v40, v41
    v_cvt_pk_bf16_f32 v41, v42, v43
    v_cvt_pk_bf16_f32 v42, v44, v45
    v_cvt_pk_bf16_f32 v43, v46, v47
    v_exp_f32 v49, v49
    v_exp_f32 v50, v50
    v_exp_f32 v51, v51
    v_mfma_f32_32x32x16_bf16 v[72:87], v[24:27], v[40:43], v[72:87]
    s_add_u32 s26, s34, 0x600000
    buffer_load_dword v90, v0, s[4:7], s26 offen
    s_andn2_b32 s26, s31, 0x3ff
    s_add_u32 s26, s26, 0x1a00000
    buffer_load_dword v90, v0, s[4:7], s26 offen
    v_exp_f32 v52, v52
    v_exp_f32 v53, v53
    v_exp_f32 v54, v54
    v_exp_f32 v55, v55
    v_cvt_pk_bf16_f32 v48, v48, v49
    v_cvt_pk_bf16_f32 v49, v50, v51
    v_cvt_pk_bf16_f32 v50, v52, v53
    v_cvt_pk_bf16_f32 v51, v54, v55
    v_exp_f32 v56, v56
    v_exp_f32 v57, v57
    v_mfma_f32_32x32x16_bf16 v[72:87], v[28:31], v[48:51], v[72:87]
    v_exp_f32 v58, v58
    v_exp_f32 v59, v59
    v_exp_f32 v60, v60
    v_exp_f32 v61, v61
    s_waitcnt lgkmcnt(0)
    v_mfma_f32_32x32x16_bf16 v[40:55], v[16:19], v[8:11], 0
    ds_read_b128 v[20:23], v3 offset:10240
    s_mov_b64 exec, s[38:39]
    ds_read_b128 v[24:27], v3 offset:9216
    ds_read_b128 v[28:31], v3 offset:9472
    s_mov_b64 exec, -1
    v_exp_f32 v62, v62
    v_exp_f32 v63, v63
    v_exp_f32 v64, v64
    v_cvt_pk_bf16_f32 v56, v56, v57
    v_cvt_pk_bf16_f32 v57, v58, v59
    v_cvt_pk_bf16_f32 v58, v60, v61
    v_cvt_pk_bf16_f32 v59, v62, v63
    v_exp_f32 v65, v65
    v_exp_f32 v66, v66
    v_exp_f32 v67, v67
    v_mfma_f32_32x32x16_bf16 v[72:87], v[32:35], v[56:59], v[72:87]
    v_exp_f32 v68, v68
    v_exp_f32 v69, v69
    v_exp_f32 v70, v70
    v_exp_f32 v71, v71
    v_cvt_pk_bf16_f32 v64, v64, v65
    v_cvt_pk_bf16_f32 v65, v66, v67
    v_cvt_pk_bf16_f32 v66, v68, v69
    v_cvt_pk_bf16_f32 v67, v70, v71
    v_exp_f32 v40, v40
    v_exp_f32 v41, v41
    v_mfma_f32_32x32x16_bf16 v[72:87], v[36:39], v[64:67], v[72:87]
    v_exp_f32 v42, v42
    v_exp_f32 v43, v43
    v_exp_f32 v44, v44
    v_exp_f32 v45, v45
    s_waitcnt lgkmcnt(0)
    v_mfma_f32_32x32x16_bf16 v[56:71], v[20:23], v[8:11], 0
    ds_read_b128 v[16:19], v3 offset:12288
    s_mov_b64 exec, s[38:39]
    ds_read_b128 v[32:35], v3 offset:11264
    ds_read_b128 v[36:39], v3 offset:11520
    s_mov_b64 exec, -1
    v_exp_f32 v46, v46
    v_exp_f32 v47, v47
    v_exp_f32 v48, v48
    v_cvt_pk_bf16_f32 v40, v40, v41
    v_cvt_pk_bf16_f32 v41, v42, v43
    v_cvt_pk_bf16_f32 v42, v44, v45
    v_cvt_pk_bf16_f32 v43, v46, v47
    v_exp_f32 v49, v49
    v_exp_f32 v50, v50
    v_exp_f32 v51, v51
    v_mfma_f32_32x32x16_bf16 v[72:87], v[24:27], v[40:43], v[72:87]
    v_exp_f32 v52, v52
    v_exp_f32 v53, v53
    v_exp_f32 v54, v54
    v_exp_f32 v55, v55
    v_cvt_pk_bf16_f32 v48, v48, v49
    v_cvt_pk_bf16_f32 v49, v50, v51
    v_cvt_pk_bf16_f32 v50, v52, v53
    v_cvt_pk_bf16_f32 v51, v54, v55
    v_exp_f32 v56, v56
    v_exp_f32 v57, v57
    v_mfma_f32_32x32x16_bf16 v[72:87], v[28:31], v[48:51], v[72:87]
    v_exp_f32 v58, v58
    v_exp_f32 v59, v59
    v_exp_f32 v60, v60
    v_exp_f32 v61, v61
    s_waitcnt lgkmcnt(0)
    v_mfma_f32_32x32x16_bf16 v[40:55], v[16:19], v[8:11], 0
    ds_read_b128 v[20:23], v3 offset:14336
    s_mov_b64 exec, s[38:39]
    ds_read_b128 v[24:27], v3 offset:13312
    ds_read_b128 v[28:31], v3 offset:13568
    s_mov_b64 exec, -1
    v_exp_f32 v62, v62
    v_exp_f32 v63, v63
    v_exp_f32 v64, v64
    v_cvt_pk_bf16_f32 v56, v56, v57
    v_cvt_pk_bf16_f32 v57, v58, v59
    v_cvt_pk_bf16_f32 v58, v60, v61
    v_cvt_pk_bf16_f32 v59, v62, v63
    v_exp_f32 v65, v65
    v_exp_f32 v66, v66
    v_exp_f32 v67, v67
    v_mfma_f32_32x32x16_bf16 v[72:87], v[32:35], v[56:59], v[72:87]
    v_exp_f32 v68, v68
    v_exp_f32 v69, v69
    v_exp_f32 v70, v70
    v_exp_f32 v71, v71
    v_cvt_pk_bf16_f32 v64, v64, v65
    v_cvt_pk_bf16_f32 v65, v66, v67
    v_cvt_pk_bf16_f32 v66, v68, v69
    v_cvt_pk_bf16_f32 v67, v70, v71
    v_exp_f32 v40, v40
    v_exp_f32 v41, v41
    v_mfma_f32_32x32x16_bf16 v[72:87], v[36:39], v[64:67], v[72:87]
    v_exp_f32 v42, v42
    v_exp_f32 v43, v43
    v_exp_f32 v44, v44
    v_exp_f32 v45, v45
    s_waitcnt lgkmcnt(0)
    v_mfma_f32_32x32x16_bf16 v[56:71], v[20:23], v[8:11], 0
    ds_read_b128 v[16:19], v3 offset:16384
    s_mov_b64 exec, s[38:39]
    ds_read_b128 v[32:35], v3 offset:15360
    ds_read_b128 v[36:39], v3 offset:15616
    s_mov_b64 exec, -1
    v_exp_f32 v46, v46
    v_exp_f32 v47, v47
    v_exp_f32 v48, v48
    v_cvt_pk_bf16_f32 v40, v40, v41
    v_cvt_pk_bf16_f32 v41, v42, v43
    v_cvt_pk_bf16_f32 v42, v44, v45
    v_cvt_pk_bf16_f32 v43, v46, v47
    v_exp_f32 v49, v49
    v_exp_f32 v50, v50
    v_exp_f32 v51, v51
    v_mfma_f32_32x32x16_bf16 v[72:87], v[24:27], v[40:43], v[72:87]
    v_exp_f32 v52, v52
    v_exp_f32 v53, v53
    v_exp_f32 v54, v54
    v_exp_f32 v55, v55
    v_cvt_pk_bf16_f32 v48, v48, v49
    v_cvt_pk_bf16_f32 v49, v50, v51
    v_cvt_pk_bf16_f32 v50, v52, v53
    v_cvt_pk_bf16_f32 v51, v54, v55
    v_exp_f32 v56, v56
    v_exp_f32 v57, v57
    v_mfma_f32_32x32x16_bf16 v[72:87], v[28:31], v[48:51], v[72:87]
    v_exp_f32 v58, v58
    v_exp_f32 v59, v59
    v_exp_f32 v60, v60
    v_exp_f32 v61, v61
    s_waitcnt lgkmcnt(0)
    v_mfma_f32_32x32x16_bf16 v[40:55], v[16:19], v[8:11], 0
    ds_read_b128 v[20:23], v3 offset:18432
    s_mov_b64 exec, s[38:39]
    ds_read_b128 v[24:27], v3 offset:17408
    ds_read_b128 v[28:31], v3 offset:17664
    s_mov_b64 exec, -1
    v_exp_f32 v62, v62
    v_exp_f32 v63, v63
    v_exp_f32 v64, v64
    v_cvt_pk_bf16_f32 v56, v56, v57
    v_cvt_pk_bf16_f32 v57, v58, v59
    v_cvt_pk_bf16_f32 v58, v60, v61
    v_cvt_pk_bf16_f32 v59, v62, v63
    v_exp_f32 v65, v65
    v_exp_f32 v66, v66
    v_exp_f32 v67, v67
    v_mfma_f32_32x32x16_bf16 v[72:87], v[32:35], v[56:59], v[72:87]
    v_exp_f32 v68, v68
    v_exp_f32 v69, v69
    v_exp_f32 v70, v70
    v_exp_f32 v71, v71
    v_cvt_pk_bf16_f32 v64, v64, v65
    v_cvt_pk_bf16_f32 v65, v66, v67
    v_cvt_pk_bf16_f32 v66, v68, v69
    v_cvt_pk_bf16_f32 v67, v70, v71
    v_exp_f32 v40, v40
    v_exp_f32 v41, v41
    v_mfma_f32_32x32x16_bf16 v[72:87], v[36:39], v[64:67], v[72:87]
    v_exp_f32 v42, v42
    v_exp_f32 v43, v43
    v_exp_f32 v44, v44
    v_exp_f32 v45, v45
    s_waitcnt lgkmcnt(0)
    v_mfma_f32_32x32x16_bf16 v[56:71], v[20:23], v[8:11], 0
    ds_read_b128 v[16:19], v3 offset:20480
    s_mov_b64 exec, s[38:39]
    ds_read_b128 v[32:35], v3 offset:19456
    ds_read_b128 v[36:39], v3 offset:19712
    s_mov_b64 exec, -1
    v_exp_f32 v46, v46
    v_exp_f32 v47, v47
    v_exp_f32 v48, v48
    v_cvt_pk_bf16_f32 v40, v40, v41
    v_cvt_pk_bf16_f32 v41, v42, v43
    v_cvt_pk_bf16_f32 v42, v44, v45
    v_cvt_pk_bf16_f32 v43, v46, v47
    v_exp_f32 v49, v49
    v_exp_f32 v50, v50
    v_exp_f32 v51, v51
    v_mfma_f32_32x32x16_bf16 v[72:87], v[24:27], v[40:43], v[72:87]
    v_exp_f32 v52, v52
    v_exp_f32 v53, v53
    v_exp_f32 v54, v54
    v_exp_f32 v55, v55
    v_cvt_pk_bf16_f32 v48, v48, v49
    v_cvt_pk_bf16_f32 v49, v50, v51
    v_cvt_pk_bf16_f32 v50, v52, v53
    v_cvt_pk_bf16_f32 v51, v54, v55
    v_exp_f32 v56, v56
    v_exp_f32 v57, v57
    v_mfma_f32_32x32x16_bf16 v[72:87], v[28:31], v[48:51], v[72:87]
    v_exp_f32 v58, v58
    v_exp_f32 v59, v59
    v_exp_f32 v60, v60
    v_exp_f32 v61, v61
    s_waitcnt lgkmcnt(0)
    v_mfma_f32_32x32x16_bf16 v[40:55], v[16:19], v[8:11], 0
    ds_read_b128 v[20:23], v3 offset:22528
    s_mov_b64 exec, s[38:39]
    ds_read_b128 v[24:27], v3 offset:21504
    ds_read_b128 v[28:31], v3 offset:21760
    s_mov_b64 exec, -1
    v_exp_f32 v62, v62
    v_exp_f32 v63, v63
    v_exp_f32 v64, v64
    v_cvt_pk_bf16_f32 v56, v56, v57
    v_cvt_pk_bf16_f32 v57, v58, v59
    v_cvt_pk_bf16_f32 v58, v60, v61
    v_cvt_pk_bf16_f32 v59, v62, v63
    v_exp_f32 v65, v65
    v_exp_f32 v66, v66
    v_exp_f32 v67, v67
    v_mfma_f32_32x32x16_bf16 v[72:87], v[32:35], v[56:59], v[72:87]
    v_exp_f32 v68, v68
    v_exp_f32 v69, v69
    v_exp_f32 v70, v70
    v_exp_f32 v71, v71
    v_cvt_pk_bf16_f32 v64, v64, v65
    v_cvt_pk_bf16_f32 v65, v66, v67
    v_cvt_pk_bf16_f32 v66, v68, v69
    v_cvt_pk_bf16_f32 v67, v70, v71
    v_exp_f32 v40, v40
    v_exp_f32 v41, v41
    v_mfma_f32_32x32x16_bf16 v[72:87], v[36:39], v[64:67], v[72:87]
    v_exp_f32 v42, v42
    v_exp_f32 v43, v43
    v_exp_f32 v44, v44
    v_exp_f32 v45, v45
    s_waitcnt lgkmcnt(0)
    v_mfma_f32_32x32x16_bf16 v[56:71], v[20:23], v[8:11], 0
    ds_read_b128 v[16:19], v3 offset:24576
    s_mov_b64 exec, s[38:39]
    ds_read_b128 v[32:35], v3 offset:23552
    ds_read_b128 v[36:39], v3 offset:23808
    s_mov_b64 exec, -1
    v_exp_f32 v46, v46
    v_exp_f32 v47, v47
    v_exp_f32 v48, v48
    v_cvt_pk_bf16_f32 v40, v40, v41
    v_cvt_pk_bf16_f32 v41, v42, v43
    v_cvt_pk_bf16_f32 v42, v44, v45
    v_cvt_pk_bf16_f32 v43, v46, v47
    v_exp_f32 v49, v49
    v_exp_f32 v50, v50
    v_exp_f32 v51, v51
    v_mfma_f32_32x32x16_bf16 v[72:87], v[24:27], v[40:43], v[72:87]
    v_exp_f32 v52, v52
    v_exp_f32 v53, v53
    v_exp_f32 v54, v54
    v_exp_f32 v55, v55
    v_cvt_pk_bf16_f32 v48, v48, v49
    v_cvt_pk_bf16_f32 v49, v50, v51
    v_cvt_pk_bf16_f32 v50, v52, v53
    v_cvt_pk_bf16_f32 v51, v54, v55
    v_exp_f32 v56, v56
    v_exp_f32 v57, v57
    v_mfma_f32_32x32x16_bf16 v[72:87], v[28:31], v[48:51], v[72:87]
    v_exp_f32 v58, v58
    v_exp_f32 v59, v59
    v_exp_f32 v60, v60
    v_exp_f32 v61, v61
    s_waitcnt lgkmcnt(0)
    v_mfma_f32_32x32x16_bf16 v[40:55], v[16:19], v[8:11], 0
    ds_read_b128 v[20:23], v3 offset:26624
    s_mov_b64 exec, s[38:39]
    ds_read_b128 v[24:27], v3 offset:25600
    ds_read_b128 v[28:31], v3 offset:25856
    s_mov_b64 exec, -1
    v_exp_f32 v62, v62
    v_exp_f32 v63, v63
    v_exp_f32 v64, v64
    v_cvt_pk_bf16_f32 v56, v56, v57
    v_cvt_pk_bf16_f32 v57, v58, v59
    v_cvt_pk_bf16_f32 v58, v60, v61
    v_cvt_pk_bf16_f32 v59, v62, v63
    v_exp_f32 v65, v65
    v_exp_f32 v66, v66
    v_exp_f32 v67, v67
    v_mfma_f32_32x32x16_bf16 v[72:87], v[32:35], v[56:59], v[72:87]
    v_exp_f32 v68, v68
    v_exp_f32 v69, v69
    v_exp_f32 v70, v70
    v_exp_f32 v71, v71
    v_cvt_pk_bf16_f32 v64, v64, v65
    v_cvt_pk_bf16_f32 v65, v66, v67
    v_cvt_pk_bf16_f32 v66, v68, v69
    v_cvt_pk_bf16_f32 v67, v70, v71
    v_exp_f32 v40, v40
    v_exp_f32 v41, v41
    v_mfma_f32_32x32x16_bf16 v[72:87], v[36:39], v[64:67], v[72:87]
    v_exp_f32 v42, v42
    v_exp_f32 v43, v43
    v_exp_f32 v44, v44
    v_exp_f32 v45, v45
    s_waitcnt lgkmcnt(0)
    v_mfma_f32_32x32x16_bf16 v[56:71], v[20:23], v[8:11], 0
    ds_read_b128 v[16:19], v3 offset:28672
    s_mov_b64 exec, s[38:39]
    ds_read_b128 v[32:35], v3 offset:27648
    ds_read_b128 v[36:39], v3 offset:27904
    s_mov_b64 exec, -1
    v_exp_f32 v46, v46
    v_exp_f32 v47, v47
    v_exp_f32 v48, v48
    v_cvt_pk_bf16_f32 v40, v40, v41
    v_cvt_pk_bf16_f32 v41, v42, v43
    v_cvt_pk_bf16_f32 v42, v44, v45
    v_cvt_pk_bf16_f32 v43, v46, v47
    v_exp_f32 v49, v49
    v_exp_f32 v50, v50
    v_exp_f32 v51, v51
    v_mfma_f32_32x32x16_bf16 v[72:87], v[24:27], v[40:43], v[72:87]
    v_exp_f32 v52, v52
    v_exp_f32 v53, v53
    v_exp_f32 v54, v54
    v_exp_f32 v55, v55
    v_cvt_pk_bf16_f32 v48, v48, v49
    v_cvt_pk_bf16_f32 v49, v50, v51
    v_cvt_pk_bf16_f32 v50, v52, v53
    v_cvt_pk_bf16_f32 v51, v54, v55
    v_exp_f32 v56, v56
    v_exp_f32 v57, v57
    v_mfma_f32_32x32x16_bf16 v[72:87], v[28:31], v[48:51], v[72:87]
    v_exp_f32 v58, v58
    v_exp_f32 v59, v59
    v_exp_f32 v60, v60
    v_exp_f32 v61, v61
    s_waitcnt lgkmcnt(0)
    v_mfma_f32_32x32x16_bf16 v[40:55], v[16:19], v[8:11], 0
    ds_read_b128 v[20:23], v3 offset:30720
    s_mov_b64 exec, s[38:39]
    ds_read_b128 v[24:27], v3 offset:29696
    ds_read_b128 v[28:31], v3 offset:29952
    s_mov_b64 exec, -1
    v_exp_f32 v62, v62
    v_exp_f32 v63, v63
    v_exp_f32 v64, v64
    v_cvt_pk_bf16_f32 v56, v56, v57
    v_cvt_pk_bf16_f32 v57, v58, v59
    v_cvt_pk_bf16_f32 v58, v60, v61
    v_cvt_pk_bf16_f32 v59, v62, v63
    v_exp_f32 v65, v65
    v_exp_f32 v66, v66
    v_exp_f32 v67, v67
    v_mfma_f32_32x32x16_bf16 v[72:87], v[32:35], v[56:59], v[72:87]
    v_exp_f32 v68, v68
    v_exp_f32 v69, v69
    v_exp_f32 v70, v70
    v_exp_f32 v71, v71
    v_cvt_pk_bf16_f32 v64, v64, v65
    v_cvt_pk_bf16_f32 v65, v66, v67
    v_cvt_pk_bf16_f32 v66, v68, v69
    v_cvt_pk_bf16_f32 v67, v70, v71
    v_exp_f32 v40, v40
    v_exp_f32 v41, v41
    v_mfma_f32_32x32x16_bf16 v[72:87], v[36:39], v[64:67], v[72:87]
    v_exp_f32 v42, v42
    v_exp_f32 v43, v43
    v_exp_f32 v44, v44
    v_exp_f32 v45, v45
    s_waitcnt lgkmcnt(0)
    v_mfma_f32_32x32x16_bf16 v[56:71], v[20:23], v[8:11], 0
    ds_read_b128 v[16:19], v3 offset:32768
    s_mov_b64 exec, s[38:39]
    ds_read_b128 v[32:35], v3 offset:31744
    ds_read_b128 v[36:39], v3 offset:32000
    s_mov_b64 exec, -1
    v_exp_f32 v46, v46
    v_exp_f32 v47, v47
    v_exp_f32 v48, v48
    v_cvt_pk_bf16_f32 v40, v40, v41
    v_cvt_pk_bf16_f32 v41, v42, v43
    v_cvt_pk_bf16_f32 v42, v44, v45
    v_cvt_pk_bf16_f32 v43, v46, v47
    v_exp_f32 v49, v49
    v_exp_f32 v50, v50
    v_exp_f32 v51, v51
    v_mfma_f32_32x32x16_bf16 v[72:87], v[24:27], v[40:43], v[72:87]
    v_exp_f32 v52, v52
    v_exp_f32 v53, v53
    v_exp_f32 v54, v54
    v_exp_f32 v55, v55
    v_cvt_pk_bf16_f32 v48, v48, v49
    v_cvt_pk_bf16_f32 v49, v50, v51
    v_cvt_pk_bf16_f32 v50, v52, v53
    v_cvt_pk_bf16_f32 v51, v54, v55
    v_exp_f32 v56, v56
    v_exp_f32 v57, v57
    v_mfma_f32_32x32x16_bf16 v[72:87], v[28:31], v[48:51], v[72:87]
    v_exp_f32 v58, v58
    v_exp_f32 v59, v59
    v_exp_f32 v60, v60
    v_exp_f32 v61, v61
    s_waitcnt lgkmcnt(0)
    v_mfma_f32_32x32x16_bf16 v[40:55], v[16:19], v[8:11], 0
    ds_read_b128 v[20:23], v3 offset:34816
    s_mov_b64 exec, s[38:39]
    ds_read_b128 v[24:27], v3 offset:33792
    ds_read_b128 v[28:31], v3 offset:34048
    s_mov_b64 exec, -1
    v_exp_f32 v62, v62
    v_exp_f32 v63, v63
    v_exp_f32 v64, v64
    v_cvt_pk_bf16_f32 v56, v56, v57
    v_cvt_pk_bf16_f32 v57, v58, v59
    v_cvt_pk_bf16_f32 v58, v60, v61
    v_cvt_pk_bf16_f32 v59, v62, v63
    v_exp_f32 v65, v65
    v_exp_f32 v66, v66
    v_exp_f32 v67, v67
    v_mfma_f32_32x32x16_bf16 v[72:87], v[32:35], v[56:59], v[72:87]
    v_exp_f32 v68, v68
    v_exp_f32 v69, v69
    v_exp_f32 v70, v70
    v_exp_f32 v71, v71
    v_cvt_pk_bf16_f32 v64, v64, v65
    v_cvt_pk_bf16_f32 v65, v66, v67
    v_cvt_pk_bf16_f32 v66, v68, v69
    v_cvt_pk_bf16_f32 v67, v70, v71
    v_exp_f32 v40, v40
    v_exp_f32 v41, v41
    v_mfma_f32_32x32x16_bf16 v[72:87], v[36:39], v[64:67], v[72:87]
    v_exp_f32 v42, v42
    v_exp_f32 v43, v43
    v_exp_f32 v44, v44
    v_exp_f32 v45, v45
    s_waitcnt lgkmcnt(0)
    v_mfma_f32_32x32x16_bf16 v[56:71], v[20:23], v[8:11], 0
    ds_read_b128 v[16:19], v3 offset:36864
    s_mov_b64 exec, s[38:39]
    ds_read_b128 v[32:35], v3 offset:35840
    ds_read_b128 v[36:39], v3 offset:36096
    s_mov_b64 exec, -1
    v_exp_f32 v46, v46
    v_exp_f32 v47, v47
    v_exp_f32 v48, v48
    v_cvt_pk_bf16_f32 v40, v40, v41
    v_cvt_pk_bf16_f32 v41, v42, v43
    v_cvt_pk_bf16_f32 v42, v44, v45
    v_cvt_pk_bf16_f32 v43, v46, v47
    v_exp_f32 v49, v49
    v_exp_f32 v50, v50
    v_exp_f32 v51, v51
    v_mfma_f32_32x32x16_bf16 v[72:87], v[24:27], v[40:43], v[72:87]
    v_exp_f32 v52, v52
    v_exp_f32 v53, v53
    v_exp_f32 v54, v54
    v_exp_f32 v55, v55
    v_cvt_pk_bf16_f32 v48, v48, v49
    v_cvt_pk_bf16_f32 v49, v50, v51
    v_cvt_pk_bf16_f32 v50, v52, v53
    v_cvt_pk_bf16_f32 v51, v54, v55
    v_exp_f32 v56, v56
    v_exp_f32 v57, v57
    v_mfma_f32_32x32x16_bf16 v[72:87], v[28:31], v[48:51], v[72:87]
    v_exp_f32 v58, v58
    v_exp_f32 v59, v59
    v_exp_f32 v60, v60
    v_exp_f32 v61, v61
    s_waitcnt lgkmcnt(0)
    v_mfma_f32_32x32x16_bf16 v[40:55], v[16:19], v[8:11], 0
    ds_read_b128 v[20:23], v3 offset:38912
    s_mov_b64 exec, s[38:39]
    ds_read_b128 v[24:27], v3 offset:37888
    ds_read_b128 v[28:31], v3 offset:38144
    s_mov_b64 exec, -1
    v_exp_f32 v62, v62
    v_exp_f32 v63, v63
    v_exp_f32 v64, v64
    v_cvt_pk_bf16_f32 v56, v56, v57
    v_cvt_pk_bf16_f32 v57, v58, v59
    v_cvt_pk_bf16_f32 v58, v60, v61
    v_cvt_pk_bf16_f32 v59, v62, v63
    v_exp_f32 v65, v65
    v_exp_f32 v66, v66
    v_exp_f32 v67, v67
    v_mfma_f32_32x32x16_bf16 v[72:87], v[32:35], v[56:59], v[72:87]
    v_exp_f32 v68, v68
    v_exp_f32 v69, v69
    v_exp_f32 v70, v70
    v_exp_f32 v71, v71
    v_cvt_pk_bf16_f32 v64, v64, v65
    v_cvt_pk_bf16_f32 v65, v66, v67
    v_cvt_pk_bf16_f32 v66, v68, v69
    v_cvt_pk_bf16_f32 v67, v70, v71
    v_exp_f32 v40, v40
    v_exp_f32 v41, v41
    v_mfma_f32_32x32x16_bf16 v[72:87], v[36:39], v[64:67], v[72:87]
    v_exp_f32 v42, v42
    v_exp_f32 v43, v43
    v_exp_f32 v44, v44
    v_exp_f32 v45, v45
    s_waitcnt lgkmcnt(0)
    v_mfma_f32_32x32x16_bf16 v[56:71], v[20:23], v[8:11], 0
    ds_read_b128 v[16:19], v3 offset:40960
    s_mov_b64 exec, s[38:39]
    ds_read_b128 v[32:35], v3 offset:39936
    ds_read_b128 v[36:39], v3 offset:40192
    s_mov_b64 exec, -1
    v_exp_f32 v46, v46
    v_exp_f32 v47, v47
    v_exp_f32 v48, v48
    v_cvt_pk_bf16_f32 v40, v40, v41
    v_cvt_pk_bf16_f32 v41, v42, v43
    v_cvt_pk_bf16_f32 v42, v44, v45
    v_cvt_pk_bf16_f32 v43, v46, v47
    v_exp_f32 v49, v49
    v_exp_f32 v50, v50
    v_exp_f32 v51, v51
    v_mfma_f32_32x32x16_bf16 v[72:87], v[24:27], v[40:43], v[72:87]
    v_exp_f32 v52, v52
    v_exp_f32 v53, v53
    v_exp_f32 v54, v54
    v_exp_f32 v55, v55
    v_cvt_pk_bf16_f32 v48, v48, v49
    v_cvt_pk_bf16_f32 v49, v50, v51
    v_cvt_pk_bf16_f32 v50, v52, v53
    v_cvt_pk_bf16_f32 v51, v54, v55
    v_exp_f32 v56, v56
    v_exp_f32 v57, v57
    v_mfma_f32_32x32x16_bf16 v[72:87], v[28:31], v[48:51], v[72:87]
    v_exp_f32 v58, v58
    v_exp_f32 v59, v59
    v_exp_f32 v60, v60
    v_exp_f32 v61, v61
    s_waitcnt lgkmcnt(0)
    v_mfma_f32_32x32x16_bf16 v[40:55], v[16:19], v[8:11], 0
    ds_read_b128 v[20:23], v3 offset:43008
    s_mov_b64 exec, s[38:39]
    ds_read_b128 v[24:27], v3 offset:41984
    ds_read_b128 v[28:31], v3 offset:42240
    s_mov_b64 exec, -1
    v_exp_f32 v62, v62
    v_exp_f32 v63, v63
    v_exp_f32 v64, v64
    v_cvt_pk_bf16_f32 v56, v56, v57
    v_cvt_pk_bf16_f32 v57, v58, v59
    v_cvt_pk_bf16_f32 v58, v60, v61
    v_cvt_pk_bf16_f32 v59, v62, v63
    v_exp_f32 v65, v65
    v_exp_f32 v66, v66
    v_exp_f32 v67, v67
    v_mfma_f32_32x32x16_bf16 v[72:87], v[32:35], v[56:59], v[72:87]
    v_exp_f32 v68, v68
    v_exp_f32 v69, v69
    v_exp_f32 v70, v70
    v_exp_f32 v71, v71
    v_cvt_pk_bf16_f32 v64, v64, v65
    v_cvt_pk_bf16_f32 v65, v66, v67
    v_cvt_pk_bf16_f32 v66, v68, v69
    v_cvt_pk_bf16_f32 v67, v70, v71
    v_exp_f32 v40, v40
    v_exp_f32 v41, v41
    v_mfma_f32_32x32x16_bf16 v[72:87], v[36:39], v[64:67], v[72:87]
    v_exp_f32 v42, v42
    v_exp_f32 v43, v43
    v_exp_f32 v44, v44
    v_exp_f32 v45, v45
    s_waitcnt lgkmcnt(0)
    v_mfma_f32_32x32x16_bf16 v[56:71], v[20:23], v[8:11], 0
    ds_read_b128 v[16:19], v3 offset:45056
    s_mov_b64 exec, s[38:39]
    ds_read_b128 v[32:35], v3 offset:44032
    ds_read_b128 v[36:39], v3 offset:44288
    s_mov_b64 exec, -1
    v_exp_f32 v46, v46
    v_exp_f32 v47, v47
    v_exp_f32 v48, v48
    v_cvt_pk_bf16_f32 v40, v40, v41
    v_cvt_pk_bf16_f32 v41, v42, v43
    v_cvt_pk_bf16_f32 v42, v44, v45
    v_cvt_pk_bf16_f32 v43, v46, v47
    v_exp_f32 v49, v49
    v_exp_f32 v50, v50
    v_exp_f32 v51, v51
    v_mfma_f32_32x32x16_bf16 v[72:87], v[24:27], v[40:43], v[72:87]
    v_exp_f32 v52, v52
    v_exp_f32 v53, v53
    v_exp_f32 v54, v54
    v_exp_f32 v55, v55
    v_cvt_pk_bf16_f32 v48, v48, v49
    v_cvt_pk_bf16_f32 v49, v50, v51
    v_cvt_pk_bf16_f32 v50, v52, v53
    v_cvt_pk_bf16_f32 v51, v54, v55
    v_exp_f32 v56, v56
    v_exp_f32 v57, v57
    v_mfma_f32_32x32x16_bf16 v[72:87], v[28:31], v[48:51], v[72:87]
    v_exp_f32 v58, v58
    v_exp_f32 v59, v59
    v_exp_f32 v60, v60
    v_exp_f32 v61, v61
    s_waitcnt lgkmcnt(0)
    v_mfma_f32_32x32x16_bf16 v[40:55], v[16:19], v[8:11], 0
    ds_read_b128 v[20:23], v3 offset:47104
    s_mov_b64 exec, s[38:39]
    ds_read_b128 v[24:27], v3 offset:46080
    ds_read_b128 v[28:31], v3 offset:46336
    s_mov_b64 exec, -1
    v_exp_f32 v62, v62
    v_exp_f32 v63, v63
    v_exp_f32 v64, v64
    v_cvt_pk_bf16_f32 v56, v56, v57
    v_cvt_pk_bf16_f32 v57, v58, v59
    v_cvt_pk_bf16_f32 v58, v60, v61
    v_cvt_pk_bf16_f32 v59, v62, v63
    v_exp_f32 v65, v65
    v_exp_f32 v66, v66
    v_exp_f32 v67, v67
    v_mfma_f32_32x32x16_bf16 v[72:87], v[32:35], v[56:59], v[72:87]
    v_exp_f32 v68, v68
    v_exp_f32 v69, v69
    v_exp_f32 v70, v70
    v_exp_f32 v71, v71
    v_cvt_pk_bf16_f32 v64, v64, v65
    v_cvt_pk_bf16_f32 v65, v66, v67
    v_cvt_pk_bf16_f32 v66, v68, v69
    v_cvt_pk_bf16_f32 v67, v70, v71
    v_exp_f32 v40, v40
    v_exp_f32 v41, v41
    v_mfma_f32_32x32x16_bf16 v[72:87], v[36:39], v[64:67], v[72:87]
    v_exp_f32 v42, v42
    v_exp_f32 v43, v43
    v_exp_f32 v44, v44
    v_exp_f32 v45, v45
    s_waitcnt lgkmcnt(0)
    v_mfma_f32_32x32x16_bf16 v[56:71], v[20:23], v[8:11], 0
    ds_read_b128 v[16:19], v3 offset:49152
    s_mov_b64 exec, s[38:39]
    ds_read_b128 v[32:35], v3 offset:48128
    ds_read_b128 v[36:39], v3 offset:48384
    s_mov_b64 exec, -1
    v_exp_f32 v46, v46
    v_exp_f32 v47, v47
    v_exp_f32 v48, v48
    v_cvt_pk_bf16_f32 v40, v40, v41
    v_cvt_pk_bf16_f32 v41, v42, v43
    v_cvt_pk_bf16_f32 v42, v44, v45
    v_cvt_pk_bf16_f32 v43, v46, v47
    v_exp_f32 v49, v49
    v_exp_f32 v50, v50
    v_exp_f32 v51, v51
    v_mfma_f32_32x32x16_bf16 v[72:87], v[24:27], v[40:43], v[72:87]
    v_exp_f32 v52, v52
    v_exp_f32 v53, v53
    v_exp_f32 v54, v54
    v_exp_f32 v55, v55
    v_cvt_pk_bf16_f32 v48, v48, v49
    v_cvt_pk_bf16_f32 v49, v50, v51
    v_cvt_pk_bf16_f32 v50, v52, v53
    v_cvt_pk_bf16_f32 v51, v54, v55
    v_exp_f32 v56, v56
    v_exp_f32 v57, v57
    v_mfma_f32_32x32x16_bf16 v[72:87], v[28:31], v[48:51], v[72:87]
    v_exp_f32 v58, v58
    v_exp_f32 v59, v59
    v_exp_f32 v60, v60
    v_exp_f32 v61, v61
    s_waitcnt lgkmcnt(0)
    v_mfma_f32_32x32x16_bf16 v[40:55], v[16:19], v[8:11], 0
    ds_read_b128 v[20:23], v3 offset:51200
    s_mov_b64 exec, s[38:39]
    ds_read_b128 v[24:27], v3 offset:50176
    ds_read_b128 v[28:31], v3 offset:50432
    s_mov_b64 exec, -1
    v_exp_f32 v62, v62
    v_exp_f32 v63, v63
    v_exp_f32 v64, v64
    v_cvt_pk_bf16_f32 v56, v56, v57
    v_cvt_pk_bf16_f32 v57, v58, v59
    v_cvt_pk_bf16_f32 v58, v60, v61
    v_cvt_pk_bf16_f32 v59, v62, v63
    v_exp_f32 v65, v65
    v_exp_f32 v66, v66
    v_exp_f32 v67, v67
    v_mfma_f32_32x32x16_bf16 v[72:87], v[32:35], v[56:59], v[72:87]
    v_exp_f32 v68, v68
    v_exp_f32 v69, v69
    v_exp_f32 v70, v70
    v_exp_f32 v71, v71
    v_cvt_pk_bf16_f32 v64, v64, v65
    v_cvt_pk_bf16_f32 v65, v66, v67
    v_cvt_pk_bf16_f32 v66, v68, v69
    v_cvt_pk_bf16_f32 v67, v70, v71
    s_setprio 0
    v_exp_f32 v40, v40
    v_exp_f32 v41, v41
    v_mfma_f32_32x32x16_bf16 v[72:87], v[36:39], v[64:67], v[72:87]
    v_exp_f32 v42, v42
    v_exp_f32 v43, v43
    v_exp_f32 v44, v44
    v_exp_f32 v45, v45
    s_waitcnt lgkmcnt(0)
    v_mfma_f32_32x32x16_bf16 v[56:71], v[20:23], v[8:11], 0
    ds_read_b128 v[16:19], v3 offset:53248
    s_mov_b64 exec, s[38:39]
    ds_read_b128 v[32:35], v3 offset:52224
    ds_read_b128 v[36:39], v3 offset:52480
    s_mov_b64 exec, -1
    v_exp_f32 v46, v46
    v_exp_f32 v47, v47
    v_exp_f32 v48, v48
    v_cvt_pk_bf16_f32 v40, v40, v41
    v_cvt_pk_bf16_f32 v41, v42, v43
    v_cvt_pk_bf16_f32 v42, v44, v45
    v_cvt_pk_bf16_f32 v43, v46, v47
    v_exp_f32 v49, v49
    v_exp_f32 v50, v50
    v_exp_f32 v51, v51
    v_mfma_f32_32x32x16_bf16 v[72:87], v[24:27], v[40:43], v[72:87]
    v_exp_f32 v52, v52
    v_exp_f32 v53, v53
    v_exp_f32 v54, v54
    v_exp_f32 v55, v55
    v_cvt_pk_bf16_f32 v48, v48, v49
    v_cvt_pk_bf16_f32 v49, v50, v51
    v_cvt_pk_bf16_f32 v50, v52, v53
    v_cvt_pk_bf16_f32 v51, v54, v55
    v_exp_f32 v56, v56
    v_exp_f32 v57, v57
    v_mfma_f32_32x32x16_bf16 v[72:87], v[28:31], v[48:51], v[72:87]
    v_exp_f32 v58, v58
    v_exp_f32 v59, v59
    v_exp_f32 v60, v60
    v_exp_f32 v61, v61
    s_waitcnt lgkmcnt(0)
    v_mfma_f32_32x32x16_bf16 v[40:55], v[16:19], v[8:11], 0
    ds_read_b128 v[20:23], v3 offset:55296
    s_mov_b64 exec, s[38:39]
    ds_read_b128 v[24:27], v3 offset:54272
    ds_read_b128 v[28:31], v3 offset:54528
    s_mov_b64 exec, -1
    v_exp_f32 v62, v62
    v_exp_f32 v63, v63
    v_exp_f32 v64, v64
    v_cvt_pk_bf16_f32 v56, v56, v57
    v_cvt_pk_bf16_f32 v57, v58, v59
    v_cvt_pk_bf16_f32 v58, v60, v61
    v_cvt_pk_bf16_f32 v59, v62, v63
    v_exp_f32 v65, v65
    v_exp_f32 v66, v66
    v_exp_f32 v67, v67
    v_mfma_f32_32x32x16_bf16 v[72:87], v[32:35], v[56:59], v[72:87]
    v_exp_f32 v68, v68
    v_exp_f32 v69, v69
    v_exp_f32 v70, v70
    v_exp_f32 v71, v71
    v_cvt_pk_bf16_f32 v64, v64, v65
    v_cvt_pk_bf16_f32 v65, v66, v67
    v_cvt_pk_bf16_f32 v66, v68, v69
    v_cvt_pk_bf16_f32 v67, v70, v71
    v_exp_f32 v40, v40
    v_exp_f32 v41, v41
    v_mfma_f32_32x32x16_bf16 v[72:87], v[36:39], v[64:67], v[72:87]
    v_exp_f32 v42, v42
    v_exp_f32 v43, v43
    v_exp_f32 v44, v44
    v_exp_f32 v45, v45
    s_waitcnt lgkmcnt(0)
    v_mfma_f32_32x32x16_bf16 v[56:71], v[20:23], v[8:11], 0
    ds_read_b128 v[16:19], v3 offset:57344
    s_mov_b64 exec, s[38:39]
    ds_read_b128 v[32:35], v3 offset:56320
    ds_read_b128 v[36:39], v3 offset:56576
    s_mov_b64 exec, -1
    v_exp_f32 v46, v46
    v_exp_f32 v47, v47
    v_exp_f32 v48, v48
    v_cvt_pk_bf16_f32 v40, v40, v41
    v_cvt_pk_bf16_f32 v41, v42, v43
    v_cvt_pk_bf16_f32 v42, v44, v45
    v_cvt_pk_bf16_f32 v43, v46, v47
    v_exp_f32 v49, v49
    v_exp_f32 v50, v50
    v_exp_f32 v51, v51
    v_mfma_f32_32x32x16_bf16 v[72:87], v[24:27], v[40:43], v[72:87]
    s_lshl_b32 s26, s22, 8
    s_add_u32 s26, s26, 0x1a86000
    buffer_load_dword v90, v89, s[4:7], s26 offen
    v_exp_f32 v52, v52
    v_exp_f32 v53, v53
    v_exp_f32 v54, v54
    v_exp_f32 v55, v55
    v_cvt_pk_bf16_f32 v48, v48, v49
    v_cvt_pk_bf16_f32 v49, v50, v51
    v_cvt_pk_bf16_f32 v50, v52, v53
    v_cvt_pk_bf16_f32 v51, v54, v55
    v_exp_f32 v56, v56
    v_exp_f32 v57, v57
    v_mfma_f32_32x32x16_bf16 v[72:87], v[28:31], v[48:51], v[72:87]
    v_exp_f32 v58, v58
    v_exp_f32 v59, v59
    v_exp_f32 v60, v60
    v_exp_f32 v61, v61
    s_waitcnt lgkmcnt(0)
    v_mfma_f32_32x32x16_bf16 v[40:55], v[16:19], v[8:11], 0
    ds_read_b128 v[20:23], v3 offset:59392
    s_mov_b64 exec, s[38:39]
    ds_read_b128 v[24:27], v3 offset:58368
    ds_read_b128 v[28:31], v3 offset:58624
    s_mov_b64 exec, -1
    v_exp_f32 v62, v62
    v_exp_f32 v63, v63
    v_exp_f32 v64, v64
    v_cvt_pk_bf16_f32 v56, v56, v57
    v_cvt_pk_bf16_f32 v57, v58, v59
    v_cvt_pk_bf16_f32 v58, v60, v61
    v_cvt_pk_bf16_f32 v59, v62, v63
    v_exp_f32 v65, v65
    v_exp_f32 v66, v66
    v_exp_f32 v67, v67
    v_mfma_f32_32x32x16_bf16 v[72:87], v[32:35], v[56:59], v[72:87]
    v_exp_f32 v68, v68
    v_exp_f32 v69, v69
    v_exp_f32 v70, v70
    v_exp_f32 v71, v71
    v_cvt_pk_bf16_f32 v64, v64, v65
    v_cvt_pk_bf16_f32 v65, v66, v67
    v_cvt_pk_bf16_f32 v66, v68, v69
    v_cvt_pk_bf16_f32 v67, v70, v71
    v_exp_f32 v40, v40
    v_exp_f32 v41, v41
    v_mfma_f32_32x32x16_bf16 v[72:87], v[36:39], v[64:67], v[72:87]
    v_exp_f32 v42, v42
    v_exp_f32 v43, v43
    v_exp_f32 v44, v44
    v_exp_f32 v45, v45
    s_waitcnt lgkmcnt(0)
    v_mfma_f32_32x32x16_bf16 v[56:71], v[20:23], v[8:11], 0
    ds_read_b128 v[16:19], v3 offset:61440
    s_mov_b64 exec, s[38:39]
    ds_read_b128 v[32:35], v3 offset:60416
    ds_read_b128 v[36:39], v3 offset:60672
    s_mov_b64 exec, -1
    v_exp_f32 v46, v46
    v_exp_f32 v47, v47
    v_exp_f32 v48, v48
    v_cvt_pk_bf16_f32 v40, v40, v41
    v_cvt_pk_bf16_f32 v41, v42, v43
    v_cvt_pk_bf16_f32 v42, v44, v45
    v_cvt_pk_bf16_f32 v43, v46, v47
    v_exp_f32 v49, v49
    v_exp_f32 v50, v50
    v_exp_f32 v51, v51
    v_mfma_f32_32x32x16_bf16 v[72:87], v[24:27], v[40:43], v[72:87]
    v_exp_f32 v52, v52
    v_exp_f32 v53, v53
    v_exp_f32 v54, v54
    v_exp_f32 v55, v55
    v_cvt_pk_bf16_f32 v48, v48, v49
    v_cvt_pk_bf16_f32 v49, v50, v51
    v_cvt_pk_bf16_f32 v50, v52, v53
    v_cvt_pk_bf16_f32 v51, v54, v55
    v_exp_f32 v56, v56
    v_exp_f32 v57, v57
    v_mfma_f32_32x32x16_bf16 v[72:87], v[28:31], v[48:51], v[72:87]
    v_exp_f32 v58, v58
    v_exp_f32 v59, v59
    v_exp_f32 v60, v60
    v_exp_f32 v61, v61
    s_waitcnt lgkmcnt(0)
    v_mfma_f32_32x32x16_bf16 v[40:55], v[16:19], v[8:11], 0
    ds_read_b128 v[20:23], v3 offset:63488
    s_mov_b64 exec, s[38:39]
    ds_read_b128 v[24:27], v3 offset:62464
    ds_read_b128 v[28:31], v3 offset:62720
    s_mov_b64 exec, -1
    v_exp_f32 v62, v62
    v_exp_f32 v63, v63
    v_exp_f32 v64, v64
    v_cvt_pk_bf16_f32 v56, v56, v57
    v_cvt_pk_bf16_f32 v57, v58, v59
    v_cvt_pk_bf16_f32 v58, v60, v61
    v_cvt_pk_bf16_f32 v59, v62, v63
    v_exp_f32 v65, v65
    v_exp_f32 v66, v66
    v_exp_f32 v67, v67
    v_mfma_f32_32x32x16_bf16 v[72:87], v[32:35], v[56:59], v[72:87]
    v_exp_f32 v68, v68
    v_exp_f32 v69, v69
    v_exp_f32 v70, v70
    v_exp_f32 v71, v71
    v_cvt_pk_bf16_f32 v64, v64, v65
    v_cvt_pk_bf16_f32 v65, v66, v67
    v_cvt_pk_bf16_f32 v66, v68, v69
    v_cvt_pk_bf16_f32 v67, v70, v71
    v_exp_f32 v40, v40
    v_exp_f32 v41, v41
    v_mfma_f32_32x32x16_bf16 v[72:87], v[36:39], v[64:67], v[72:87]
    v_exp_f32 v42, v42
    v_exp_f32 v43, v43
    v_exp_f32 v44, v44
    v_exp_f32 v45, v45
    s_waitcnt lgkmcnt(0)
    v_mfma_f32_32x32x16_bf16 v[56:71], v[20:23], v[8:11], 0
    s_mov_b64 exec, s[38:39]
    ds_read_b128 v[32:35], v3 offset:64512
    ds_read_b128 v[36:39], v3 offset:64768
    s_mov_b64 exec, -1
    v_exp_f32 v46, v46
    v_exp_f32 v47, v47
    v_exp_f32 v48, v48
    v_cvt_pk_bf16_f32 v40, v40, v41
    v_cvt_pk_bf16_f32 v41, v42, v43
    v_cvt_pk_bf16_f32 v42, v44, v45
    v_cvt_pk_bf16_f32 v43, v46, v47
    v_exp_f32 v49, v49
    v_exp_f32 v50, v50
    v_exp_f32 v51, v51
    v_mfma_f32_32x32x16_bf16 v[72:87], v[24:27], v[40:43], v[72:87]
    v_exp_f32 v52, v52
    v_exp_f32 v53, v53
    v_exp_f32 v54, v54
    v_exp_f32 v55, v55
    v_cvt_pk_bf16_f32 v48, v48, v49
    v_cvt_pk_bf16_f32 v49, v50, v51
    v_cvt_pk_bf16_f32 v50, v52, v53
    v_cvt_pk_bf16_f32 v51, v54, v55
    v_exp_f32 v56, v56
    v_exp_f32 v57, v57
    v_mfma_f32_32x32x16_bf16 v[72:87], v[28:31], v[48:51], v[72:87]
    v_exp_f32 v58, v58
    v_exp_f32 v59, v59
    v_exp_f32 v60, v60
    v_exp_f32 v61, v61
    s_waitcnt lgkmcnt(0)
    v_exp_f32 v62, v62
    v_exp_f32 v63, v63
    v_exp_f32 v64, v64
    v_cvt_pk_bf16_f32 v56, v56, v57
    v_cvt_pk_bf16_f32 v57, v58, v59
    v_cvt_pk_bf16_f32 v58, v60, v61
    v_cvt_pk_bf16_f32 v59, v62, v63
    v_exp_f32 v65, v65
    v_exp_f32 v66, v66
    v_exp_f32 v67, v67
    v_mfma_f32_32x32x16_bf16 v[72:87], v[32:35], v[56:59], v[72:87]
    v_exp_f32 v68, v68
    v_exp_f32 v69, v69
    v_exp_f32 v70, v70
    v_exp_f32 v71, v71
    v_cvt_pk_bf16_f32 v64, v64, v65
    v_cvt_pk_bf16_f32 v65, v66, v67
    v_cvt_pk_bf16_f32 v66, v68, v69
    v_cvt_pk_bf16_f32 v67, v70, v71
    s_nop 1
    v_mfma_f32_32x32x16_bf16 v[72:87], v[36:39], v[64:67], v[72:87]
    s_branch L_adone_77
L_slow_76:
    s_setprio 0
    s_add_u32 s50, s50, 0x1000
    s_and_b32 s50, s50, 0x7fff
    s_add_u32 s51, s51, 0x4000
    s_add_u32 s52, s50, s56
    s_mov_b32 m0, s51
    s_nop 0
    buffer_load_dwordx4 v0, s[4:7], s52 offen offset:0 lds
    buffer_load_dwordx4 v0, s[4:7], s52 offen offset:1024 lds
    s_add_u32 s50, s50, 0x1000
    s_and_b32 s50, s50, 0x7fff
    s_add_u32 s51, s51, 0x4000
    s_add_u32 s52, s50, s56
    s_mov_b32 m0, s51
    s_nop 0
    buffer_load_dwordx4 v0, s[4:7], s52 offen offset:0 lds
    buffer_load_dwordx4 v0, s[4:7], s52 offen offset:1024 lds
    s_add_u32 s50, s50, 0x1000
    s_and_b32 s50, s50, 0x7fff
    s_add_u32 s51, s51, 0x4000
    s_add_u32 s52, s50, s56
    s_mov_b32 m0, s51
    s_nop 0
    buffer_load_dwordx4 v0, s[4:7], s52 offen offset:0 lds
    buffer_load_dwordx4 v0, s[4:7], s52 offen offset:1024 lds
    s_add_u32 s50, s50, 0x1000
    s_and_b32 s50, s50, 0x7fff
    s_add_u32 s51, s51, 0x4000
    s_add_u32 s52, s50, s56
    s_mov_b32 m0, s51
    s_nop 0
    buffer_load_dwordx4 v0, s[4:7], s52 offen offset:0 lds
    buffer_load_dwordx4 v0, s[4:7], s52 offen offset:1024 lds
    s_add_u32 s50, s50, 0x1000
    s_and_b32 s50, s50, 0x7fff
    s_add_u32 s51, s51, 0x4000
    s_add_u32 s52, s50, s56
    s_mov_b32 m0, s51
    s_nop 0
    buffer_load_dwordx4 v0, s[4:7], s52 offen offset:0 lds
    buffer_load_dwordx4 v0, s[4:7], s52 offen offset:1024 lds
    s_add_u32 s50, s50, 0x1000
    s_and_b32 s50, s50, 0x7fff
    s_add_u32 s51, s51, 0x4000
    s_add_u32 s52, s50, s56
    s_mov_b32 m0, s51
    s_nop 0
    buffer_load_dwordx4 v0, s[4:7], s52 offen offset:0 lds
    buffer_load_dwordx4 v0, s[4:7], s52 offen offset:1024 lds
    s_add_u32 s26, s26, 4096
    buffer_load_dwordx4 v[128:131], v0, s[4:7], s26 offen offset:0
    buffer_load_dwordx4 v[132:135], v0, s[4:7], s26 offen offset:1024
    buffer_load_dwordx4 v[136:139], v0, s[4:7], s26 offen offset:2048
    buffer_load_dwordx4 v[140:143], v0, s[4:7], s26 offen offset:3072
    s_add_u32 s26, s26, 4096
    buffer_load_dwordx4 v[144:147], v0, s[4:7], s26 offen offset:0
    buffer_load_dwordx4 v[148:151], v0, s[4:7], s26 offen offset:1024
    buffer_load_dwordx4 v[152:155], v0, s[4:7], s26 offen offset:2048
    buffer_load_dwordx4 v[156:159], v0, s[4:7], s26 offen offset:3072
    s_lshl_b32 s28, s32, 15
    s_add_u32 s28, s28, 0x100000
    buffer_load_dwordx4 v[160:163], v0, s[4:7], s28 offen offset:0
    buffer_load_dwordx4 v[164:167], v0, s[4:7], s28 offen offset:1024
    buffer_load_dwordx4 v[224:227], v0, s[4:7], s28 offen offset:2048
    buffer_load_dwordx4 v[228:231], v0, s[4:7], s28 offen offset:3072
    s_add_u32 s28, s28, 4096
    buffer_load_dwordx4 v[168:171], v0, s[4:7], s28 offen offset:0
    buffer_load_dwordx4 v[172:175], v0, s[4:7], s28 offen offset:1024
    buffer_load_dwordx4 v[232:235], v0, s[4:7], s28 offen offset:2048
    buffer_load_dwordx4 v[236:239], v0, s[4:7], s28 offen offset:3072
    s_add_u32 s28, s28, 4096
    buffer_load_dwordx4 v[176:179], v0, s[4:7], s28 offen offset:0
    buffer_load_dwordx4 v[180:183], v0, s[4:7], s28 offen offset:1024
    buffer_load_dwordx4 v[240:243], v0, s[4:7], s28 offen offset:2048
    buffer_load_dwordx4 v[244:247], v0, s[4:7], s28 offen offset:3072
    s_add_u32 s28, s28, 4096
    buffer_load_dwordx4 v[184:187], v0, s[4:7], s28 offen offset:0
    buffer_load_dwordx4 v[188:191], v0, s[4:7], s28 offen offset:1024
    buffer_load_dwordx4 v[248:251], v0, s[4:7], s28 offen offset:2048
    buffer_load_dwordx4 v[252:255], v0, s[4:7], s28 offen offset:3072
    s_add_u32 s28, s28, 4096
    buffer_load_dwordx4 v[192:195], v0, s[4:7], s28 offen offset:0
    buffer_load_dwordx4 v[196:199], v0, s[4:7], s28 offen offset:1024
    s_add_u32 s28, s28, 4096
    buffer_load_dwordx4 v[200:203], v0, s[4:7], s28 offen offset:0
    buffer_load_dwordx4 v[204:207], v0, s[4:7], s28 offen offset:1024
    s_add_u32 s28, s28, 4096
    buffer_load_dwordx4 v[208:211], v0, s[4:7], s28 offen offset:0
    buffer_load_dwordx4 v[212:215], v0, s[4:7], s28 offen offset:1024
    s_add_u32 s28, s28, 4096
    buffer_load_dwordx4 v[216:219], v0, s[4:7], s28 offen offset:0
    buffer_load_dwordx4 v[220:223], v0, s[4:7], s28 offen offset:1024
    s_mul_i32 s27, s22, 176128
    s_add_u32 s27, s27, 0x1000000
    s_lshl_b32 s26, s32, 11
    s_add_u32 s26, s26, s27
    buffer_load_dword v90, v91, s[4:7], s26 offen
    s_add_u32 s26, s26, 88064
    buffer_load_dword v90, v91, s[4:7], s26 offen
    s_add_u32 s26, s34, 0x600000
    buffer_load_dword v90, v0, s[4:7], s26 offen
    s_andn2_b32 s26, s31, 0x3ff
    s_add_u32 s26, s26, 0x1a00000
    buffer_load_dword v90, v0, s[4:7], s26 offen
    s_lshl_b32 s26, s22, 8
    s_add_u32 s26, s26, 0x1a86000
    buffer_load_dword v90, v89, s[4:7], s26 offen
    s_waitcnt vmcnt(0) lgkmcnt(0)
    s_barrier
    s_barrier
    v_mov_b32 v72, 0
    v_mov_b32 v73, 0
    v_mov_b32 v74, 0
    v_mov_b32 v75, 0
    v_mov_b32 v76, 0
    v_mov_b32 v77, 0
    v_mov_b32 v78, 0
    v_mov_b32 v79, 0
    v_mov_b32 v80, 0
    v_mov_b32 v81, 0
    v_mov_b32 v82, 0
    v_mov_b32 v83, 0
    v_mov_b32 v84, 0
    v_mov_b32 v85, 0
    v_mov_b32 v86, 0
    v_mov_b32 v87, 0
    v_mov_b32 v4, 0xff800000
    s_mov_b32 s36, 0
L_sloop_89:
    ds_read_b128 v[16:19], v2 offset:0
    s_mov_b64 exec, s[38:39]
    ds_read_b128 v[24:27], v2 offset:1024
    ds_read_b128 v[28:31], v2 offset:1280
    s_mov_b64 exec, -1
    s_waitcnt lgkmcnt(0)
    v_mfma_f32_32x32x16_bf16 v[40:55], v[16:19], v[8:11], 0
    s_nop 15
    v_max_f32 v5, v40, v41
    v_max_f32 v5, v5, v42
    v_max_f32 v5, v5, v43
    v_max_f32 v5, v5, v44
    v_max_f32 v5, v5, v45
    v_max_f32 v5, v5, v46
    v_max_f32 v5, v5, v47
    v_max_f32 v5, v5, v48
    v_max_f32 v5, v5, v49
    v_max_f32 v5, v5, v50
    v_max_f32 v5, v5, v51
    v_max_f32 v5, v5, v52
    v_max_f32 v5, v5, v53
    v_max_f32 v5, v5, v54
    v_max_f32 v5, v5, v55
    v_mov_b32 v6, v5
    s_nop 1
    v_permlane32_swap_b32 v5, v6
    s_nop 1
    v_max3_f32 v5, v5, v6, v4
    v_sub_f32 v6, v4, v5
    v_exp_f32 v6, v6
    v_mov_b32 v4, v5
    v_sub_f32 v40, v40, v5
    v_sub_f32 v41, v41, v5
    v_sub_f32 v42, v42, v5
    v_sub_f32 v43, v43, v5
    v_sub_f32 v44, v44, v5
    v_sub_f32 v45, v45, v5
    v_sub_f32 v46, v46, v5
    v_sub_f32 v47, v47, v5
    v_sub_f32 v48, v48, v5
    v_sub_f32 v49, v49, v5
    v_sub_f32 v50, v50, v5
    v_sub_f32 v51, v51, v5
    v_sub_f32 v52, v52, v5
    v_sub_f32 v53, v53, v5
    v_sub_f32 v54, v54, v5
    v_sub_f32 v55, v55, v5
    v_mul_f32 v72, v72, v6
    v_mul_f32 v73, v73, v6
    v_mul_f32 v74, v74, v6
    v_mul_f32 v75, v75, v6
    v_mul_f32 v76, v76, v6
    v_mul_f32 v77, v77, v6
    v_mul_f32 v78, v78, v6
    v_mul_f32 v79, v79, v6
    v_mul_f32 v80, v80, v6
    v_mul_f32 v81, v81, v6
    v_mul_f32 v82, v82, v6
    v_mul_f32 v83, v83, v6
    v_mul_f32 v84, v84, v6
    v_mul_f32 v85, v85, v6
    v_mul_f32 v86, v86, v6
    v_mul_f32 v87, v87, v6
    v_exp_f32 v40, v40
    v_exp_f32 v41, v41
    v_exp_f32 v42, v42
    v_exp_f32 v43, v43
    v_exp_f32 v44, v44
    v_exp_f32 v45, v45
    v_exp_f32 v46, v46
    v_exp_f32 v47, v47
    v_exp_f32 v48, v48
    v_exp_f32 v49, v49
    v_exp_f32 v50, v50
    v_exp_f32 v51, v51
    v_exp_f32 v52, v52
    v_exp_f32 v53, v53
    v_exp_f32 v54, v54
    v_exp_f32 v55, v55
    s_nop 0
    v_cvt_pk_bf16_f32 v56, v40, v41
    v_cvt_pk_bf16_f32 v57, v42, v43
    v_cvt_pk_bf16_f32 v58, v44, v45
    v_cvt_pk_bf16_f32 v59, v46, v47
    v_cvt_pk_bf16_f32 v60, v48, v49
    v_cvt_pk_bf16_f32 v61, v50, v51
    v_cvt_pk_bf16_f32 v62, v52, v53
    v_cvt_pk_bf16_f32 v63, v54, v55
    s_nop 1
    v_mfma_f32_32x32x16_bf16 v[72:87], v[24:27], v[56:59], v[72:87]
    v_mfma_f32_32x32x16_bf16 v[72:87], v[28:31], v[60:63], v[72:87]
    s_nop 15
    v_add_u32 v2, 0x800, v2
    s_add_u32 s36, s36, 1
    s_cmp_lg_u32 s36, 64
    s_cbranch_scc1 L_sloop_89
L_adone_77:
    s_nop 11
    v_rcp_f32 v4, v80
    s_nop 0
    v_mul_f32 v72, v72, v4
    v_mul_f32 v73, v73, v4
    v_mul_f32 v74, v74, v4
    v_mul_f32 v75, v75, v4
    v_mul_f32 v76, v76, v4
    v_mul_f32 v77, v77, v4
    v_mul_f32 v78, v78, v4
    v_mul_f32 v79, v79, v4
    v_cvt_pk_bf16_f32 v16, v72, v73
    v_cvt_pk_bf16_f32 v17, v74, v75
    v_cvt_pk_bf16_f32 v18, v76, v77
    v_cvt_pk_bf16_f32 v19, v78, v79
    s_add_u32 s26, s34, 0x400000
    s_cmp_lg_u32 s37, 0
    s_cbranch_scc1 L_hs_90
    buffer_store_dwordx4 v[16:19], v0, s[4:7], s26 offen sc1
    s_branch L_hsd_91
L_hs_90:
    buffer_store_dwordx4 v[16:19], v0, s[4:7], s26 offen
L_hsd_91:
    s_lshl_b32 s26, s22, 8
    s_lshl_b32 s27, s21, 5
    s_add_u32 s26, s26, s27
    s_lshl_b32 s27, s20, 2
    s_add_u32 s26, s26, s27
    s_add_u32 s26, s26, 0x1a84000
    v_mov_b32 v2, 1
    s_mov_b64 exec, 1
    s_waitcnt vmcnt(0)
    s_cmp_lg_u32 s37, 0
    s_cbranch_scc1 L_hs_92
    buffer_store_dword v2, off, s[4:7], s26 sc1
    s_branch L_hsd_93
L_hs_92:
    buffer_store_dword v2, off, s[4:7], s26
L_hsd_93:
    s_mov_b64 exec, -1
    s_lshl_b32 s44, s32, 15
    s_add_u32 s44, s44, 0x100000
    s_cmp_ge_u32 s20, 0
    s_cbranch_scc1 L_w1l_94
    s_add_u32 s44, s44, 16384
    buffer_load_dwordx4 v[64:67], v0, s[4:7], s44 offen offset:2048
    buffer_load_dwordx4 v[68:71], v0, s[4:7], s44 offen offset:3072
    s_add_u32 s44, s44, 4096
    buffer_load_dwordx4 v[72:75], v0, s[4:7], s44 offen offset:2048
    buffer_load_dwordx4 v[76:79], v0, s[4:7], s44 offen offset:3072
    s_add_u32 s44, s44, 4096
    buffer_load_dwordx4 v[80:83], v0, s[4:7], s44 offen offset:2048
    buffer_load_dwordx4 v[84:87], v0, s[4:7], s44 offen offset:3072
    s_add_u32 s44, s44, 4096
    buffer_load_dwordx4 v[88:91], v0, s[4:7], s44 offen offset:2048
    buffer_load_dwordx4 v[92:95], v0, s[4:7], s44 offen offset:3072
L_w1l_94:
    s_barrier
    s_lshl_b32 s26, s22, 8
    s_lshl_b32 s27, s20, 5
    s_add_u32 s26, s26, s27
    s_add_u32 s26, s26, 0x1a84000
    v_lshrrev_b32 v3, 2, v0
    v_and_b32 v3, 28, v3
    s_mov_b32 s36, 200000
L_poll_95:
    buffer_load_dword v2, v3, s[4:7], s26 offen sc1
    s_waitcnt vmcnt(0)
    v_cmp_eq_u32 vcc, 1, v2
    s_cmp_eq_u64 vcc, exec
    s_cbranch_scc1 L_polld_96
    s_sub_u32 s36, s36, 1
    s_cmp_lg_u32 s36, 0
    s_cbranch_scc1 L_poll_95
L_polld_96:
    s_lshl_b32 s26, s22, 16
    s_lshl_b32 s27, s20, 12
    s_add_u32 s26, s26, s27
    s_add_u32 s26, s26, 0x400000
    s_add_u32 s27, s27, 0x0
    s_add_u32 s28, s26, 0x8000
    s_add_u32 s29, s27, 0x8000
    s_mov_b32 m0, s27
    s_nop 0
    buffer_load_dwordx4 v0, s[4:7], s26 offen offset:0 sc1 lds
    buffer_load_dwordx4 v0, s[4:7], s26 offen offset:1024 sc1 lds
    s_mov_b32 m0, s29
    s_nop 0
    buffer_load_dwordx4 v0, s[4:7], s28 offen offset:0 sc1 lds
    buffer_load_dwordx4 v0, s[4:7], s28 offen offset:1024 sc1 lds
    s_mov_b32 m0, s27
    s_nop 0
    buffer_load_dwordx4 v0, s[4:7], s26 offen offset:2048 sc1 lds
    buffer_load_dwordx4 v0, s[4:7], s26 offen offset:3072 sc1 lds
    s_mov_b32 m0, s29
    s_nop 0
    buffer_load_dwordx4 v0, s[4:7], s28 offen offset:2048 sc1 lds
    buffer_load_dwordx4 v0, s[4:7], s28 offen offset:3072 sc1 lds
    s_waitcnt vmcnt(4) lgkmcnt(0)
    s_barrier
    s_lshl_b32 s26, s23, 15
    s_lshl_b32 s27, s25, 14
    s_add_u32 s26, s26, s27
    s_add_u32 s26, s26, 0x0
    v_add_u32 v2, s26, v0
    ds_read_b128 v[32:35], v2 offset:0
    ds_read_b128 v[36:39], v2 offset:1024
    ds_read_b128 v[40:43], v2 offset:4096
    ds_read_b128 v[44:47], v2 offset:5120
    ds_read_b128 v[48:51], v2 offset:8192
    ds_read_b128 v[52:55], v2 offset:9216
    ds_read_b128 v[56:59], v2 offset:12288
    ds_read_b128 v[60:63], v2 offset:13312
    s_waitcnt lgkmcnt(7)
    v_mfma_f32_32x32x16_bf16 v[16:31], v[96:99], v[32:35], 0
    s_waitcnt lgkmcnt(6)
    v_mfma_f32_32x32x16_bf16 v[16:31], v[100:103], v[36:39], v[16:31]
    s_waitcnt lgkmcnt(5)
    v_mfma_f32_32x32x16_bf16 v[16:31], v[112:115], v[40:43], v[16:31]
    s_waitcnt lgkmcnt(4)
    v_mfma_f32_32x32x16_bf16 v[16:31], v[116:119], v[44:47], v[16:31]
    s_waitcnt lgkmcnt(3)
    v_mfma_f32_32x32x16_bf16 v[16:31], v[128:131], v[48:51], v[16:31]
    s_waitcnt vmcnt(0)
    s_barrier
    ds_read_b128 v[32:35], v2 offset:2048
    ds_read_b128 v[36:39], v2 offset:3072
    ds_read_b128 v[40:43], v2 offset:6144
    ds_read_b128 v[44:47], v2 offset:7168
    ds_read_b128 v[48:51], v2 offset:10240
    s_cmp_lt_u32 s20, 0
    s_cbranch_scc1 L_w1h_97
    s_add_u32 s44, s44, 16384
    buffer_load_dwordx4 v[64:67], v0, s[4:7], s44 offen offset:2048
    buffer_load_dwordx4 v[68:71], v0, s[4:7], s44 offen offset:3072
    s_add_u32 s44, s44, 4096
    buffer_load_dwordx4 v[72:75], v0, s[4:7], s44 offen offset:2048
    buffer_load_dwordx4 v[76:79], v0, s[4:7], s44 offen offset:3072
    s_add_u32 s44, s44, 4096
    buffer_load_dwordx4 v[80:83], v0, s[4:7], s44 offen offset:2048
    buffer_load_dwordx4 v[84:87], v0, s[4:7], s44 offen offset:3072
    s_add_u32 s44, s44, 4096
    buffer_load_dwordx4 v[88:91], v0, s[4:7], s44 offen offset:2048
    buffer_load_dwordx4 v[92:95], v0, s[4:7], s44 offen offset:3072
L_w1h_97:
    s_waitcnt lgkmcnt(7)
    v_mfma_f32_32x32x16_bf16 v[16:31], v[132:135], v[52:55], v[16:31]
    ds_read_b128 v[52:55], v2 offset:11264
    s_waitcnt lgkmcnt(7)
    v_mfma_f32_32x32x16_bf16 v[16:31], v[144:147], v[56:59], v[16:31]
    ds_read_b128 v[56:59], v2 offset:14336
    s_waitcnt lgkmcnt(7)
    v_mfma_f32_32x32x16_bf16 v[16:31], v[148:151], v[60:63], v[16:31]
    ds_read_b128 v[60:63], v2 offset:15360
    s_waitcnt lgkmcnt(7)
    v_mfma_f32_32x32x16_bf16 v[16:31], v[104:107], v[32:35], v[16:31]
    s_waitcnt lgkmcnt(6)
    v_mfma_f32_32x32x16_bf16 v[16:31], v[108:111], v[36:39], v[16:31]
    s_waitcnt lgkmcnt(5)
    v_mfma_f32_32x32x16_bf16 v[16:31], v[120:123], v[40:43], v[16:31]
    s_waitcnt lgkmcnt(4)
    v_mfma_f32_32x32x16_bf16 v[16:31], v[124:127], v[44:47], v[16:31]
    s_waitcnt lgkmcnt(3)
    v_mfma_f32_32x32x16_bf16 v[16:31], v[136:139], v[48:51], v[16:31]
    s_waitcnt lgkmcnt(2)
    v_mfma_f32_32x32x16_bf16 v[16:31], v[140:143], v[52:55], v[16:31]
    s_waitcnt lgkmcnt(1)
    v_mfma_f32_32x32x16_bf16 v[16:31], v[152:155], v[56:59], v[16:31]
    s_waitcnt lgkmcnt(0)
    v_mfma_f32_32x32x16_bf16 v[16:31], v[156:159], v[60:63], v[16:31]
    s_lshl_b32 s26, s20, 11
    s_add_u32 s26, s26, 0x20000
    v_add_u32 v2, s26, v0
    v_xor_b32 v3, 0x2000, v2
    s_nop 7
    s_cmp_eq_u32 s25, 0
    s_cbranch_scc1 L_kh_98
    ds_write_b128 v2, v[16:19]
    ds_write_b128 v2, v[20:23] offset:1024
    s_nop 1
    v_mov_b32 v16, v24
    v_mov_b32 v17, v25
    v_mov_b32 v18, v26
    v_mov_b32 v19, v27
    v_mov_b32 v20, v28
    v_mov_b32 v21, v29
    v_mov_b32 v22, v30
    v_mov_b32 v23, v31
    s_branch L_khd_99
L_kh_98:
    ds_write_b128 v2, v[24:27]
    ds_write_b128 v2, v[28:31] offset:1024
L_khd_99:
    s_waitcnt lgkmcnt(0)
    s_barrier
    ds_read_b128 v[24:27], v3
    ds_read_b128 v[28:31], v3 offset:1024
    s_waitcnt lgkmcnt(0)
    v_pk_add_f32 v[16:17], v[16:17], v[24:25]
    v_pk_add_f32 v[18:19], v[18:19], v[26:27]
    v_pk_add_f32 v[20:21], v[20:21], v[28:29]
    v_pk_add_f32 v[22:23], v[22:23], v[30:31]
    s_lshl_b32 s26, s20, 9
    s_add_u32 s26, s26, 0x27000
    v_add_u32 v6, s26, v1
    ds_read_b128 v[128:131], v6 offset:0
    ds_read_b128 v[132:135], v6 offset:32
    ds_read_b128 v[136:139], v6 offset:64
    ds_read_b128 v[140:143], v6 offset:96
    ds_read_b128 v[144:147], v6 offset:128
    ds_read_b128 v[148:151], v6 offset:160
    ds_read_b128 v[152:155], v6 offset:192
    ds_read_b128 v[156:159], v6 offset:224
    v_lshlrev_b32 v2, 16, v12
    v_and_b32 v3, 0xffff0000, v12
    v_add_f32 v16, v16, v2
    v_add_f32 v17, v17, v3
    v_lshlrev_b32 v2, 16, v13
    v_and_b32 v3, 0xffff0000, v13
    v_add_f32 v18, v18, v2
    v_add_f32 v19, v19, v3
    v_lshlrev_b32 v2, 16, v14
    v_and_b32 v3, 0xffff0000, v14
    v_add_f32 v20, v20, v2
    v_add_f32 v21, v21, v3
    v_lshlrev_b32 v2, 16, v15
    v_and_b32 v3, 0xffff0000, v15
    v_add_f32 v22, v22, v2
    v_add_f32 v23, v23, v3
    v_cvt_pk_bf16_f32 v12, v16, v17
    v_cvt_pk_bf16_f32 v13, v18, v19
    v_cvt_pk_bf16_f32 v14, v20, v21
    v_cvt_pk_bf16_f32 v15, v22, v23
    s_add_u32 s26, s34, 0x600000
    s_cmp_lg_u32 s37, 0
    s_cbranch_scc1 L_hs_100
    buffer_store_dwordx4 v[12:15], v0, s[4:7], s26 offen sc1
    s_branch L_hsd_101
L_hs_100:
    buffer_store_dwordx4 v[12:15], v0, s[4:7], s26 offen
L_hsd_101:
    v_pk_mul_f32 v[4:5], v[16:17], v[16:17]
    v_pk_add_f32 v[2:3], v[16:17], v[18:19]
    v_pk_fma_f32 v[4:5], v[18:19], v[18:19], v[4:5]
    v_pk_fma_f32 v[4:5], v[20:21], v[20:21], v[4:5]
    v_pk_fma_f32 v[4:5], v[22:23], v[22:23], v[4:5]
    v_pk_add_f32 v[2:3], v[2:3], v[20:21]
    v_pk_add_f32 v[2:3], v[2:3], v[22:23]
    v_add_f32 v2, v2, v3
    v_add_f32 v3, v4, v5
    v_mov_b32 v4, v2
    s_nop 1
    v_permlane32_swap_b32 v2, v4
    s_nop 1
    v_add_f32 v2, v2, v4
    v_mov_b32 v4, v3
    s_nop 1
    v_permlane32_swap_b32 v3, v4
    s_nop 1
    v_add_f32 v3, v3, v4
    v_or_b32 v3, 0x80000000, v3
    s_add_u32 s26, s31, 0x1a00000
    v_lshlrev_b32 v4, 1, v0
    s_mov_b64 exec, 0xffffffff
    s_waitcnt vmcnt(0)
    s_cmp_lg_u32 s37, 0
    s_cbranch_scc1 L_hs_102
    buffer_store_dwordx2 v[2:3], v4, s[4:7], s26 offen sc1
    s_branch L_hsd_103
L_hs_102:
    buffer_store_dwordx2 v[2:3], v4, s[4:7], s26 offen
L_hsd_103:
    s_mov_b64 exec, -1
    s_lshl_b32 s26, s22, 14
    s_lshl_b32 s27, s20, 11
    s_add_u32 s26, s26, s27
    s_add_u32 s26, s26, 0x1a00000
    v_lshlrev_b32 v3, 1, v0
    s_mov_b32 s36, 200000
L_poll_104:
    buffer_load_dwordx4 v[16:19], v3, s[4:7], s26 offen offset:0 sc1
    buffer_load_dwordx4 v[20:23], v3, s[4:7], s26 offen offset:16 sc1
    s_waitcnt vmcnt(0)
    v_and_b32 v2, v17, v19
    v_and_b32 v4, v21, v23
    v_and_b32 v2, v2, v4
    v_cmp_gt_i32 vcc, 0, v2
    s_cmp_eq_u64 vcc, exec
    s_cbranch_scc1 L_polld_105
    s_sub_u32 s36, s36, 1
    s_cmp_lg_u32 s36, 0
    s_cbranch_scc1 L_poll_104
L_polld_105:
    s_lshl_b32 s26, s22, 16
    s_lshl_b32 s27, s20, 12
    s_add_u32 s26, s26, s27
    s_add_u32 s26, s26, 0x600000
    s_add_u32 s27, s27, 0x0
    s_add_u32 s28, s26, 0x8000
    s_add_u32 s29, s27, 0x8000
    s_mov_b32 m0, s27
    s_nop 0
    buffer_load_dwordx4 v0, s[4:7], s26 offen offset:0 sc1 lds
    buffer_load_dwordx4 v0, s[4:7], s26 offen offset:1024 sc1 lds
    s_mov_b32 m0, s29
    s_nop 0
    buffer_load_dwordx4 v0, s[4:7], s28 offen offset:0 sc1 lds
    buffer_load_dwordx4 v0, s[4:7], s28 offen offset:1024 sc1 lds
    s_mov_b32 m0, s27
    s_nop 0
    buffer_load_dwordx4 v0, s[4:7], s26 offen offset:2048 sc1 lds
    buffer_load_dwordx4 v0, s[4:7], s26 offen offset:3072 sc1 lds
    s_mov_b32 m0, s29
    s_nop 0
    buffer_load_dwordx4 v0, s[4:7], s28 offen offset:2048 sc1 lds
    buffer_load_dwordx4 v0, s[4:7], s28 offen offset:3072 sc1 lds
    v_pk_add_f32 v[16:17], v[16:17], v[18:19]
    v_pk_add_f32 v[20:21], v[20:21], v[22:23]
    s_lshl_b32 s28, s20, 9
    s_add_u32 s28, s28, 0x24000
    v_lshrrev_b32 v3, 1, v0
    v_add_u32 v3, s28, v3
    v_pk_add_f32 v[16:17], v[16:17], v[20:21]
    ds_write_b64 v3, v[16:17]
    s_mul_i32 s44, s21, 172
    s_lshl_b32 s45, s33, 1
    s_add_u32 s44, s44, s45
    s_lshl_b32 s44, s44, 10
    s_add_u32 s44, s44, 0x260000
    s_add_u32 s45, s44, 88064
    s_waitcnt vmcnt(4) lgkmcnt(0)
    s_barrier
    s_cmp_ge_u32 s20, 4
    s_cbranch_scc1 L_f1hi_106
    v_add_u32 v2, 0x0, v0
    ds_read_b128 v[48:51], v2 offset:0
    ds_read_b128 v[52:55], v2 offset:32768
    ds_read_b128 v[56:59], v2 offset:1024
    ds_read_b128 v[60:63], v2 offset:33792
    ds_read_b128 v[96:99], v2 offset:4096
    ds_read_b128 v[100:103], v2 offset:36864
    ds_read_b128 v[104:107], v2 offset:5120
    ds_read_b128 v[108:111], v2 offset:37888
    s_waitcnt lgkmcnt(6)
    v_mfma_f32_32x32x16_bf16 v[16:31], v[160:163], v[48:51], 0
    v_mfma_f32_32x32x16_bf16 v[32:47], v[160:163], v[52:55], 0
    ds_read_b128 v[48:51], v2 offset:8192
    ds_read_b128 v[52:55], v2 offset:40960
    buffer_load_dwordx4 v[112:115], v0, s[4:7], s44 offen offset:0
    s_waitcnt lgkmcnt(6)
    v_mfma_f32_32x32x16_bf16 v[16:31], v[164:167], v[56:59], v[16:31]
    v_mfma_f32_32x32x16_bf16 v[32:47], v[164:167], v[60:63], v[32:47]
    ds_read_b128 v[56:59], v2 offset:9216
    ds_read_b128 v[60:63], v2 offset:41984
    buffer_load_dwordx4 v[116:119], v0, s[4:7], s45 offen offset:0
    s_waitcnt lgkmcnt(6)
    v_mfma_f32_32x32x16_bf16 v[16:31], v[168:171], v[96:99], v[16:31]
    v_mfma_f32_32x32x16_bf16 v[32:47], v[168:171], v[100:103], v[32:47]
    ds_read_b128 v[96:99], v2 offset:12288
    ds_read_b128 v[100:103], v2 offset:45056
    buffer_load_dwordx4 v[120:123], v0, s[4:7], s44 offen offset:1024
    s_waitcnt lgkmcnt(6)
    v_mfma_f32_32x32x16_bf16 v[16:31], v[172:175], v[104:107], v[16:31]
    v_mfma_f32_32x32x16_bf16 v[32:47], v[172:175], v[108:111], v[32:47]
    ds_read_b128 v[104:107], v2 offset:13312
    ds_read_b128 v[108:111], v2 offset:46080
    buffer_load_dwordx4 v[124:127], v0, s[4:7], s45 offen offset:1024
    s_waitcnt lgkmcnt(6)
    v_mfma_f32_32x32x16_bf16 v[16:31], v[176:179], v[48:51], v[16:31]
    v_mfma_f32_32x32x16_bf16 v[32:47], v[176:179], v[52:55], v[32:47]
    ds_read_b128 v[48:51], v2 offset:16384
    ds_read_b128 v[52:55], v2 offset:49152
    buffer_load_dwordx4 v[160:163], v0, s[4:7], s44 offen offset:2048
    s_waitcnt lgkmcnt(6)
    v_mfma_f32_32x32x16_bf16 v[16:31], v[180:183], v[56:59], v[16:31]
    v_mfma_f32_32x32x16_bf16 v[32:47], v[180:183], v[60:63], v[32:47]
    ds_read_b128 v[56:59], v2 offset:17408
    ds_read_b128 v[60:63], v2 offset:50176
    buffer_load_dwordx4 v[164:167], v0, s[4:7], s45 offen offset:2048
    s_waitcnt lgkmcnt(6)
    v_mfma_f32_32x32x16_bf16 v[16:31], v[184:187], v[96:99], v[16:31]
    v_mfma_f32_32x32x16_bf16 v[32:47], v[184:187], v[100:103], v[32:47]
    ds_read_b128 v[96:99], v2 offset:20480
    ds_read_b128 v[100:103], v2 offset:53248
    buffer_load_dwordx4 v[168:171], v0, s[4:7], s44 offen offset:3072
    s_waitcnt lgkmcnt(6)
    v_mfma_f32_32x32x16_bf16 v[16:31], v[188:191], v[104:107], v[16:31]
    v_mfma_f32_32x32x16_bf16 v[32:47], v[188:191], v[108:111], v[32:47]
    ds_read_b128 v[104:107], v2 offset:21504
    ds_read_b128 v[108:111], v2 offset:54272
    buffer_load_dwordx4 v[172:175], v0, s[4:7], s45 offen offset:3072
    s_waitcnt lgkmcnt(6)
    v_mfma_f32_32x32x16_bf16 v[16:31], v[192:195], v[48:51], v[16:31]
    v_mfma_f32_32x32x16_bf16 v[32:47], v[192:195], v[52:55], v[32:47]
    ds_read_b128 v[48:51], v2 offset:24576
    ds_read_b128 v[52:55], v2 offset:57344
    s_add_u32 s44, s44, 4096
    s_add_u32 s45, s45, 4096
    buffer_load_dwordx4 v[176:179], v0, s[4:7], s44 offen offset:0
    s_waitcnt lgkmcnt(6)
    v_mfma_f32_32x32x16_bf16 v[16:31], v[196:199], v[56:59], v[16:31]
    v_mfma_f32_32x32x16_bf16 v[32:47], v[196:199], v[60:63], v[32:47]
    s_waitcnt vmcnt(9)
    s_barrier
    ds_read_b128 v[56:59], v2 offset:25600
    ds_read_b128 v[60:63], v2 offset:58368
    buffer_load_dwordx4 v[180:183], v0, s[4:7], s45 offen offset:0
    s_waitcnt lgkmcnt(6)
    v_mfma_f32_32x32x16_bf16 v[16:31], v[200:203], v[96:99], v[16:31]
    v_mfma_f32_32x32x16_bf16 v[32:47], v[200:203], v[100:103], v[32:47]
    ds_read_b128 v[96:99], v2 offset:28672
    ds_read_b128 v[100:103], v2 offset:61440
    buffer_load_dwordx4 v[184:187], v0, s[4:7], s44 offen offset:1024
    s_waitcnt lgkmcnt(6)
    v_mfma_f32_32x32x16_bf16 v[16:31], v[204:207], v[104:107], v[16:31]
    v_mfma_f32_32x32x16_bf16 v[32:47], v[204:207], v[108:111], v[32:47]
    ds_read_b128 v[104:107], v2 offset:29696
    ds_read_b128 v[108:111], v2 offset:62464
    buffer_load_dwordx4 v[188:191], v0, s[4:7], s45 offen offset:1024
    s_waitcnt lgkmcnt(6)
    v_mfma_f32_32x32x16_bf16 v[16:31], v[208:211], v[48:51], v[16:31]
    v_mfma_f32_32x32x16_bf16 v[32:47], v[208:211], v[52:55], v[32:47]
    ds_read_b128 v[48:51], v2 offset:2048
    ds_read_b128 v[52:55], v2 offset:34816
    buffer_load_dwordx4 v[192:195], v0, s[4:7], s44 offen offset:2048
    s_waitcnt lgkmcnt(6)
    v_mfma_f32_32x32x16_bf16 v[16:31], v[212:215], v[56:59], v[16:31]
    v_mfma_f32_32x32x16_bf16 v[32:47], v[212:215], v[60:63], v[32:47]
    ds_read_b128 v[56:59], v2 offset:3072
    ds_read_b128 v[60:63], v2 offset:35840
    buffer_load_dwordx4 v[196:199], v0, s[4:7], s45 offen offset:2048
    s_waitcnt lgkmcnt(6)
    v_mfma_f32_32x32x16_bf16 v[16:31], v[216:219], v[96:99], v[16:31]
    v_mfma_f32_32x32x16_bf16 v[32:47], v[216:219], v[100:103], v[32:47]
    ds_read_b128 v[96:99], v2 offset:6144
    ds_read_b128 v[100:103], v2 offset:38912
    buffer_load_dwordx4 v[200:203], v0, s[4:7], s44 offen offset:3072
    s_waitcnt lgkmcnt(6)
    v_mfma_f32_32x32x16_bf16 v[16:31], v[220:223], v[104:107], v[16:31]
    v_mfma_f32_32x32x16_bf16 v[32:47], v[220:223], v[108:111], v[32:47]
    ds_read_b128 v[104:107], v2 offset:7168
    ds_read_b128 v[108:111], v2 offset:39936
    buffer_load_dwordx4 v[204:207], v0, s[4:7], s45 offen offset:3072
    s_waitcnt lgkmcnt(6)
    v_mfma_f32_32x32x16_bf16 v[16:31], v[224:227], v[48:51], v[16:31]
    v_mfma_f32_32x32x16_bf16 v[32:47], v[224:227], v[52:55], v[32:47]
    ds_read_b128 v[48:51], v2 offset:10240
    ds_read_b128 v[52:55], v2 offset:43008
    s_add_u32 s44, s44, 4096
    s_add_u32 s45, s45, 4096
    buffer_load_dwordx4 v[208:211], v0, s[4:7], s44 offen offset:0
    s_waitcnt lgkmcnt(6)
    v_mfma_f32_32x32x16_bf16 v[16:31], v[228:231], v[56:59], v[16:31]
    v_mfma_f32_32x32x16_bf16 v[32:47], v[228:231], v[60:63], v[32:47]
    ds_read_b128 v[56:59], v2 offset:11264
    ds_read_b128 v[60:63], v2 offset:44032
    buffer_load_dwordx4 v[212:215], v0, s[4:7], s45 offen offset:0
    s_waitcnt lgkmcnt(6)
    v_mfma_f32_32x32x16_bf16 v[16:31], v[232:235], v[96:99], v[16:31]
    v_mfma_f32_32x32x16_bf16 v[32:47], v[232:235], v[100:103], v[32:47]
    ds_read_b128 v[96:99], v2 offset:14336
    ds_read_b128 v[100:103], v2 offset:47104
    buffer_load_dwordx4 v[216:219], v0, s[4:7], s44 offen offset:1024
    s_waitcnt lgkmcnt(6)
    v_mfma_f32_32x32x16_bf16 v[16:31], v[236:239], v[104:107], v[16:31]
    v_mfma_f32_32x32x16_bf16 v[32:47], v[236:239], v[108:111], v[32:47]
    ds_read_b128 v[104:107], v2 offset:15360
    ds_read_b128 v[108:111], v2 offset:48128
    buffer_load_dwordx4 v[220:223], v0, s[4:7], s45 offen offset:1024
    s_waitcnt lgkmcnt(6)
    v_mfma_f32_32x32x16_bf16 v[16:31], v[240:243], v[48:51], v[16:31]
    v_mfma_f32_32x32x16_bf16 v[32:47], v[240:243], v[52:55], v[32:47]
    ds_read_b128 v[48:51], v2 offset:18432
    ds_read_b128 v[52:55], v2 offset:51200
    buffer_load_dwordx4 v[224:227], v0, s[4:7], s44 offen offset:2048
    s_waitcnt lgkmcnt(6)
    v_mfma_f32_32x32x16_bf16 v[16:31], v[244:247], v[56:59], v[16:31]
    v_mfma_f32_32x32x16_bf16 v[32:47], v[244:247], v[60:63], v[32:47]
    ds_read_b128 v[56:59], v2 offset:19456
    ds_read_b128 v[60:63], v2 offset:52224
    buffer_load_dwordx4 v[228:231], v0, s[4:7], s45 offen offset:2048
    s_waitcnt lgkmcnt(6)
    v_mfma_f32_32x32x16_bf16 v[16:31], v[248:251], v[96:99], v[16:31]
    v_mfma_f32_32x32x16_bf16 v[32:47], v[248:251], v[100:103], v[32:47]
    ds_read_b128 v[96:99], v2 offset:22528
    ds_read_b128 v[100:103], v2 offset:55296
    buffer_load_dwordx4 v[232:235], v0, s[4:7], s44 offen offset:3072
    s_waitcnt lgkmcnt(6)
    v_mfma_f32_32x32x16_bf16 v[16:31], v[252:255], v[104:107], v[16:31]
    v_mfma_f32_32x32x16_bf16 v[32:47], v[252:255], v[108:111], v[32:47]
    ds_read_b128 v[104:107], v2 offset:23552
    ds_read_b128 v[108:111], v2 offset:56320
    buffer_load_dwordx4 v[236:239], v0, s[4:7], s45 offen offset:3072
    s_waitcnt lgkmcnt(6)
    v_mfma_f32_32x32x16_bf16 v[16:31], v[64:67], v[48:51], v[16:31]
    v_mfma_f32_32x32x16_bf16 v[32:47], v[64:67], v[52:55], v[32:47]
    ds_read_b128 v[48:51], v2 offset:26624
    ds_read_b128 v[52:55], v2 offset:59392
    s_waitcnt lgkmcnt(6)
    v_mfma_f32_32x32x16_bf16 v[16:31], v[68:71], v[56:59], v[16:31]
    v_mfma_f32_32x32x16_bf16 v[32:47], v[68:71], v[60:63], v[32:47]
    ds_read_b128 v[56:59], v2 offset:27648
    ds_read_b128 v[60:63], v2 offset:60416
    s_waitcnt lgkmcnt(6)
    v_mfma_f32_32x32x16_bf16 v[16:31], v[72:75], v[96:99], v[16:31]
    v_mfma_f32_32x32x16_bf16 v[32:47], v[72:75], v[100:103], v[32:47]
    ds_read_b128 v[96:99], v2 offset:30720
    ds_read_b128 v[100:103], v2 offset:63488
    s_waitcnt lgkmcnt(6)
    v_mfma_f32_32x32x16_bf16 v[16:31], v[76:79], v[104:107], v[16:31]
    v_mfma_f32_32x32x16_bf16 v[32:47], v[76:79], v[108:111], v[32:47]
    ds_read_b128 v[104:107], v2 offset:31744
    ds_read_b128 v[108:111], v2 offset:64512
    s_waitcnt lgkmcnt(6)
    v_mfma_f32_32x32x16_bf16 v[16:31], v[80:83], v[48:51], v[16:31]
    v_mfma_f32_32x32x16_bf16 v[32:47], v[80:83], v[52:55], v[32:47]
    v_and_b32 v3, 0x1f0, v0
    v_lshrrev_b32 v3, 1, v3
    v_add_u32 v3, 0x24000, v3
    ds_read2st64_b64 v[240:243], v3 offset0:0 offset1:1
    ds_read2st64_b64 v[244:247], v3 offset0:2 offset1:3
    ds_read2st64_b64 v[248:251], v3 offset0:4 offset1:5
    ds_read2st64_b64 v[252:255], v3 offset0:6 offset1:7
    v_and_b32 v3, 0x1f0, v0
    v_lshrrev_b32 v3, 1, v3
    v_add_u32 v3, 0x24100, v3
    ds_read2st64_b64 v[64:67], v3 offset0:0 offset1:1
    ds_read2st64_b64 v[68:71], v3 offset0:2 offset1:3
    ds_read2st64_b64 v[72:75], v3 offset0:4 offset1:5
    ds_read2st64_b64 v[76:79], v3 offset0:6 offset1:7
    s_waitcnt lgkmcnt(12)
    v_mfma_f32_32x32x16_bf16 v[16:31], v[84:87], v[56:59], v[16:31]
    v_mfma_f32_32x32x16_bf16 v[32:47], v[84:87], v[60:63], v[32:47]
    s_waitcnt lgkmcnt(10)
    v_mfma_f32_32x32x16_bf16 v[16:31], v[88:91], v[96:99], v[16:31]
    v_mfma_f32_32x32x16_bf16 v[32:47], v[88:91], v[100:103], v[32:47]
    s_waitcnt lgkmcnt(8)
    v_mfma_f32_32x32x16_bf16 v[16:31], v[92:95], v[104:107], v[16:31]
    v_mfma_f32_32x32x16_bf16 v[32:47], v[92:95], v[108:111], v[32:47]
    s_waitcnt lgkmcnt(0)
    v_pk_add_f32 v[240:241], v[240:241], v[248:249]
    v_pk_add_f32 v[242:243], v[242:243], v[250:251]
    v_pk_add_f32 v[244:245], v[244:245], v[252:253]
    v_pk_add_f32 v[246:247], v[246:247], v[254:255]
    v_pk_add_f32 v[240:241], v[240:241], v[244:245]
    v_pk_add_f32 v[242:243], v[242:243], v[246:247]
    v_pk_add_f32 v[4:5], v[240:241], v[242:243]
    v_pk_add_f32 v[64:65], v[64:65], v[72:73]
    v_pk_add_f32 v[66:67], v[66:67], v[74:75]
    v_pk_add_f32 v[68:69], v[68:69], v[76:77]
    v_pk_add_f32 v[70:71], v[70:71], v[78:79]
    v_pk_add_f32 v[64:65], v[64:65], v[68:69]
    v_pk_add_f32 v[66:67], v[66:67], v[70:71]
    v_pk_add_f32 v[6:7], v[64:65], v[66:67]
    v_mul_f32 v4, 0xbb000000, v4
    v_mul_f32 v5, 0xbb000000, v5
    v_fma_f32 v5, -v4, v4, v5
    v_max_f32 v5, 0, v5
    v_add_f32 v5, 0x3727c5ac, v5
    v_rsq_f32 v5, v5
    s_nop 0
    v_mul_f32 v6, 0xbb000000, v6
    v_mul_f32 v7, 0xbb000000, v7
    v_fma_f32 v7, -v6, v6, v7
    v_max_f32 v7, 0, v7
    v_add_f32 v7, 0x3727c5ac, v7
    v_rsq_f32 v7, v7
    s_nop 0
    s_mov_b32 s42, 0xbdd2d3e8
    s_mov_b32 s43, s42
    v_mov_b32 v2, 0xc0135761
    v_mov_b32 v3, v2
    s_mul_i32 s26, s22, 172
    s_lshl_b32 s27, s32, 1
    s_add_u32 s26, s26, s27
    s_lshl_b32 s26, s26, 10
    s_add_u32 s26, s26, 0x1000000
    s_add_u32 s27, s26, 88064
    v_pk_fma_f32 v[16:17], v[4:5], v[128:129], v[16:17] op_sel_hi:[0,1,1]
    v_pk_fma_f32 v[18:19], v[4:5], v[130:131], v[18:19] op_sel_hi:[0,1,1]
    v_pk_fma_f32 v[20:21], v[4:5], v[132:133], v[20:21] op_sel_hi:[0,1,1]
    v_pk_fma_f32 v[22:23], v[4:5], v[134:135], v[22:23] op_sel_hi:[0,1,1]
    v_pk_fma_f32 v[24:25], v[4:5], v[136:137], v[24:25] op_sel_hi:[0,1,1]
    v_pk_fma_f32 v[26:27], v[4:5], v[138:139], v[26:27] op_sel_hi:[0,1,1]
    v_pk_fma_f32 v[28:29], v[4:5], v[140:141], v[28:29] op_sel_hi:[0,1,1]
    v_pk_fma_f32 v[30:31], v[4:5], v[142:143], v[30:31] op_sel_hi:[0,1,1]
    v_pk_fma_f32 v[16:17], v[4:5], v[16:17], v[144:145] op_sel:[1,0,0]
    v_pk_fma_f32 v[18:19], v[4:5], v[18:19], v[146:147] op_sel:[1,0,0]
    v_pk_fma_f32 v[20:21], v[4:5], v[20:21], v[148:149] op_sel:[1,0,0]
    v_pk_fma_f32 v[22:23], v[4:5], v[22:23], v[150:151] op_sel:[1,0,0]
    v_pk_fma_f32 v[24:25], v[4:5], v[24:25], v[152:153] op_sel:[1,0,0]
    v_pk_fma_f32 v[26:27], v[4:5], v[26:27], v[154:155] op_sel:[1,0,0]
    v_pk_fma_f32 v[28:29], v[4:5], v[28:29], v[156:157] op_sel:[1,0,0]
    v_pk_fma_f32 v[30:31], v[4:5], v[30:31], v[158:159] op_sel:[1,0,0]
    v_pk_mul_f32 v[48:49], v[16:17], v[16:17]
    v_pk_mul_f32 v[50:51], v[18:19], v[18:19]
    v_pk_mul_f32 v[52:53], v[20:21], v[20:21]
    v_pk_mul_f32 v[54:55], v[22:23], v[22:23]
    v_pk_mul_f32 v[56:57], v[24:25], v[24:25]
    v_pk_mul_f32 v[58:59], v[26:27], v[26:27]
    v_pk_mul_f32 v[60:61], v[28:29], v[28:29]
    v_pk_mul_f32 v[62:63], v[30:31], v[30:31]
    v_pk_fma_f32 v[48:49], v[48:49], s[42:43], v[2:3]
    v_pk_fma_f32 v[50:51], v[50:51], s[42:43], v[2:3]
    v_pk_fma_f32 v[52:53], v[52:53], s[42:43], v[2:3]
    v_pk_fma_f32 v[54:55], v[54:55], s[42:43], v[2:3]
    v_pk_fma_f32 v[56:57], v[56:57], s[42:43], v[2:3]
    v_pk_fma_f32 v[58:59], v[58:59], s[42:43], v[2:3]
    v_pk_fma_f32 v[60:61], v[60:61], s[42:43], v[2:3]
    v_pk_fma_f32 v[62:63], v[62:63], s[42:43], v[2:3]
    v_pk_mul_f32 v[48:49], v[48:49], v[16:17]
    v_pk_mul_f32 v[50:51], v[50:51], v[18:19]
    v_pk_mul_f32 v[52:53], v[52:53], v[20:21]
    v_pk_mul_f32 v[54:55], v[54:55], v[22:23]
    v_pk_mul_f32 v[56:57], v[56:57], v[24:25]
    v_pk_mul_f32 v[58:59], v[58:59], v[26:27]
    v_pk_mul_f32 v[60:61], v[60:61], v[28:29]
    v_pk_mul_f32 v[62:63], v[62:63], v[30:31]
    v_exp_f32 v48, v48
    v_exp_f32 v49, v49
    v_exp_f32 v50, v50
    v_exp_f32 v51, v51
    v_exp_f32 v52, v52
    v_exp_f32 v53, v53
    v_exp_f32 v54, v54
    v_exp_f32 v55, v55
    v_exp_f32 v56, v56
    v_exp_f32 v57, v57
    v_exp_f32 v58, v58
    v_exp_f32 v59, v59
    v_exp_f32 v60, v60
    v_exp_f32 v61, v61
    v_exp_f32 v62, v62
    v_exp_f32 v63, v63
    v_pk_add_f32 v[48:49], v[48:49], 1.0 op_sel_hi:[1,0]
    v_pk_add_f32 v[50:51], v[50:51], 1.0 op_sel_hi:[1,0]
    v_pk_add_f32 v[52:53], v[52:53], 1.0 op_sel_hi:[1,0]
    v_pk_add_f32 v[54:55], v[54:55], 1.0 op_sel_hi:[1,0]
    v_pk_add_f32 v[56:57], v[56:57], 1.0 op_sel_hi:[1,0]
    v_pk_add_f32 v[58:59], v[58:59], 1.0 op_sel_hi:[1,0]
    v_pk_add_f32 v[60:61], v[60:61], 1.0 op_sel_hi:[1,0]
    v_pk_add_f32 v[62:63], v[62:63], 1.0 op_sel_hi:[1,0]
    v_rcp_f32 v48, v48
    v_rcp_f32 v49, v49
    v_rcp_f32 v50, v50
    v_rcp_f32 v51, v51
    v_rcp_f32 v52, v52
    v_rcp_f32 v53, v53
    v_rcp_f32 v54, v54
    v_rcp_f32 v55, v55
    v_rcp_f32 v56, v56
    v_rcp_f32 v57, v57
    v_rcp_f32 v58, v58
    v_rcp_f32 v59, v59
    v_rcp_f32 v60, v60
    v_rcp_f32 v61, v61
    v_rcp_f32 v62, v62
    v_rcp_f32 v63, v63
    v_pk_mul_f32 v[16:17], v[16:17], v[48:49]
    v_pk_mul_f32 v[18:19], v[18:19], v[50:51]
    v_pk_mul_f32 v[20:21], v[20:21], v[52:53]
    v_pk_mul_f32 v[22:23], v[22:23], v[54:55]
    v_pk_mul_f32 v[24:25], v[24:25], v[56:57]
    v_pk_mul_f32 v[26:27], v[26:27], v[58:59]
    v_pk_mul_f32 v[28:29], v[28:29], v[60:61]
    v_pk_mul_f32 v[30:31], v[30:31], v[62:63]
    v_cvt_pk_bf16_f32 v16, v16, v17
    v_cvt_pk_bf16_f32 v17, v18, v19
    v_cvt_pk_bf16_f32 v18, v20, v21
    v_cvt_pk_bf16_f32 v19, v22, v23
    v_cvt_pk_bf16_f32 v20, v24, v25
    v_cvt_pk_bf16_f32 v21, v26, v27
    v_cvt_pk_bf16_f32 v22, v28, v29
    v_cvt_pk_bf16_f32 v23, v30, v31
    s_cmp_lg_u32 s37, 0
    s_cbranch_scc1 L_hs_108
    buffer_store_dwordx4 v[16:19], v0, s[4:7], s26 offen offset:0 sc1
    buffer_store_dwordx4 v[20:23], v0, s[4:7], s26 offen offset:1024 sc1
    s_branch L_hsd_109
L_hs_108:
    buffer_store_dwordx4 v[16:19], v0, s[4:7], s26 offen offset:0
    buffer_store_dwordx4 v[20:23], v0, s[4:7], s26 offen offset:1024
L_hsd_109:
    v_pk_fma_f32 v[32:33], v[6:7], v[128:129], v[32:33] op_sel_hi:[0,1,1]
    v_pk_fma_f32 v[34:35], v[6:7], v[130:131], v[34:35] op_sel_hi:[0,1,1]
    v_pk_fma_f32 v[36:37], v[6:7], v[132:133], v[36:37] op_sel_hi:[0,1,1]
    v_pk_fma_f32 v[38:39], v[6:7], v[134:135], v[38:39] op_sel_hi:[0,1,1]
    v_pk_fma_f32 v[40:41], v[6:7], v[136:137], v[40:41] op_sel_hi:[0,1,1]
    v_pk_fma_f32 v[42:43], v[6:7], v[138:139], v[42:43] op_sel_hi:[0,1,1]
    v_pk_fma_f32 v[44:45], v[6:7], v[140:141], v[44:45] op_sel_hi:[0,1,1]
    v_pk_fma_f32 v[46:47], v[6:7], v[142:143], v[46:47] op_sel_hi:[0,1,1]
    v_pk_fma_f32 v[32:33], v[6:7], v[32:33], v[144:145] op_sel:[1,0,0]
    v_pk_fma_f32 v[34:35], v[6:7], v[34:35], v[146:147] op_sel:[1,0,0]
    v_pk_fma_f32 v[36:37], v[6:7], v[36:37], v[148:149] op_sel:[1,0,0]
    v_pk_fma_f32 v[38:39], v[6:7], v[38:39], v[150:151] op_sel:[1,0,0]
    v_pk_fma_f32 v[40:41], v[6:7], v[40:41], v[152:153] op_sel:[1,0,0]
    v_pk_fma_f32 v[42:43], v[6:7], v[42:43], v[154:155] op_sel:[1,0,0]
    v_pk_fma_f32 v[44:45], v[6:7], v[44:45], v[156:157] op_sel:[1,0,0]
    v_pk_fma_f32 v[46:47], v[6:7], v[46:47], v[158:159] op_sel:[1,0,0]
    v_pk_mul_f32 v[48:49], v[32:33], v[32:33]
    v_pk_mul_f32 v[50:51], v[34:35], v[34:35]
    v_pk_mul_f32 v[52:53], v[36:37], v[36:37]
    v_pk_mul_f32 v[54:55], v[38:39], v[38:39]
    v_pk_mul_f32 v[56:57], v[40:41], v[40:41]
    v_pk_mul_f32 v[58:59], v[42:43], v[42:43]
    v_pk_mul_f32 v[60:61], v[44:45], v[44:45]
    v_pk_mul_f32 v[62:63], v[46:47], v[46:47]
    v_pk_fma_f32 v[48:49], v[48:49], s[42:43], v[2:3]
    v_pk_fma_f32 v[50:51], v[50:51], s[42:43], v[2:3]
    v_pk_fma_f32 v[52:53], v[52:53], s[42:43], v[2:3]
    v_pk_fma_f32 v[54:55], v[54:55], s[42:43], v[2:3]
    v_pk_fma_f32 v[56:57], v[56:57], s[42:43], v[2:3]
    v_pk_fma_f32 v[58:59], v[58:59], s[42:43], v[2:3]
    v_pk_fma_f32 v[60:61], v[60:61], s[42:43], v[2:3]
    v_pk_fma_f32 v[62:63], v[62:63], s[42:43], v[2:3]
    v_pk_mul_f32 v[48:49], v[48:49], v[32:33]
    v_pk_mul_f32 v[50:51], v[50:51], v[34:35]
    v_pk_mul_f32 v[52:53], v[52:53], v[36:37]
    v_pk_mul_f32 v[54:55], v[54:55], v[38:39]
    v_pk_mul_f32 v[56:57], v[56:57], v[40:41]
    v_pk_mul_f32 v[58:59], v[58:59], v[42:43]
    v_pk_mul_f32 v[60:61], v[60:61], v[44:45]
    v_pk_mul_f32 v[62:63], v[62:63], v[46:47]
    v_exp_f32 v48, v48
    v_exp_f32 v49, v49
    v_exp_f32 v50, v50
    v_exp_f32 v51, v51
    v_exp_f32 v52, v52
    v_exp_f32 v53, v53
    v_exp_f32 v54, v54
    v_exp_f32 v55, v55
    v_exp_f32 v56, v56
    v_exp_f32 v57, v57
    v_exp_f32 v58, v58
    v_exp_f32 v59, v59
    v_exp_f32 v60, v60
    v_exp_f32 v61, v61
    v_exp_f32 v62, v62
    v_exp_f32 v63, v63
    v_pk_add_f32 v[48:49], v[48:49], 1.0 op_sel_hi:[1,0]
    v_pk_add_f32 v[50:51], v[50:51], 1.0 op_sel_hi:[1,0]
    v_pk_add_f32 v[52:53], v[52:53], 1.0 op_sel_hi:[1,0]
    v_pk_add_f32 v[54:55], v[54:55], 1.0 op_sel_hi:[1,0]
    v_pk_add_f32 v[56:57], v[56:57], 1.0 op_sel_hi:[1,0]
    v_pk_add_f32 v[58:59], v[58:59], 1.0 op_sel_hi:[1,0]
    v_pk_add_f32 v[60:61], v[60:61], 1.0 op_sel_hi:[1,0]
    v_pk_add_f32 v[62:63], v[62:63], 1.0 op_sel_hi:[1,0]
    v_rcp_f32 v48, v48
    v_rcp_f32 v49, v49
    v_rcp_f32 v50, v50
    v_rcp_f32 v51, v51
    v_rcp_f32 v52, v52
    v_rcp_f32 v53, v53
    v_rcp_f32 v54, v54
    v_rcp_f32 v55, v55
    v_rcp_f32 v56, v56
    v_rcp_f32 v57, v57
    v_rcp_f32 v58, v58
    v_rcp_f32 v59, v59
    v_rcp_f32 v60, v60
    v_rcp_f32 v61, v61
    v_rcp_f32 v62, v62
    v_rcp_f32 v63, v63
    v_pk_mul_f32 v[32:33], v[32:33], v[48:49]
    v_pk_mul_f32 v[34:35], v[34:35], v[50:51]
    v_pk_mul_f32 v[36:37], v[36:37], v[52:53]
    v_pk_mul_f32 v[38:39], v[38:39], v[54:55]
    v_pk_mul_f32 v[40:41], v[40:41], v[56:57]
    v_pk_mul_f32 v[42:43], v[42:43], v[58:59]
    v_pk_mul_f32 v[44:45], v[44:45], v[60:61]
    v_pk_mul_f32 v[46:47], v[46:47], v[62:63]
    v_cvt_pk_bf16_f32 v32, v32, v33
    v_cvt_pk_bf16_f32 v33, v34, v35
    v_cvt_pk_bf16_f32 v34, v36, v37
    v_cvt_pk_bf16_f32 v35, v38, v39
    v_cvt_pk_bf16_f32 v36, v40, v41
    v_cvt_pk_bf16_f32 v37, v42, v43
    v_cvt_pk_bf16_f32 v38, v44, v45
    v_cvt_pk_bf16_f32 v39, v46, v47
    s_cmp_lg_u32 s37, 0
    s_cbranch_scc1 L_hs_110
    buffer_store_dwordx4 v[32:35], v0, s[4:7], s27 offen offset:0 sc1
    buffer_store_dwordx4 v[36:39], v0, s[4:7], s27 offen offset:1024 sc1
    s_branch L_hsd_111
L_hs_110:
    buffer_store_dwordx4 v[32:35], v0, s[4:7], s27 offen offset:0
    buffer_store_dwordx4 v[36:39], v0, s[4:7], s27 offen offset:1024
L_hsd_111:
    s_branch L_f1j_107
L_f1hi_106:
    s_cmp_ge_u32 s21, 3
    s_cselect_b32 s30, 6, 8
    s_cmp_ge_u32 s20, s30
    s_cbranch_scc1 L_f1sk_112
    s_lshl_b32 s30, s24, 15
    s_add_u32 s30, s30, 0x0
    v_add_u32 v2, s30, v0
    v_and_b32 v3, 0x1f0, v0
    v_lshrrev_b32 v3, 1, v3
    s_lshl_b32 s28, s24, 8
    s_add_u32 s28, s28, 0x24000
    v_add_u32 v3, s28, v3
    ds_read2st64_b64 v[32:35], v3 offset0:0 offset1:1
    ds_read2st64_b64 v[36:39], v3 offset0:2 offset1:3
    ds_read2st64_b64 v[40:43], v3 offset0:4 offset1:5
    ds_read2st64_b64 v[44:47], v3 offset0:6 offset1:7
    ds_read_b128 v[48:51], v2 offset:0
    ds_read_b128 v[52:55], v2 offset:1024
    ds_read_b128 v[56:59], v2 offset:4096
    ds_read_b128 v[60:63], v2 offset:5120
    ds_read_b128 v[96:99], v2 offset:8192
    ds_read_b128 v[100:103], v2 offset:9216
    ds_read_b128 v[104:107], v2 offset:12288
    ds_read_b128 v[108:111], v2 offset:13312
    s_waitcnt lgkmcnt(7)
    v_mfma_f32_32x32x16_bf16 v[16:31], v[160:163], v[48:51], 0
    ds_read_b128 v[48:51], v2 offset:16384
    buffer_load_dwordx4 v[112:115], v0, s[4:7], s44 offen offset:0
    s_waitcnt lgkmcnt(7)
    v_mfma_f32_32x32x16_bf16 v[16:31], v[164:167], v[52:55], v[16:31]
    ds_read_b128 v[52:55], v2 offset:17408
    buffer_load_dwordx4 v[116:119], v0, s[4:7], s45 offen offset:0
    s_waitcnt lgkmcnt(7)
    v_mfma_f32_32x32x16_bf16 v[16:31], v[168:171], v[56:59], v[16:31]
    ds_read_b128 v[56:59], v2 offset:20480
    buffer_load_dwordx4 v[120:123], v0, s[4:7], s44 offen offset:1024
    s_waitcnt lgkmcnt(7)
    v_mfma_f32_32x32x16_bf16 v[16:31], v[172:175], v[60:63], v[16:31]
    ds_read_b128 v[60:63], v2 offset:21504
    buffer_load_dwordx4 v[124:127], v0, s[4:7], s45 offen offset:1024
    s_waitcnt lgkmcnt(7)
    v_mfma_f32_32x32x16_bf16 v[16:31], v[176:179], v[96:99], v[16:31]
    ds_read_b128 v[96:99], v2 offset:24576
    buffer_load_dwordx4 v[160:163], v0, s[4:7], s44 offen offset:2048
    s_waitcnt lgkmcnt(7)
    v_mfma_f32_32x32x16_bf16 v[16:31], v[180:183], v[100:103], v[16:31]
    ds_read_b128 v[100:103], v2 offset:25600
    buffer_load_dwordx4 v[164:167], v0, s[4:7], s45 offen offset:2048
    s_waitcnt lgkmcnt(7)
    v_mfma_f32_32x32x16_bf16 v[16:31], v[184:187], v[104:107], v[16:31]
    ds_read_b128 v[104:107], v2 offset:28672
    buffer_load_dwordx4 v[168:171], v0, s[4:7], s44 offen offset:3072
    s_waitcnt lgkmcnt(7)
    v_mfma_f32_32x32x16_bf16 v[16:31], v[188:191], v[108:111], v[16:31]
    ds_read_b128 v[108:111], v2 offset:29696
    buffer_load_dwordx4 v[172:175], v0, s[4:7], s45 offen offset:3072
    s_waitcnt lgkmcnt(7)
    v_mfma_f32_32x32x16_bf16 v[16:31], v[192:195], v[48:51], v[16:31]
    s_waitcnt vmcnt(8)
    s_barrier
    ds_read_b128 v[48:51], v2 offset:2048
    s_add_u32 s44, s44, 4096
    s_add_u32 s45, s45, 4096
    buffer_load_dwordx4 v[176:179], v0, s[4:7], s44 offen offset:0
    s_waitcnt lgkmcnt(7)
    v_mfma_f32_32x32x16_bf16 v[16:31], v[196:199], v[52:55], v[16:31]
    ds_read_b128 v[52:55], v2 offset:3072
    buffer_load_dwordx4 v[180:183], v0, s[4:7], s45 offen offset:0
    s_waitcnt lgkmcnt(7)
    v_mfma_f32_32x32x16_bf16 v[16:31], v[200:203], v[56:59], v[16:31]
    ds_read_b128 v[56:59], v2 offset:6144
    buffer_load_dwordx4 v[184:187], v0, s[4:7], s44 offen offset:1024
    s_waitcnt lgkmcnt(7)
    v_mfma_f32_32x32x16_bf16 v[16:31], v[204:207], v[60:63], v[16:31]
    ds_read_b128 v[60:63], v2 offset:7168
    buffer_load_dwordx4 v[188:191], v0, s[4:7], s45 offen offset:1024
    s_waitcnt lgkmcnt(7)
    v_mfma_f32_32x32x16_bf16 v[16:31], v[208:211], v[96:99], v[16:31]
    ds_read_b128 v[96:99], v2 offset:10240
    buffer_load_dwordx4 v[192:195], v0, s[4:7], s44 offen offset:2048
    s_waitcnt lgkmcnt(7)
    v_mfma_f32_32x32x16_bf16 v[16:31], v[212:215], v[100:103], v[16:31]
    ds_read_b128 v[100:103], v2 offset:11264
    buffer_load_dwordx4 v[196:199], v0, s[4:7], s45 offen offset:2048
    s_waitcnt lgkmcnt(7)
    v_mfma_f32_32x32x16_bf16 v[16:31], v[216:219], v[104:107], v[16:31]
    ds_read_b128 v[104:107], v2 offset:14336
    buffer_load_dwordx4 v[200:203], v0, s[4:7], s44 offen offset:3072
    s_waitcnt lgkmcnt(7)
    v_mfma_f32_32x32x16_bf16 v[16:31], v[220:223], v[108:111], v[16:31]
    ds_read_b128 v[108:111], v2 offset:15360
    buffer_load_dwordx4 v[204:207], v0, s[4:7], s45 offen offset:3072
    s_waitcnt lgkmcnt(7)
    v_mfma_f32_32x32x16_bf16 v[16:31], v[224:227], v[48:51], v[16:31]
    ds_read_b128 v[48:51], v2 offset:18432
    s_add_u32 s44, s44, 4096
    s_add_u32 s45, s45, 4096
    buffer_load_dwordx4 v[208:211], v0, s[4:7], s44 offen offset:0
    s_waitcnt lgkmcnt(7)
    v_mfma_f32_32x32x16_bf16 v[16:31], v[228:231], v[52:55], v[16:31]
    ds_read_b128 v[52:55], v2 offset:19456
    buffer_load_dwordx4 v[212:215], v0, s[4:7], s45 offen offset:0
    s_waitcnt lgkmcnt(7)
    v_mfma_f32_32x32x16_bf16 v[16:31], v[232:235], v[56:59], v[16:31]
    ds_read_b128 v[56:59], v2 offset:22528
    buffer_load_dwordx4 v[216:219], v0, s[4:7], s44 offen offset:1024
    s_waitcnt lgkmcnt(7)
    v_mfma_f32_32x32x16_bf16 v[16:31], v[236:239], v[60:63], v[16:31]
    ds_read_b128 v[60:63], v2 offset:23552
    buffer_load_dwordx4 v[220:223], v0, s[4:7], s45 offen offset:1024
    s_waitcnt lgkmcnt(7)
    v_mfma_f32_32x32x16_bf16 v[16:31], v[240:243], v[96:99], v[16:31]
    ds_read_b128 v[96:99], v2 offset:26624
    s_waitcnt lgkmcnt(7)
    v_mfma_f32_32x32x16_bf16 v[16:31], v[244:247], v[100:103], v[16:31]
    ds_read_b128 v[100:103], v2 offset:27648
    s_waitcnt lgkmcnt(7)
    v_mfma_f32_32x32x16_bf16 v[16:31], v[248:251], v[104:107], v[16:31]
    ds_read_b128 v[104:107], v2 offset:30720
    s_waitcnt lgkmcnt(7)
    v_mfma_f32_32x32x16_bf16 v[16:31], v[252:255], v[108:111], v[16:31]
    ds_read_b128 v[108:111], v2 offset:31744
    s_waitcnt lgkmcnt(7)
    v_mfma_f32_32x32x16_bf16 v[16:31], v[64:67], v[48:51], v[16:31]
    s_waitcnt lgkmcnt(6)
    v_mfma_f32_32x32x16_bf16 v[16:31], v[68:71], v[52:55], v[16:31]
    s_waitcnt lgkmcnt(5)
    v_mfma_f32_32x32x16_bf16 v[16:31], v[72:75], v[56:59], v[16:31]
    s_waitcnt lgkmcnt(4)
    v_mfma_f32_32x32x16_bf16 v[16:31], v[76:79], v[60:63], v[16:31]
    s_waitcnt lgkmcnt(3)
    v_mfma_f32_32x32x16_bf16 v[16:31], v[80:83], v[96:99], v[16:31]
    s_waitcnt lgkmcnt(2)
    v_mfma_f32_32x32x16_bf16 v[16:31], v[84:87], v[100:103], v[16:31]
    s_waitcnt lgkmcnt(1)
    v_mfma_f32_32x32x16_bf16 v[16:31], v[88:91], v[104:107], v[16:31]
    s_waitcnt lgkmcnt(0)
    v_mfma_f32_32x32x16_bf16 v[16:31], v[92:95], v[108:111], v[16:31]
    v_pk_add_f32 v[32:33], v[32:33], v[40:41]
    v_pk_add_f32 v[34:35], v[34:35], v[42:43]
    v_pk_add_f32 v[36:37], v[36:37], v[44:45]
    v_pk_add_f32 v[38:39], v[38:39], v[46:47]
    v_pk_add_f32 v[32:33], v[32:33], v[36:37]
    v_pk_add_f32 v[34:35], v[34:35], v[38:39]
    v_pk_add_f32 v[4:5], v[32:33], v[34:35]
    v_mul_f32 v4, 0xbb000000, v4
    v_mul_f32 v5, 0xbb000000, v5
    v_fma_f32 v5, -v4, v4, v5
    v_max_f32 v5, 0, v5
    v_add_f32 v5, 0x3727c5ac, v5
    v_rsq_f32 v5, v5
    s_nop 0
    s_mov_b32 s42, 0xbdd2d3e8
    s_mov_b32 s43, s42
    v_mov_b32 v2, 0xc0135761
    v_mov_b32 v3, v2
    s_lshl_b32 s26, s22, 1
    s_add_u32 s26, s26, s24
    s_mul_i32 s26, s26, 86
    s_lshl_b32 s27, s32, 1
    s_add_u32 s26, s26, s27
    s_lshl_b32 s26, s26, 10
    s_add_u32 s26, s26, 0x1000000
    v_pk_fma_f32 v[16:17], v[4:5], v[128:129], v[16:17] op_sel_hi:[0,1,1]
    v_pk_fma_f32 v[18:19], v[4:5], v[130:131], v[18:19] op_sel_hi:[0,1,1]
    v_pk_fma_f32 v[20:21], v[4:5], v[132:133], v[20:21] op_sel_hi:[0,1,1]
    v_pk_fma_f32 v[22:23], v[4:5], v[134:135], v[22:23] op_sel_hi:[0,1,1]
    v_pk_fma_f32 v[24:25], v[4:5], v[136:137], v[24:25] op_sel_hi:[0,1,1]
    v_pk_fma_f32 v[26:27], v[4:5], v[138:139], v[26:27] op_sel_hi:[0,1,1]
    v_pk_fma_f32 v[28:29], v[4:5], v[140:141], v[28:29] op_sel_hi:[0,1,1]
    v_pk_fma_f32 v[30:31], v[4:5], v[142:143], v[30:31] op_sel_hi:[0,1,1]
    v_pk_fma_f32 v[16:17], v[4:5], v[16:17], v[144:145] op_sel:[1,0,0]
    v_pk_fma_f32 v[18:19], v[4:5], v[18:19], v[146:147] op_sel:[1,0,0]
    v_pk_fma_f32 v[20:21], v[4:5], v[20:21], v[148:149] op_sel:[1,0,0]
    v_pk_fma_f32 v[22:23], v[4:5], v[22:23], v[150:151] op_sel:[1,0,0]
    v_pk_fma_f32 v[24:25], v[4:5], v[24:25], v[152:153] op_sel:[1,0,0]
    v_pk_fma_f32 v[26:27], v[4:5], v[26:27], v[154:155] op_sel:[1,0,0]
    v_pk_fma_f32 v[28:29], v[4:5], v[28:29], v[156:157] op_sel:[1,0,0]
    v_pk_fma_f32 v[30:31], v[4:5], v[30:31], v[158:159] op_sel:[1,0,0]
    v_pk_mul_f32 v[48:49], v[16:17], v[16:17]
    v_pk_mul_f32 v[50:51], v[18:19], v[18:19]
    v_pk_mul_f32 v[52:53], v[20:21], v[20:21]
    v_pk_mul_f32 v[54:55], v[22:23], v[22:23]
    v_pk_mul_f32 v[56:57], v[24:25], v[24:25]
    v_pk_mul_f32 v[58:59], v[26:27], v[26:27]
    v_pk_mul_f32 v[60:61], v[28:29], v[28:29]
    v_pk_mul_f32 v[62:63], v[30:31], v[30:31]
    v_pk_fma_f32 v[48:49], v[48:49], s[42:43], v[2:3]
    v_pk_fma_f32 v[50:51], v[50:51], s[42:43], v[2:3]
    v_pk_fma_f32 v[52:53], v[52:53], s[42:43], v[2:3]
    v_pk_fma_f32 v[54:55], v[54:55], s[42:43], v[2:3]
    v_pk_fma_f32 v[56:57], v[56:57], s[42:43], v[2:3]
    v_pk_fma_f32 v[58:59], v[58:59], s[42:43], v[2:3]
    v_pk_fma_f32 v[60:61], v[60:61], s[42:43], v[2:3]
    v_pk_fma_f32 v[62:63], v[62:63], s[42:43], v[2:3]
    v_pk_mul_f32 v[48:49], v[48:49], v[16:17]
    v_pk_mul_f32 v[50:51], v[50:51], v[18:19]
    v_pk_mul_f32 v[52:53], v[52:53], v[20:21]
    v_pk_mul_f32 v[54:55], v[54:55], v[22:23]
    v_pk_mul_f32 v[56:57], v[56:57], v[24:25]
    v_pk_mul_f32 v[58:59], v[58:59], v[26:27]
    v_pk_mul_f32 v[60:61], v[60:61], v[28:29]
    v_pk_mul_f32 v[62:63], v[62:63], v[30:31]
    v_exp_f32 v48, v48
    v_exp_f32 v49, v49
    v_exp_f32 v50, v50
    v_exp_f32 v51, v51
    v_exp_f32 v52, v52
    v_exp_f32 v53, v53
    v_exp_f32 v54, v54
    v_exp_f32 v55, v55
    v_exp_f32 v56, v56
    v_exp_f32 v57, v57
    v_exp_f32 v58, v58
    v_exp_f32 v59, v59
    v_exp_f32 v60, v60
    v_exp_f32 v61, v61
    v_exp_f32 v62, v62
    v_exp_f32 v63, v63
    v_pk_add_f32 v[48:49], v[48:49], 1.0 op_sel_hi:[1,0]
    v_pk_add_f32 v[50:51], v[50:51], 1.0 op_sel_hi:[1,0]
    v_pk_add_f32 v[52:53], v[52:53], 1.0 op_sel_hi:[1,0]
    v_pk_add_f32 v[54:55], v[54:55], 1.0 op_sel_hi:[1,0]
    v_pk_add_f32 v[56:57], v[56:57], 1.0 op_sel_hi:[1,0]
    v_pk_add_f32 v[58:59], v[58:59], 1.0 op_sel_hi:[1,0]
    v_pk_add_f32 v[60:61], v[60:61], 1.0 op_sel_hi:[1,0]
    v_pk_add_f32 v[62:63], v[62:63], 1.0 op_sel_hi:[1,0]
    v_rcp_f32 v48, v48
    v_rcp_f32 v49, v49
    v_rcp_f32 v50, v50
    v_rcp_f32 v51, v51
    v_rcp_f32 v52, v52
    v_rcp_f32 v53, v53
    v_rcp_f32 v54, v54
    v_rcp_f32 v55, v55
    v_rcp_f32 v56, v56
    v_rcp_f32 v57, v57
    v_rcp_f32 v58, v58
    v_rcp_f32 v59, v59
    v_rcp_f32 v60, v60
    v_rcp_f32 v61, v61
    v_rcp_f32 v62, v62
    v_rcp_f32 v63, v63
    v_pk_mul_f32 v[16:17], v[16:17], v[48:49]
    v_pk_mul_f32 v[18:19], v[18:19], v[50:51]
    v_pk_mul_f32 v[20:21], v[20:21], v[52:53]
    v_pk_mul_f32 v[22:23], v[22:23], v[54:55]
    v_pk_mul_f32 v[24:25], v[24:25], v[56:57]
    v_pk_mul_f32 v[26:27], v[26:27], v[58:59]
    v_pk_mul_f32 v[28:29], v[28:29], v[60:61]
    v_pk_mul_f32 v[30:31], v[30:31], v[62:63]
    v_cvt_pk_bf16_f32 v16, v16, v17
    v_cvt_pk_bf16_f32 v17, v18, v19
    v_cvt_pk_bf16_f32 v18, v20, v21
    v_cvt_pk_bf16_f32 v19, v22, v23
    v_cvt_pk_bf16_f32 v20, v24, v25
    v_cvt_pk_bf16_f32 v21, v26, v27
    v_cvt_pk_bf16_f32 v22, v28, v29
    v_cvt_pk_bf16_f32 v23, v30, v31
    s_cmp_lg_u32 s37, 0
    s_cbranch_scc1 L_hs_113
    buffer_store_dwordx4 v[16:19], v0, s[4:7], s26 offen offset:0 sc1
    buffer_store_dwordx4 v[20:23], v0, s[4:7], s26 offen offset:1024 sc1
    s_branch L_hsd_114
L_hs_113:
    buffer_store_dwordx4 v[16:19], v0, s[4:7], s26 offen offset:0
    buffer_store_dwordx4 v[20:23], v0, s[4:7], s26 offen offset:1024
L_hsd_114:
    s_branch L_f1j_107
L_f1sk_112:
    s_waitcnt vmcnt(0)
    s_barrier
    buffer_load_dwordx4 v[112:115], v0, s[4:7], s44 offen offset:0
    buffer_load_dwordx4 v[116:119], v0, s[4:7], s45 offen offset:0
    buffer_load_dwordx4 v[120:123], v0, s[4:7], s44 offen offset:1024
    buffer_load_dwordx4 v[124:127], v0, s[4:7], s45 offen offset:1024
    buffer_load_dwordx4 v[160:163], v0, s[4:7], s44 offen offset:2048
    buffer_load_dwordx4 v[164:167], v0, s[4:7], s45 offen offset:2048
    buffer_load_dwordx4 v[168:171], v0, s[4:7], s44 offen offset:3072
    buffer_load_dwordx4 v[172:175], v0, s[4:7], s45 offen offset:3072
    s_add_u32 s44, s44, 4096
    s_add_u32 s45, s45, 4096
    buffer_load_dwordx4 v[176:179], v0, s[4:7], s44 offen offset:0
    buffer_load_dwordx4 v[180:183], v0, s[4:7], s45 offen offset:0
    buffer_load_dwordx4 v[184:187], v0, s[4:7], s44 offen offset:1024
    buffer_load_dwordx4 v[188:191], v0, s[4:7], s45 offen offset:1024
    buffer_load_dwordx4 v[192:195], v0, s[4:7], s44 offen offset:2048
    buffer_load_dwordx4 v[196:199], v0, s[4:7], s45 offen offset:2048
    buffer_load_dwordx4 v[200:203], v0, s[4:7], s44 offen offset:3072
    buffer_load_dwordx4 v[204:207], v0, s[4:7], s45 offen offset:3072
    s_add_u32 s44, s44, 4096
    s_add_u32 s45, s45, 4096
    buffer_load_dwordx4 v[208:211], v0, s[4:7], s44 offen offset:0
    buffer_load_dwordx4 v[212:215], v0, s[4:7], s45 offen offset:0
    buffer_load_dwordx4 v[216:219], v0, s[4:7], s44 offen offset:1024
    buffer_load_dwordx4 v[220:223], v0, s[4:7], s45 offen offset:1024
L_f1j_107:
    s_lshl_b32 s26, s22, 8
    s_lshl_b32 s27, s21, 5
    s_add_u32 s26, s26, s27
    s_lshl_b32 s27, s20, 2
    s_add_u32 s26, s26, s27
    s_add_u32 s26, s26, 0x1a86000
    v_mov_b32 v2, 1
    s_mov_b64 exec, 1
    s_waitcnt vmcnt(0)
    s_cmp_lg_u32 s37, 0
    s_cbranch_scc1 L_hs_115
    buffer_store_dword v2, off, s[4:7], s26 sc1
    s_branch L_hsd_116
L_hs_115:
    buffer_store_dword v2, off, s[4:7], s26
L_hsd_116:
    s_mov_b64 exec, -1
    s_barrier
    s_lshl_b32 s26, s22, 8
    s_lshl_b32 s27, s20, 5
    s_add_u32 s26, s26, s27
    s_add_u32 s26, s26, 0x1a86000
    v_lshrrev_b32 v3, 2, v0
    v_and_b32 v3, 28, v3
    s_mov_b32 s36, 200000
L_poll_117:
    buffer_load_dword v2, v3, s[4:7], s26 offen sc1
    s_waitcnt vmcnt(0)
    v_cmp_eq_u32 vcc, 1, v2
    s_cmp_eq_u64 vcc, exec
    s_cbranch_scc1 L_polld_118
    s_sub_u32 s36, s36, 1
    s_cmp_lg_u32 s36, 0
    s_cbranch_scc1 L_poll_117
L_polld_118:
    s_mul_i32 s26, s22, 172
    s_lshl_b32 s27, s33, 1
    s_add_u32 s26, s26, s27
    s_lshl_b32 s26, s26, 10
    s_add_u32 s26, s26, 0x1000000
    s_add_u32 s27, s26, 88064
    buffer_load_dwordx4 v[128:131], v0, s[4:7], s26 offen offset:0 sc1
    buffer_load_dwordx4 v[132:135], v0, s[4:7], s27 offen offset:0 sc1
    buffer_load_dwordx4 v[136:139], v0, s[4:7], s26 offen offset:1024 sc1
    buffer_load_dwordx4 v[140:143], v0, s[4:7], s27 offen offset:1024 sc1
    buffer_load_dwordx4 v[144:147], v0, s[4:7], s26 offen offset:2048 sc1
    buffer_load_dwordx4 v[148:151], v0, s[4:7], s27 offen offset:2048 sc1
    buffer_load_dwordx4 v[152:155], v0, s[4:7], s26 offen offset:3072 sc1
    buffer_load_dwordx4 v[156:159], v0, s[4:7], s27 offen offset:3072 sc1
    s_add_u32 s26, s26, 4096
    s_add_u32 s27, s27, 4096
    buffer_load_dwordx4 v[240:243], v0, s[4:7], s26 offen offset:0 sc1
    buffer_load_dwordx4 v[244:247], v0, s[4:7], s27 offen offset:0 sc1
    buffer_load_dwordx4 v[248:251], v0, s[4:7], s26 offen offset:1024 sc1
    buffer_load_dwordx4 v[252:255], v0, s[4:7], s27 offen offset:1024 sc1
    buffer_load_dwordx4 v[80:83], v0, s[4:7], s26 offen offset:2048 sc1
    buffer_load_dwordx4 v[84:87], v0, s[4:7], s27 offen offset:2048 sc1
    buffer_load_dwordx4 v[88:91], v0, s[4:7], s26 offen offset:3072 sc1
    buffer_load_dwordx4 v[92:95], v0, s[4:7], s27 offen offset:3072 sc1
    s_add_u32 s26, s26, 4096
    s_add_u32 s27, s27, 4096
    buffer_load_dwordx4 v[96:99], v0, s[4:7], s26 offen offset:0 sc1
    buffer_load_dwordx4 v[100:103], v0, s[4:7], s27 offen offset:0 sc1
    buffer_load_dwordx4 v[104:107], v0, s[4:7], s26 offen offset:1024 sc1
    buffer_load_dwordx4 v[108:111], v0, s[4:7], s27 offen offset:1024 sc1
    s_cmp_ge_u32 s20, 3
    s_cbranch_scc1 L_f2s_119
    s_waitcnt vmcnt(18)
    v_mfma_f32_32x32x16_bf16 v[16:31], v[112:115], v[128:131], 0
    v_mfma_f32_32x32x16_bf16 v[48:63], v[116:119], v[128:131], 0
    v_mfma_f32_32x32x16_bf16 v[32:47], v[112:115], v[132:135], 0
    v_mfma_f32_32x32x16_bf16 v[64:79], v[116:119], v[132:135], 0
    buffer_load_dwordx4 v[128:131], v0, s[4:7], s26 offen offset:2048 sc1
    buffer_load_dwordx4 v[132:135], v0, s[4:7], s27 offen offset:2048 sc1
    s_waitcnt vmcnt(18)
    v_mfma_f32_32x32x16_bf16 v[16:31], v[120:123], v[136:139], v[16:31]
    v_mfma_f32_32x32x16_bf16 v[48:63], v[124:127], v[136:139], v[48:63]
    v_mfma_f32_32x32x16_bf16 v[32:47], v[120:123], v[140:143], v[32:47]
    v_mfma_f32_32x32x16_bf16 v[64:79], v[124:127], v[140:143], v[64:79]
    buffer_load_dwordx4 v[136:139], v0, s[4:7], s26 offen offset:3072 sc1
    buffer_load_dwordx4 v[140:143], v0, s[4:7], s27 offen offset:3072 sc1
    s_waitcnt vmcnt(18)
    v_mfma_f32_32x32x16_bf16 v[16:31], v[160:163], v[144:147], v[16:31]
    v_mfma_f32_32x32x16_bf16 v[48:63], v[164:167], v[144:147], v[48:63]
    v_mfma_f32_32x32x16_bf16 v[32:47], v[160:163], v[148:151], v[32:47]
    v_mfma_f32_32x32x16_bf16 v[64:79], v[164:167], v[148:151], v[64:79]
    s_lshr_b32 s28, s34, 5
    s_and_b32 s28, s28, 0x3ff
    v_lshrrev_b32 v3, 1, v1
    buffer_load_dwordx2 v[8:9], v3, s[16:19], s28 offen
    buffer_load_dwordx2 v[10:11], v3, s[16:19], s28 offen offset:16
    s_waitcnt vmcnt(18)
    v_mfma_f32_32x32x16_bf16 v[16:31], v[168:171], v[152:155], v[16:31]
    v_mfma_f32_32x32x16_bf16 v[48:63], v[172:175], v[152:155], v[48:63]
    v_mfma_f32_32x32x16_bf16 v[32:47], v[168:171], v[156:159], v[32:47]
    v_mfma_f32_32x32x16_bf16 v[64:79], v[172:175], v[156:159], v[64:79]
    s_waitcnt vmcnt(16)
    v_mfma_f32_32x32x16_bf16 v[16:31], v[176:179], v[240:243], v[16:31]
    v_mfma_f32_32x32x16_bf16 v[48:63], v[180:183], v[240:243], v[48:63]
    v_mfma_f32_32x32x16_bf16 v[32:47], v[176:179], v[244:247], v[32:47]
    v_mfma_f32_32x32x16_bf16 v[64:79], v[180:183], v[244:247], v[64:79]
    s_waitcnt vmcnt(14)
    v_mfma_f32_32x32x16_bf16 v[16:31], v[184:187], v[248:251], v[16:31]
    v_mfma_f32_32x32x16_bf16 v[48:63], v[188:191], v[248:251], v[48:63]
    v_mfma_f32_32x32x16_bf16 v[32:47], v[184:187], v[252:255], v[32:47]
    v_mfma_f32_32x32x16_bf16 v[64:79], v[188:191], v[252:255], v[64:79]
    s_waitcnt vmcnt(12)
    v_mfma_f32_32x32x16_bf16 v[16:31], v[192:195], v[80:83], v[16:31]
    v_mfma_f32_32x32x16_bf16 v[48:63], v[196:199], v[80:83], v[48:63]
    v_mfma_f32_32x32x16_bf16 v[32:47], v[192:195], v[84:87], v[32:47]
    v_mfma_f32_32x32x16_bf16 v[64:79], v[196:199], v[84:87], v[64:79]
    s_waitcnt vmcnt(10)
    v_mfma_f32_32x32x16_bf16 v[16:31], v[200:203], v[88:91], v[16:31]
    v_mfma_f32_32x32x16_bf16 v[48:63], v[204:207], v[88:91], v[48:63]
    v_mfma_f32_32x32x16_bf16 v[32:47], v[200:203], v[92:95], v[32:47]
    v_mfma_f32_32x32x16_bf16 v[64:79], v[204:207], v[92:95], v[64:79]
    s_waitcnt vmcnt(8)
    v_mfma_f32_32x32x16_bf16 v[16:31], v[208:211], v[96:99], v[16:31]
    v_mfma_f32_32x32x16_bf16 v[48:63], v[212:215], v[96:99], v[48:63]
    v_mfma_f32_32x32x16_bf16 v[32:47], v[208:211], v[100:103], v[32:47]
    v_mfma_f32_32x32x16_bf16 v[64:79], v[212:215], v[100:103], v[64:79]
    s_waitcnt vmcnt(6)
    v_mfma_f32_32x32x16_bf16 v[16:31], v[216:219], v[104:107], v[16:31]
    v_mfma_f32_32x32x16_bf16 v[48:63], v[220:223], v[104:107], v[48:63]
    v_mfma_f32_32x32x16_bf16 v[32:47], v[216:219], v[108:111], v[32:47]
    v_mfma_f32_32x32x16_bf16 v[64:79], v[220:223], v[108:111], v[64:79]
    s_waitcnt vmcnt(4)
    v_mfma_f32_32x32x16_bf16 v[16:31], v[224:227], v[128:131], v[16:31]
    v_mfma_f32_32x32x16_bf16 v[48:63], v[228:231], v[128:131], v[48:63]
    v_mfma_f32_32x32x16_bf16 v[32:47], v[224:227], v[132:135], v[32:47]
    v_mfma_f32_32x32x16_bf16 v[64:79], v[228:231], v[132:135], v[64:79]
    s_waitcnt vmcnt(2)
    v_mfma_f32_32x32x16_bf16 v[16:31], v[232:235], v[136:139], v[16:31]
    v_mfma_f32_32x32x16_bf16 v[48:63], v[236:239], v[136:139], v[48:63]
    v_mfma_f32_32x32x16_bf16 v[32:47], v[232:235], v[140:143], v[32:47]
    v_mfma_f32_32x32x16_bf16 v[64:79], v[236:239], v[140:143], v[64:79]
    s_branch L_f2f_120
L_f2s_119:
    s_lshr_b32 s28, s34, 5
    s_and_b32 s28, s28, 0x3ff
    v_lshrrev_b32 v3, 1, v1
    buffer_load_dwordx2 v[8:9], v3, s[16:19], s28 offen
    buffer_load_dwordx2 v[10:11], v3, s[16:19], s28 offen offset:16
    s_waitcnt vmcnt(20)
    v_mfma_f32_32x32x16_bf16 v[16:31], v[112:115], v[128:131], 0
    v_mfma_f32_32x32x16_bf16 v[48:63], v[116:119], v[128:131], 0
    v_mfma_f32_32x32x16_bf16 v[32:47], v[112:115], v[132:135], 0
    v_mfma_f32_32x32x16_bf16 v[64:79], v[116:119], v[132:135], 0
    s_waitcnt vmcnt(18)
    v_mfma_f32_32x32x16_bf16 v[16:31], v[120:123], v[136:139], v[16:31]
    v_mfma_f32_32x32x16_bf16 v[48:63], v[124:127], v[136:139], v[48:63]
    v_mfma_f32_32x32x16_bf16 v[32:47], v[120:123], v[140:143], v[32:47]
    v_mfma_f32_32x32x16_bf16 v[64:79], v[124:127], v[140:143], v[64:79]
    s_waitcnt vmcnt(16)
    v_mfma_f32_32x32x16_bf16 v[16:31], v[160:163], v[144:147], v[16:31]
    v_mfma_f32_32x32x16_bf16 v[48:63], v[164:167], v[144:147], v[48:63]
    v_mfma_f32_32x32x16_bf16 v[32:47], v[160:163], v[148:151], v[32:47]
    v_mfma_f32_32x32x16_bf16 v[64:79], v[164:167], v[148:151], v[64:79]
    s_waitcnt vmcnt(14)
    v_mfma_f32_32x32x16_bf16 v[16:31], v[168:171], v[152:155], v[16:31]
    v_mfma_f32_32x32x16_bf16 v[48:63], v[172:175], v[152:155], v[48:63]
    v_mfma_f32_32x32x16_bf16 v[32:47], v[168:171], v[156:159], v[32:47]
    v_mfma_f32_32x32x16_bf16 v[64:79], v[172:175], v[156:159], v[64:79]
    s_waitcnt vmcnt(12)
    v_mfma_f32_32x32x16_bf16 v[16:31], v[176:179], v[240:243], v[16:31]
    v_mfma_f32_32x32x16_bf16 v[48:63], v[180:183], v[240:243], v[48:63]
    v_mfma_f32_32x32x16_bf16 v[32:47], v[176:179], v[244:247], v[32:47]
    v_mfma_f32_32x32x16_bf16 v[64:79], v[180:183], v[244:247], v[64:79]
    s_waitcnt vmcnt(10)
    v_mfma_f32_32x32x16_bf16 v[16:31], v[184:187], v[248:251], v[16:31]
    v_mfma_f32_32x32x16_bf16 v[48:63], v[188:191], v[248:251], v[48:63]
    v_mfma_f32_32x32x16_bf16 v[32:47], v[184:187], v[252:255], v[32:47]
    v_mfma_f32_32x32x16_bf16 v[64:79], v[188:191], v[252:255], v[64:79]
    s_waitcnt vmcnt(8)
    v_mfma_f32_32x32x16_bf16 v[16:31], v[192:195], v[80:83], v[16:31]
    v_mfma_f32_32x32x16_bf16 v[48:63], v[196:199], v[80:83], v[48:63]
    v_mfma_f32_32x32x16_bf16 v[32:47], v[192:195], v[84:87], v[32:47]
    v_mfma_f32_32x32x16_bf16 v[64:79], v[196:199], v[84:87], v[64:79]
    s_waitcnt vmcnt(6)
    v_mfma_f32_32x32x16_bf16 v[16:31], v[200:203], v[88:91], v[16:31]
    v_mfma_f32_32x32x16_bf16 v[48:63], v[204:207], v[88:91], v[48:63]
    v_mfma_f32_32x32x16_bf16 v[32:47], v[200:203], v[92:95], v[32:47]
    v_mfma_f32_32x32x16_bf16 v[64:79], v[204:207], v[92:95], v[64:79]
    s_waitcnt vmcnt(4)
    v_mfma_f32_32x32x16_bf16 v[16:31], v[208:211], v[96:99], v[16:31]
    v_mfma_f32_32x32x16_bf16 v[48:63], v[212:215], v[96:99], v[48:63]
    v_mfma_f32_32x32x16_bf16 v[32:47], v[208:211], v[100:103], v[32:47]
    v_mfma_f32_32x32x16_bf16 v[64:79], v[212:215], v[100:103], v[64:79]
    s_waitcnt vmcnt(2)
    v_mfma_f32_32x32x16_bf16 v[16:31], v[216:219], v[104:107], v[16:31]
    v_mfma_f32_32x32x16_bf16 v[48:63], v[220:223], v[104:107], v[48:63]
    v_mfma_f32_32x32x16_bf16 v[32:47], v[216:219], v[108:111], v[32:47]
    v_mfma_f32_32x32x16_bf16 v[64:79], v[220:223], v[108:111], v[64:79]
L_f2f_120:
    s_lshl_b32 s26, s20, 11
    v_add_u32 v2, s26, v0
    v_add_u32 v3, 0x10000, v2
    s_nop 11
    ds_write_b128 v2, v[16:19] offset:0
    ds_write_b128 v2, v[20:23] offset:1024
    ds_write_b128 v2, v[48:51] offset:16384
    ds_write_b128 v2, v[52:55] offset:17408
    ds_write_b128 v2, v[32:35] offset:32768
    ds_write_b128 v2, v[36:39] offset:33792
    ds_write_b128 v2, v[64:67] offset:49152
    ds_write_b128 v2, v[68:71] offset:50176
    ds_write_b128 v3, v[24:27] offset:0
    ds_write_b128 v3, v[28:31] offset:1024
    ds_write_b128 v3, v[56:59] offset:16384
    ds_write_b128 v3, v[60:63] offset:17408
    ds_write_b128 v3, v[40:43] offset:32768
    ds_write_b128 v3, v[44:47] offset:33792
    ds_write_b128 v3, v[72:75] offset:49152
    ds_write_b128 v3, v[76:79] offset:50176
    s_lshl_b32 s26, s20, 14
    v_add_u32 v2, s26, v0
    s_waitcnt lgkmcnt(0)
    s_barrier
    ds_read_b128 v[16:19], v2 offset:0
    ds_read_b128 v[20:23], v2 offset:1024
    ds_read_b128 v[24:27], v2 offset:2048
    ds_read_b128 v[28:31], v2 offset:3072
    ds_read_b128 v[32:35], v2 offset:4096
    ds_read_b128 v[36:39], v2 offset:5120
    ds_read_b128 v[40:43], v2 offset:6144
    ds_read_b128 v[44:47], v2 offset:7168
    s_waitcnt vmcnt(0) lgkmcnt(4)
    ds_read_b128 v[48:51], v2 offset:8192
    ds_read_b128 v[52:55], v2 offset:9216
    ds_read_b128 v[56:59], v2 offset:10240
    ds_read_b128 v[60:63], v2 offset:11264
    ds_read_b128 v[64:67], v2 offset:12288
    ds_read_b128 v[68:71], v2 offset:13312
    ds_read_b128 v[72:75], v2 offset:14336
    ds_read_b128 v[76:79], v2 offset:15360
    v_lshlrev_b32 v4, 16, v12
    v_and_b32 v5, 0xffff0000, v12
    v_add_f32 v16, v16, v4
    v_add_f32 v17, v17, v5
    v_lshlrev_b32 v4, 16, v13
    v_and_b32 v5, 0xffff0000, v13
    v_add_f32 v18, v18, v4
    v_add_f32 v19, v19, v5
    v_lshlrev_b32 v4, 16, v14
    v_and_b32 v5, 0xffff0000, v14
    v_add_f32 v20, v20, v4
    v_add_f32 v21, v21, v5
    v_lshlrev_b32 v4, 16, v15
    v_and_b32 v5, 0xffff0000, v15
    v_add_f32 v22, v22, v4
    v_add_f32 v23, v23, v5
    v_lshlrev_b32 v4, 16, v8
    v_and_b32 v5, 0xffff0000, v8
    v_add_f32 v24, v24, v4
    v_add_f32 v25, v25, v5
    v_lshlrev_b32 v4, 16, v9
    v_and_b32 v5, 0xffff0000, v9
    v_add_f32 v26, v26, v4
    v_add_f32 v27, v27, v5
    v_lshlrev_b32 v4, 16, v10
    v_and_b32 v5, 0xffff0000, v10
    v_add_f32 v28, v28, v4
    v_add_f32 v29, v29, v5
    v_lshlrev_b32 v4, 16, v11
    v_and_b32 v5, 0xffff0000, v11
    v_add_f32 v30, v30, v4
    v_add_f32 v31, v31, v5
    v_pk_add_f32 v[16:17], v[16:17], v[24:25]
    v_pk_add_f32 v[18:19], v[18:19], v[26:27]
    v_pk_add_f32 v[20:21], v[20:21], v[28:29]
    v_pk_add_f32 v[22:23], v[22:23], v[30:31]
    s_waitcnt lgkmcnt(10)
    v_pk_add_f32 v[16:17], v[16:17], v[32:33]
    v_pk_add_f32 v[18:19], v[18:19], v[34:35]
    v_pk_add_f32 v[20:21], v[20:21], v[36:37]
    v_pk_add_f32 v[22:23], v[22:23], v[38:39]
    s_waitcnt lgkmcnt(8)
    v_pk_add_f32 v[16:17], v[16:17], v[40:41]
    v_pk_add_f32 v[18:19], v[18:19], v[42:43]
    v_pk_add_f32 v[20:21], v[20:21], v[44:45]
    v_pk_add_f32 v[22:23], v[22:23], v[46:47]
    s_waitcnt lgkmcnt(6)
    v_pk_add_f32 v[16:17], v[16:17], v[48:49]
    v_pk_add_f32 v[18:19], v[18:19], v[50:51]
    v_pk_add_f32 v[20:21], v[20:21], v[52:53]
    v_pk_add_f32 v[22:23], v[22:23], v[54:55]
    s_waitcnt lgkmcnt(4)
    v_pk_add_f32 v[16:17], v[16:17], v[56:57]
    v_pk_add_f32 v[18:19], v[18:19], v[58:59]
    v_pk_add_f32 v[20:21], v[20:21], v[60:61]
    v_pk_add_f32 v[22:23], v[22:23], v[62:63]
    s_waitcnt lgkmcnt(2)
    v_pk_add_f32 v[16:17], v[16:17], v[64:65]
    v_pk_add_f32 v[18:19], v[18:19], v[66:67]
    v_pk_add_f32 v[20:21], v[20:21], v[68:69]
    v_pk_add_f32 v[22:23], v[22:23], v[70:71]
    s_waitcnt lgkmcnt(0)
    v_pk_add_f32 v[16:17], v[16:17], v[72:73]
    v_pk_add_f32 v[18:19], v[18:19], v[74:75]
    v_pk_add_f32 v[20:21], v[20:21], v[76:77]
    v_pk_add_f32 v[22:23], v[22:23], v[78:79]
    v_cvt_pk_bf16_f32 v12, v16, v17
    v_cvt_pk_bf16_f32 v13, v18, v19
    v_cvt_pk_bf16_f32 v14, v20, v21
    v_cvt_pk_bf16_f32 v15, v22, v23
    s_lshr_b32 s26, s34, 15
    s_lshl_b32 s26, s26, 15
    s_lshr_b32 s27, s34, 5
    s_and_b32 s27, s27, 0x3ff
    s_add_u32 s26, s26, s27
    v_and_b32 v2, 0x1f0, v0
    v_lshlrev_b32 v2, 6, v2
    v_lshrrev_b32 v3, 1, v1
    v_add_u32 v2, v2, v3
    buffer_store_dwordx2 v[12:13], v2, s[8:11], s26 offen
    buffer_store_dwordx2 v[14:15], v2, s[8:11], s26 offen offset:16
main_kernel_exit:
    s_endpgm
.section .rodata,"a"
.p2align 6
.amdhsa_kernel prep_kernel
  .amdhsa_next_free_vgpr 64
  .amdhsa_next_free_sgpr 102
  .amdhsa_accum_offset 64
  .amdhsa_group_segment_fixed_size 0
  .amdhsa_kernarg_size 104
  .amdhsa_user_sgpr_count 2
  .amdhsa_user_sgpr_kernarg_segment_ptr 1
  .amdhsa_system_sgpr_workgroup_id_x 1
.end_amdhsa_kernel
.p2align 6
.amdhsa_kernel main_kernel
  .amdhsa_next_free_vgpr 256
  .amdhsa_next_free_sgpr 102
  .amdhsa_accum_offset 256
  .amdhsa_group_segment_fixed_size 0
  .amdhsa_kernarg_size 104
  .amdhsa_user_sgpr_count 2
  .amdhsa_user_sgpr_kernarg_segment_ptr 1
  .amdhsa_system_sgpr_workgroup_id_x 1
.end_amdhsa_kernel
```
